```python
import torch

def _softmax(x, axis=-1):
    return torch.softmax(x, dim=axis)
def _gelu(x):
    return torch.nn.functional.gelu(x, approximate="tanh")
def _silu(x):
    return torch.nn.functional.silu(x)
def _sigmoid(x):
    return torch.sigmoid(x)
def _layernorm(x, axis=-1, eps=1e-5):
    m = x.mean(dim=axis, keepdim=True)
    v = x.var(dim=axis, keepdim=True, unbiased=False)
    return (x - m) / torch.sqrt(v + eps)
def _scatter_add(tgt, idx, src, axis=0):
    return tgt.clone().index_add_(axis, idx, src)
def _segment_sum(src, seg, n):
    out = torch.zeros((n,) + src.shape[1:], dtype=src.dtype)
    return out.index_add_(0, seg, src)
def _pad(x, pw):
    flat = tuple(v for pair in reversed(pw) for v in pair)
    return torch.nn.functional.pad(x, flat)

kernel_name = 'interleave_layers__linear_attn_block__swiglu_ffn__prompt'

def setup_inputs():

    _w = (lambda a: (lambda t: t.to(torch.bfloat16) if t.is_floating_point() else t)(torch.as_tensor(a)))
    def _A_setup():
        B, S, D = 1, 2048, 640
        return {
            "x": _w((lambda *s: torch.randn(*s, dtype=torch.bfloat16) * 0.05)(B, S, D)),
            "wqkv": _w((lambda *s: torch.randn(*s, dtype=torch.bfloat16) * 0.05)(D, 3 * D)),
            "wo": _w((lambda *s: torch.randn(*s, dtype=torch.bfloat16) * 0.05)(D, D)),
        }
    _A_in = _A_setup()

    def _B_setup():
        B, S, D, F = 1, 2048, 640, 1728
        return {
            "x": _w((lambda *s: torch.randn(*s, dtype=torch.bfloat16) * 0.05)(B, S, D)),
            "w_gate": _w((lambda *s: torch.randn(*s, dtype=torch.bfloat16) * 0.05)(D, F)),
            "w_up": _w((lambda *s: torch.randn(*s, dtype=torch.bfloat16) * 0.05)(D, F)),
            "w_down": _w((lambda *s: torch.randn(*s, dtype=torch.bfloat16) * 0.05)(F, D)),
        }
    _B_in = _B_setup()

    return {
        "A_x": _A_in["x"],
        "A_wqkv": _A_in["wqkv"],
        "A_wo": _A_in["wo"],
        "B_x": _B_in["x"],
        "B_w_gate": _B_in["w_gate"],
        "B_w_up": _B_in["w_up"],
        "B_w_down": _B_in["w_down"],
    }

def reference(A_x, A_wqkv, A_wo, B_x, B_w_gate, B_w_up, B_w_down):
    def _A_ref(x, wqkv, wo):
        B, S, D = x.shape
        H = 32; Dh = D // H
        qkv = (lambda x, *d: x.permute(*d))((x @ wqkv).reshape(B, S, 3, H, Dh), 2, 0, 3, 1, 4)
        q, k, v = qkv[0], qkv[1], qkv[2]
        phi = lambda t: torch.where(t > 0, t + 1, torch.exp(t)) + 1e-6
        pq, pk = phi(q), phi(k)
        kv = torch.einsum("bhsd,bhse->bhde", pk, v)
        z = torch.einsum("bhsd->bhd", pk)
        num = torch.einsum("bhqd,bhde->bhqe", pq, kv)
        den = torch.einsum("bhqd,bhd->bhq", pq, z)[..., None] + 1e-6
        o = num / den
        return (lambda x, *d: x.permute(*d))(o, 0, 2, 1, 3).reshape(B, S, D) @ wo

    def _B_ref(x, w_gate, w_up, w_down):
        g = _silu(x @ w_gate)
        u = x @ w_up
        return (g * u) @ w_down

    x = A_x
    x = x + _A_ref(_layernorm(x, axis=-1), A_wqkv, A_wo)
    x = x + _B_ref(_layernorm(x, axis=-1), B_w_gate, B_w_up, B_w_down)
    x = x + _A_ref(_layernorm(x, axis=-1), A_wqkv, A_wo)
    x = x + _B_ref(_layernorm(x, axis=-1), B_w_gate, B_w_up, B_w_down)
    return x
```

```asm
; @launch kernel=k0_kernel grid=(429,1,1) block=(256,1,1) lds=36864
; @launch kernel=main_kernel grid=(256,1,1) block=(256,1,1) lds=163840
.amdgcn_target "amdgcn-amd-amdhsa--gfx950"
.text
.globl k0_kernel
.p2align 8
.type k0_kernel,@function
k0_kernel:
  s_cmp_ge_u32 s2, 429
  s_cbranch_scc1 K0_END
  s_load_dwordx2 s[4:5], s[0:1], 72
  v_lshrrev_b32 v1, 6, v0
  v_and_b32 v2, 63, v0
  v_readfirstlane_b32 s3, v1
  v_lshrrev_b32 v3, 4, v2
  v_and_b32 v4, 15, v2
  v_lshlrev_b32 v5, 4, v2
  v_mov_b32 v15, 0x40000000
  s_mul_i32 s46, s3, 9216
  s_mov_b32 s17, 84
  s_cmp_ge_u32 s2, 172
  s_cselect_b32 s17, -172, s17
  s_cmp_ge_u32 s2, 256
  s_cselect_b32 s17, 0, s17
  s_add_u32 s2, s2, s17
  s_cmp_ge_u32 s2, 389
  s_cbranch_scc1 K0_J34
  s_cmp_ge_u32 s2, 301
  s_cbranch_scc1 K0_J2
  s_cmp_ge_u32 s2, 221
  s_cbranch_scc1 K0_J1
  s_cmp_ge_u32 s2, 212
  s_cbranch_scc1 K0_J7
  s_cmp_ge_u32 s2, 84
  s_cbranch_scc1 K0_J5
  s_branch K0_J6
K0_J1:
  s_load_dwordx2 s[6:7], s[0:1], 8
  s_sub_u32 s29, s2, 221
  s_and_b32 s30, s29, 3
  s_lshr_b32 s29, s29, 2
  s_lshl_b32 s30, s30, 2
  s_add_u32 s30, s30, s3
  s_mul_i32 s47, s29, 122880
  s_mul_i32 s31, s30, 80
  s_mul_i32 s24, s30, 163840
  s_mul_i32 s44, s29, 3072
  s_add_u32 s44, s44, s24
  s_add_u32 s44, s44, 102400
  s_mul_i32 s25, s29, 5120
  s_add_u32 s24, s24, s25
  s_mov_b32 s32, 2480
  s_mov_b32 s33, -160
  s_waitcnt lgkmcnt(0)
  s_mov_b32 s8, s6
  s_mov_b32 s9, s7
  s_mov_b32 s10, 0x258000
  s_mov_b32 s11, 0x00020000
  s_mov_b32 s12, s4
  s_mov_b32 s13, s5
  s_mov_b32 s14, 0x280000
  s_mov_b32 s15, 0x00020000
  s_mov_b32 s45, 3840
  v_add_u32 v6, 0, v2
  v_mul_u32_u24 v7, 3641, v6
  v_lshrrev_b32 v7, 16, v7
  v_mul_u32_u24 v8, 18, v7
  v_sub_u32 v8, v6, v8
  v_mov_b32 v12, s33
  v_mov_b32 v13, s32
  v_cmp_gt_u32 vcc, 10, v8
  s_nop 1
  v_cndmask_b32 v12, v12, v13, vcc
  v_mov_b32 v13, 1280
  v_cmp_gt_u32 vcc, 5, v8
  s_nop 1
  v_cndmask_b32 v12, v12, v13, vcc
  v_lshl_add_u32 v9, v8, 4, v12
  v_add_u32 v9, s31, v9
  v_cmp_gt_u32 vcc, 15, v8
  s_nop 1
  v_cndmask_b32 v9, v15, v9, vcc
  v_mad_u32_u24 v16, v7, s45, v9
  s_add_u32 m0, s46, 0
  s_nop 0
  buffer_load_dwordx4 v16, s[8:11], s47 offen lds
  v_add_u32 v6, 64, v2
  v_mul_u32_u24 v7, 3641, v6
  v_lshrrev_b32 v7, 16, v7
  v_mul_u32_u24 v8, 18, v7
  v_sub_u32 v8, v6, v8
  v_mov_b32 v12, s33
  v_mov_b32 v13, s32
  v_cmp_gt_u32 vcc, 10, v8
  s_nop 1
  v_cndmask_b32 v12, v12, v13, vcc
  v_mov_b32 v13, 1280
  v_cmp_gt_u32 vcc, 5, v8
  s_nop 1
  v_cndmask_b32 v12, v12, v13, vcc
  v_lshl_add_u32 v9, v8, 4, v12
  v_add_u32 v9, s31, v9
  v_cmp_gt_u32 vcc, 15, v8
  s_nop 1
  v_cndmask_b32 v9, v15, v9, vcc
  v_mad_u32_u24 v17, v7, s45, v9
  s_add_u32 m0, s46, 1024
  s_nop 0
  buffer_load_dwordx4 v17, s[8:11], s47 offen lds
  v_add_u32 v6, 128, v2
  v_mul_u32_u24 v7, 3641, v6
  v_lshrrev_b32 v7, 16, v7
  v_mul_u32_u24 v8, 18, v7
  v_sub_u32 v8, v6, v8
  v_mov_b32 v12, s33
  v_mov_b32 v13, s32
  v_cmp_gt_u32 vcc, 10, v8
  s_nop 1
  v_cndmask_b32 v12, v12, v13, vcc
  v_mov_b32 v13, 1280
  v_cmp_gt_u32 vcc, 5, v8
  s_nop 1
  v_cndmask_b32 v12, v12, v13, vcc
  v_lshl_add_u32 v9, v8, 4, v12
  v_add_u32 v9, s31, v9
  v_cmp_gt_u32 vcc, 15, v8
  s_nop 1
  v_cndmask_b32 v9, v15, v9, vcc
  v_mad_u32_u24 v18, v7, s45, v9
  s_add_u32 m0, s46, 2048
  s_nop 0
  buffer_load_dwordx4 v18, s[8:11], s47 offen lds
  v_add_u32 v6, 192, v2
  v_mul_u32_u24 v7, 3641, v6
  v_lshrrev_b32 v7, 16, v7
  v_mul_u32_u24 v8, 18, v7
  v_sub_u32 v8, v6, v8
  v_mov_b32 v12, s33
  v_mov_b32 v13, s32
  v_cmp_gt_u32 vcc, 10, v8
  s_nop 1
  v_cndmask_b32 v12, v12, v13, vcc
  v_mov_b32 v13, 1280
  v_cmp_gt_u32 vcc, 5, v8
  s_nop 1
  v_cndmask_b32 v12, v12, v13, vcc
  v_lshl_add_u32 v9, v8, 4, v12
  v_add_u32 v9, s31, v9
  v_cmp_gt_u32 vcc, 15, v8
  s_nop 1
  v_cndmask_b32 v9, v15, v9, vcc
  v_mad_u32_u24 v19, v7, s45, v9
  s_add_u32 m0, s46, 3072
  s_nop 0
  buffer_load_dwordx4 v19, s[8:11], s47 offen lds
  v_add_u32 v6, 256, v2
  v_mul_u32_u24 v7, 3641, v6
  v_lshrrev_b32 v7, 16, v7
  v_mul_u32_u24 v8, 18, v7
  v_sub_u32 v8, v6, v8
  v_mov_b32 v12, s33
  v_mov_b32 v13, s32
  v_cmp_gt_u32 vcc, 10, v8
  s_nop 1
  v_cndmask_b32 v12, v12, v13, vcc
  v_mov_b32 v13, 1280
  v_cmp_gt_u32 vcc, 5, v8
  s_nop 1
  v_cndmask_b32 v12, v12, v13, vcc
  v_lshl_add_u32 v9, v8, 4, v12
  v_add_u32 v9, s31, v9
  v_cmp_gt_u32 vcc, 15, v8
  s_nop 1
  v_cndmask_b32 v9, v15, v9, vcc
  v_mad_u32_u24 v20, v7, s45, v9
  s_add_u32 m0, s46, 4096
  s_nop 0
  buffer_load_dwordx4 v20, s[8:11], s47 offen lds
  v_add_u32 v6, 320, v2
  v_mul_u32_u24 v7, 3641, v6
  v_lshrrev_b32 v7, 16, v7
  v_mul_u32_u24 v8, 18, v7
  v_sub_u32 v8, v6, v8
  v_mov_b32 v12, s33
  v_mov_b32 v13, s32
  v_cmp_gt_u32 vcc, 10, v8
  s_nop 1
  v_cndmask_b32 v12, v12, v13, vcc
  v_mov_b32 v13, 1280
  v_cmp_gt_u32 vcc, 5, v8
  s_nop 1
  v_cndmask_b32 v12, v12, v13, vcc
  v_lshl_add_u32 v9, v8, 4, v12
  v_add_u32 v9, s31, v9
  v_cmp_gt_u32 vcc, 15, v8
  s_nop 1
  v_cndmask_b32 v9, v15, v9, vcc
  v_mad_u32_u24 v21, v7, s45, v9
  s_add_u32 m0, s46, 5120
  s_nop 0
  buffer_load_dwordx4 v21, s[8:11], s47 offen lds
  v_add_u32 v6, 384, v2
  v_mul_u32_u24 v7, 3641, v6
  v_lshrrev_b32 v7, 16, v7
  v_mul_u32_u24 v8, 18, v7
  v_sub_u32 v8, v6, v8
  v_mov_b32 v12, s33
  v_mov_b32 v13, s32
  v_cmp_gt_u32 vcc, 10, v8
  s_nop 1
  v_cndmask_b32 v12, v12, v13, vcc
  v_mov_b32 v13, 1280
  v_cmp_gt_u32 vcc, 5, v8
  s_nop 1
  v_cndmask_b32 v12, v12, v13, vcc
  v_lshl_add_u32 v9, v8, 4, v12
  v_add_u32 v9, s31, v9
  v_cmp_gt_u32 vcc, 15, v8
  s_nop 1
  v_cndmask_b32 v9, v15, v9, vcc
  v_mad_u32_u24 v22, v7, s45, v9
  s_add_u32 m0, s46, 6144
  s_nop 0
  buffer_load_dwordx4 v22, s[8:11], s47 offen lds
  v_add_u32 v6, 448, v2
  v_mul_u32_u24 v7, 3641, v6
  v_lshrrev_b32 v7, 16, v7
  v_mul_u32_u24 v8, 18, v7
  v_sub_u32 v8, v6, v8
  v_mov_b32 v12, s33
  v_mov_b32 v13, s32
  v_cmp_gt_u32 vcc, 10, v8
  s_nop 1
  v_cndmask_b32 v12, v12, v13, vcc
  v_mov_b32 v13, 1280
  v_cmp_gt_u32 vcc, 5, v8
  s_nop 1
  v_cndmask_b32 v12, v12, v13, vcc
  v_lshl_add_u32 v9, v8, 4, v12
  v_add_u32 v9, s31, v9
  v_cmp_gt_u32 vcc, 15, v8
  s_nop 1
  v_cndmask_b32 v9, v15, v9, vcc
  v_mad_u32_u24 v23, v7, s45, v9
  s_add_u32 m0, s46, 7168
  s_nop 0
  buffer_load_dwordx4 v23, s[8:11], s47 offen lds
  v_add_u32 v6, 512, v2
  v_mul_u32_u24 v7, 3641, v6
  v_lshrrev_b32 v7, 16, v7
  v_mul_u32_u24 v8, 18, v7
  v_sub_u32 v8, v6, v8
  v_mov_b32 v12, s33
  v_mov_b32 v13, s32
  v_cmp_gt_u32 vcc, 10, v8
  s_nop 1
  v_cndmask_b32 v12, v12, v13, vcc
  v_mov_b32 v13, 1280
  v_cmp_gt_u32 vcc, 5, v8
  s_nop 1
  v_cndmask_b32 v12, v12, v13, vcc
  v_lshl_add_u32 v9, v8, 4, v12
  v_add_u32 v9, s31, v9
  v_cmp_gt_u32 vcc, 15, v8
  s_nop 1
  v_cndmask_b32 v9, v15, v9, vcc
  v_mad_u32_u24 v24, v7, s45, v9
  s_add_u32 m0, s46, 8192
  s_nop 0
  buffer_load_dwordx4 v24, s[8:11], s47 offen lds
  v_lshrrev_b32 v6, 2, v2
  v_mul_u32_u24 v6, 288, v6
  v_and_b32 v7, 3, v2
  v_lshl_add_u32 v6, v7, 3, v6
  v_add_u32 v6, s46, v6
  s_add_u32 s25, s24, 4096
  v_cmp_gt_u32 s[34:35], 8, v4
  s_waitcnt vmcnt(0)
  ds_read_b64_tr_b16 v[32:33], v6 offset:0
  ds_read_b64_tr_b16 v[34:35], v6 offset:4608
  ds_read_b64_tr_b16 v[36:37], v6 offset:32
  ds_read_b64_tr_b16 v[38:39], v6 offset:4640
  ds_read_b64_tr_b16 v[40:41], v6 offset:64
  ds_read_b64_tr_b16 v[42:43], v6 offset:4672
  ds_read_b64_tr_b16 v[44:45], v6 offset:96
  ds_read_b64_tr_b16 v[46:47], v6 offset:4704
  ds_read_b64_tr_b16 v[48:49], v6 offset:128
  ds_read_b64_tr_b16 v[50:51], v6 offset:4736
  ds_read_b64_tr_b16 v[52:53], v6 offset:160
  ds_read_b64_tr_b16 v[54:55], v6 offset:4768
  ds_read_b64_tr_b16 v[56:57], v6 offset:192
  ds_read_b64_tr_b16 v[58:59], v6 offset:4800
  ds_read_b64_tr_b16 v[60:61], v6 offset:224
  ds_read_b64_tr_b16 v[62:63], v6 offset:4832
  s_waitcnt lgkmcnt(14)
  buffer_store_dwordx4 v[32:35], v5, s[12:15], s24 offen offset:0
  s_waitcnt lgkmcnt(12)
  buffer_store_dwordx4 v[36:39], v5, s[12:15], s24 offen offset:1024
  s_waitcnt lgkmcnt(10)
  buffer_store_dwordx4 v[40:43], v5, s[12:15], s24 offen offset:2048
  s_waitcnt lgkmcnt(8)
  buffer_store_dwordx4 v[44:47], v5, s[12:15], s24 offen offset:3072
  s_waitcnt lgkmcnt(6)
  buffer_store_dwordx4 v[48:51], v5, s[12:15], s25 offen offset:0
  s_waitcnt lgkmcnt(4)
  buffer_store_dwordx4 v[52:55], v5, s[12:15], s44 offen offset:0
  s_waitcnt lgkmcnt(2)
  buffer_store_dwordx4 v[56:59], v5, s[12:15], s44 offen offset:1024
  s_waitcnt lgkmcnt(0)
  v_cndmask_b32 v60, 0, v60, s[34:35]
  v_cndmask_b32 v61, 0, v61, s[34:35]
  v_cndmask_b32 v62, 0, v62, s[34:35]
  v_cndmask_b32 v63, 0, v63, s[34:35]
  buffer_store_dwordx4 v[60:63], v5, s[12:15], s44 offen offset:2048
  s_branch K0_END
K0_J2:
  s_sub_u32 s29, s2, 301
  s_and_b32 s31, s29, 1
  s_lshl_b32 s28, s31, 3
  s_add_u32 s6, s0, s28
  s_addc_u32 s7, s1, 0
  s_load_dwordx2 s[6:7], s[6:7], 32
  s_lshr_b32 s30, s29, 1
  s_and_b32 s30, s30, 3
  s_lshl_b32 s30, s30, 2
  s_add_u32 s30, s30, s3
  s_lshr_b32 s29, s29, 3
  s_mul_i32 s47, s29, 110592
  s_mul_i32 s32, s30, 216
  s_mul_i32 s24, s30, 280
  s_mul_i32 s44, s29, 6
  s_mul_i32 s33, s31, 3
  s_add_u32 s44, s44, s33
  s_add_u32 s44, s44, s24
  s_add_u32 s44, s44, 160
  s_lshl_b32 s44, s44, 10
  s_lshl_b32 s33, s29, 3
  s_add_u32 s24, s24, s33
  s_lshl_b32 s31, s31, 2
  s_add_u32 s24, s24, s31
  s_lshl_b32 s24, s24, 10
  s_waitcnt lgkmcnt(0)
  s_mov_b32 s8, s6
  s_mov_b32 s9, s7
  s_mov_b32 s10, 0x21c000
  s_mov_b32 s11, 0x00020000
  s_add_u32 s12, s4, 0x348000
  s_addc_u32 s13, s5, 0
  s_mov_b32 s14, 0x460000
  s_mov_b32 s15, 0x00020000
  s_mov_b32 s45, 3456
  v_add_u32 v6, 0, v2
  v_mul_u32_u24 v7, 4682, v6
  v_lshrrev_b32 v7, 16, v7
  v_mul_u32_u24 v8, 14, v7
  v_sub_u32 v8, v6, v8
  v_lshlrev_b32 v9, 4, v8
  v_min_u32 v9, 200, v9
  v_add_u32 v9, s32, v9
  v_mad_u32_u24 v16, v7, s45, v9
  s_add_u32 m0, s46, 0
  s_nop 0
  buffer_load_dwordx4 v16, s[8:11], s47 offen lds
  v_add_u32 v6, 64, v2
  v_mul_u32_u24 v7, 4682, v6
  v_lshrrev_b32 v7, 16, v7
  v_mul_u32_u24 v8, 14, v7
  v_sub_u32 v8, v6, v8
  v_lshlrev_b32 v9, 4, v8
  v_min_u32 v9, 200, v9
  v_add_u32 v9, s32, v9
  v_mad_u32_u24 v17, v7, s45, v9
  s_add_u32 m0, s46, 1024
  s_nop 0
  buffer_load_dwordx4 v17, s[8:11], s47 offen lds
  v_add_u32 v6, 128, v2
  v_mul_u32_u24 v7, 4682, v6
  v_lshrrev_b32 v7, 16, v7
  v_mul_u32_u24 v8, 14, v7
  v_sub_u32 v8, v6, v8
  v_lshlrev_b32 v9, 4, v8
  v_min_u32 v9, 200, v9
  v_add_u32 v9, s32, v9
  v_mad_u32_u24 v18, v7, s45, v9
  s_add_u32 m0, s46, 2048
  s_nop 0
  buffer_load_dwordx4 v18, s[8:11], s47 offen lds
  v_add_u32 v6, 192, v2
  v_mul_u32_u24 v7, 4682, v6
  v_lshrrev_b32 v7, 16, v7
  v_mul_u32_u24 v8, 14, v7
  v_sub_u32 v8, v6, v8
  v_lshlrev_b32 v9, 4, v8
  v_min_u32 v9, 200, v9
  v_add_u32 v9, s32, v9
  v_mad_u32_u24 v19, v7, s45, v9
  s_add_u32 m0, s46, 3072
  s_nop 0
  buffer_load_dwordx4 v19, s[8:11], s47 offen lds
  v_add_u32 v6, 256, v2
  v_mul_u32_u24 v7, 4682, v6
  v_lshrrev_b32 v7, 16, v7
  v_mul_u32_u24 v8, 14, v7
  v_sub_u32 v8, v6, v8
  v_lshlrev_b32 v9, 4, v8
  v_min_u32 v9, 200, v9
  v_add_u32 v9, s32, v9
  v_mad_u32_u24 v20, v7, s45, v9
  s_add_u32 m0, s46, 4096
  s_nop 0
  buffer_load_dwordx4 v20, s[8:11], s47 offen lds
  v_add_u32 v6, 320, v2
  v_mul_u32_u24 v7, 4682, v6
  v_lshrrev_b32 v7, 16, v7
  v_mul_u32_u24 v8, 14, v7
  v_sub_u32 v8, v6, v8
  v_lshlrev_b32 v9, 4, v8
  v_min_u32 v9, 200, v9
  v_add_u32 v9, s32, v9
  v_mad_u32_u24 v21, v7, s45, v9
  s_add_u32 m0, s46, 5120
  s_nop 0
  buffer_load_dwordx4 v21, s[8:11], s47 offen lds
  v_add_u32 v6, 384, v2
  v_mul_u32_u24 v7, 4682, v6
  v_lshrrev_b32 v7, 16, v7
  v_mul_u32_u24 v8, 14, v7
  v_sub_u32 v8, v6, v8
  v_lshlrev_b32 v9, 4, v8
  v_min_u32 v9, 200, v9
  v_add_u32 v9, s32, v9
  v_mad_u32_u24 v22, v7, s45, v9
  s_add_u32 m0, s46, 6144
  s_nop 0
  buffer_load_dwordx4 v22, s[8:11], s47 offen lds
  v_lshrrev_b32 v6, 2, v2
  v_mul_u32_u24 v6, 224, v6
  v_and_b32 v7, 3, v2
  v_lshl_add_u32 v6, v7, 3, v6
  v_add_u32 v6, s46, v6
  v_and_b32 v7, 3, v2
  v_cmp_eq_u32 vcc, 2, v7
  v_add_u32 v8, 8, v6
  s_nop 0
  v_cndmask_b32 v7, v6, v8, vcc
  v_cmp_gt_u32 s[34:35], 12, v4
  s_waitcnt vmcnt(0)
  ds_read_b64_tr_b16 v[32:33], v6 offset:0
  ds_read_b64_tr_b16 v[34:35], v6 offset:3584
  ds_read_b64_tr_b16 v[36:37], v6 offset:32
  ds_read_b64_tr_b16 v[38:39], v6 offset:3616
  ds_read_b64_tr_b16 v[40:41], v6 offset:64
  ds_read_b64_tr_b16 v[42:43], v6 offset:3648
  ds_read_b64_tr_b16 v[44:45], v6 offset:96
  ds_read_b64_tr_b16 v[46:47], v6 offset:3680
  ds_read_b64_tr_b16 v[48:49], v6 offset:128
  ds_read_b64_tr_b16 v[50:51], v6 offset:3712
  ds_read_b64_tr_b16 v[52:53], v6 offset:160
  ds_read_b64_tr_b16 v[54:55], v6 offset:3744
  ds_read_b64_tr_b16 v[56:57], v7 offset:192
  ds_read_b64_tr_b16 v[58:59], v7 offset:3776
  s_waitcnt lgkmcnt(12)
  buffer_store_dwordx4 v[32:35], v5, s[12:15], s24 offen offset:0
  s_waitcnt lgkmcnt(10)
  buffer_store_dwordx4 v[36:39], v5, s[12:15], s24 offen offset:1024
  s_waitcnt lgkmcnt(8)
  buffer_store_dwordx4 v[40:43], v5, s[12:15], s24 offen offset:2048
  s_waitcnt lgkmcnt(6)
  buffer_store_dwordx4 v[44:47], v5, s[12:15], s24 offen offset:3072
  s_waitcnt lgkmcnt(4)
  buffer_store_dwordx4 v[48:51], v5, s[12:15], s44 offen offset:0
  s_waitcnt lgkmcnt(2)
  buffer_store_dwordx4 v[52:55], v5, s[12:15], s44 offen offset:1024
  s_waitcnt lgkmcnt(0)
  v_cndmask_b32 v56, 0, v56, s[34:35]
  v_cndmask_b32 v57, 0, v57, s[34:35]
  v_cndmask_b32 v58, 0, v58, s[34:35]
  v_cndmask_b32 v59, 0, v59, s[34:35]
  buffer_store_dwordx4 v[56:59], v5, s[12:15], s44 offen offset:2048
  s_branch K0_END
K0_J34:
  s_load_dwordx2 s[6:7], s[0:1], 16
  s_sub_u32 s29, s2, 389
  s_and_b32 s30, s29, 1
  s_lshl_b32 s30, s30, 2
  s_add_u32 s30, s30, s3
  s_lshr_b32 s29, s29, 1
  s_mul_i32 s31, s29, 52
  s_lshr_b32 s31, s31, 8
  s_mul_i32 s32, s31, 5
  s_sub_u32 s32, s29, s32
  s_mul_i32 s33, s31, 160
  s_cmp_gt_u32 s32, 2
  s_cselect_b32 s34, 1, 0
  s_sub_u32 s34, s32, s34
  s_mul_i32 s34, s34, 40
  s_add_u32 s26, s33, s34
  s_add_u32 s35, s33, 16
  s_cmp_eq_u32 s32, 2
  s_cselect_b32 s26, s35, s26
  s_mov_b32 s27, 20
  s_cselect_b32 s36, 40, 4
  s_mov_b32 s37, 4
  s_mul_i32 s24, s30, 20
  s_add_u32 s24, s24, s29
  s_mul_i32 s24, s24, 5120
  s_waitcnt lgkmcnt(0)
  s_mov_b32 s8, s6
  s_mov_b32 s9, s7
  s_mov_b32 s10, 0xc8000
  s_mov_b32 s11, 0x00020000
  s_add_u32 s12, s4, 0x280000
  s_addc_u32 s13, s5, 0
  s_mov_b32 s14, 0xc8000
  s_mov_b32 s15, 0x00020000
K0_J34C:
  s_mul_i32 s47, s26, 1280
  s_mul_i32 s38, s30, 160
  s_mov_b32 s45, 1280
  v_add_u32 v6, 0, v2
  v_mul_u32_u24 v7, 6554, v6
  v_lshrrev_b32 v7, 16, v7
  v_mul_u32_u24 v8, 10, v7
  v_sub_u32 v8, v6, v8
  v_lshlrev_b32 v9, 4, v8
  v_add_u32 v9, s38, v9
  v_lshrrev_b32 v10, 4, v7
  v_mul_u32_u24 v10, s27, v10
  v_bfe_u32 v11, v7, 2, 2
  v_mad_u32_u24 v10, v11, s36, v10
  v_and_b32 v7, 3, v7
  v_add_u32 v7, v7, v10
  v_mad_u32_u24 v16, v7, s45, v9
  v_cmp_gt_u32 vcc, s37, v11
  s_nop 1
  v_cndmask_b32 v16, v15, v16, vcc
  s_add_u32 m0, s46, 0
  s_nop 0
  buffer_load_dwordx4 v16, s[8:11], s47 offen lds
  v_add_u32 v6, 64, v2
  v_mul_u32_u24 v7, 6554, v6
  v_lshrrev_b32 v7, 16, v7
  v_mul_u32_u24 v8, 10, v7
  v_sub_u32 v8, v6, v8
  v_lshlrev_b32 v9, 4, v8
  v_add_u32 v9, s38, v9
  v_lshrrev_b32 v10, 4, v7
  v_mul_u32_u24 v10, s27, v10
  v_bfe_u32 v11, v7, 2, 2
  v_mad_u32_u24 v10, v11, s36, v10
  v_and_b32 v7, 3, v7
  v_add_u32 v7, v7, v10
  v_mad_u32_u24 v17, v7, s45, v9
  v_cmp_gt_u32 vcc, s37, v11
  s_nop 1
  v_cndmask_b32 v17, v15, v17, vcc
  s_add_u32 m0, s46, 1024
  s_nop 0
  buffer_load_dwordx4 v17, s[8:11], s47 offen lds
  v_add_u32 v6, 128, v2
  v_mul_u32_u24 v7, 6554, v6
  v_lshrrev_b32 v7, 16, v7
  v_mul_u32_u24 v8, 10, v7
  v_sub_u32 v8, v6, v8
  v_lshlrev_b32 v9, 4, v8
  v_add_u32 v9, s38, v9
  v_lshrrev_b32 v10, 4, v7
  v_mul_u32_u24 v10, s27, v10
  v_bfe_u32 v11, v7, 2, 2
  v_mad_u32_u24 v10, v11, s36, v10
  v_and_b32 v7, 3, v7
  v_add_u32 v7, v7, v10
  v_mad_u32_u24 v18, v7, s45, v9
  v_cmp_gt_u32 vcc, s37, v11
  s_nop 1
  v_cndmask_b32 v18, v15, v18, vcc
  s_add_u32 m0, s46, 2048
  s_nop 0
  buffer_load_dwordx4 v18, s[8:11], s47 offen lds
  v_add_u32 v6, 192, v2
  v_mul_u32_u24 v7, 6554, v6
  v_lshrrev_b32 v7, 16, v7
  v_mul_u32_u24 v8, 10, v7
  v_sub_u32 v8, v6, v8
  v_lshlrev_b32 v9, 4, v8
  v_add_u32 v9, s38, v9
  v_lshrrev_b32 v10, 4, v7
  v_mul_u32_u24 v10, s27, v10
  v_bfe_u32 v11, v7, 2, 2
  v_mad_u32_u24 v10, v11, s36, v10
  v_and_b32 v7, 3, v7
  v_add_u32 v7, v7, v10
  v_mad_u32_u24 v19, v7, s45, v9
  v_cmp_gt_u32 vcc, s37, v11
  s_nop 1
  v_cndmask_b32 v19, v15, v19, vcc
  s_add_u32 m0, s46, 3072
  s_nop 0
  buffer_load_dwordx4 v19, s[8:11], s47 offen lds
  v_add_u32 v6, 256, v2
  v_mul_u32_u24 v7, 6554, v6
  v_lshrrev_b32 v7, 16, v7
  v_mul_u32_u24 v8, 10, v7
  v_sub_u32 v8, v6, v8
  v_lshlrev_b32 v9, 4, v8
  v_add_u32 v9, s38, v9
  v_lshrrev_b32 v10, 4, v7
  v_mul_u32_u24 v10, s27, v10
  v_bfe_u32 v11, v7, 2, 2
  v_mad_u32_u24 v10, v11, s36, v10
  v_and_b32 v7, 3, v7
  v_add_u32 v7, v7, v10
  v_mad_u32_u24 v20, v7, s45, v9
  v_cmp_gt_u32 vcc, s37, v11
  s_nop 1
  v_cndmask_b32 v20, v15, v20, vcc
  s_add_u32 m0, s46, 4096
  s_nop 0
  buffer_load_dwordx4 v20, s[8:11], s47 offen lds
  v_lshrrev_b32 v6, 2, v2
  v_mul_u32_u24 v6, 160, v6
  v_and_b32 v7, 3, v2
  v_lshl_add_u32 v6, v7, 3, v6
  v_add_u32 v6, s46, v6
  s_and_b32 s39, s30, 1
  s_cmp_eq_u32 s39, 1
  s_mov_b32 s39, 0
  s_cselect_b32 s39, 32, s39
  v_add_u32 v8, s39, v6
  s_mov_b32 s39, 32
  s_cselect_b32 s39, 64, s39
  v_add_u32 v9, s39, v6
  s_mov_b32 s39, 64
  s_cselect_b32 s39, 96, s39
  v_add_u32 v10, s39, v6
  s_mov_b32 s39, 96
  s_cselect_b32 s39, 128, s39
  v_add_u32 v11, s39, v6
  s_mov_b32 s39, 128
  s_cselect_b32 s39, 0, s39
  v_add_u32 v12, s39, v6
  s_add_u32 s44, s24, 4096
  v_cmp_gt_u32 s[34:35], s37, v3
  s_waitcnt vmcnt(0)
  ds_read_b64_tr_b16 v[32:33], v8 offset:0
  ds_read_b64_tr_b16 v[34:35], v8 offset:2560
  ds_read_b64_tr_b16 v[36:37], v9 offset:0
  ds_read_b64_tr_b16 v[38:39], v9 offset:2560
  ds_read_b64_tr_b16 v[40:41], v10 offset:0
  ds_read_b64_tr_b16 v[42:43], v10 offset:2560
  ds_read_b64_tr_b16 v[44:45], v11 offset:0
  ds_read_b64_tr_b16 v[46:47], v11 offset:2560
  ds_read_b64_tr_b16 v[48:49], v12 offset:0
  ds_read_b64_tr_b16 v[50:51], v12 offset:2560
  s_waitcnt lgkmcnt(8)
  v_cndmask_b32 v32, 0, v32, s[34:35]
  v_cndmask_b32 v33, 0, v33, s[34:35]
  v_cndmask_b32 v34, 0, v34, s[34:35]
  v_cndmask_b32 v35, 0, v35, s[34:35]
  buffer_store_dwordx4 v[32:35], v5, s[12:15], s24 offen offset:0
  s_waitcnt lgkmcnt(6)
  v_cndmask_b32 v36, 0, v36, s[34:35]
  v_cndmask_b32 v37, 0, v37, s[34:35]
  v_cndmask_b32 v38, 0, v38, s[34:35]
  v_cndmask_b32 v39, 0, v39, s[34:35]
  buffer_store_dwordx4 v[36:39], v5, s[12:15], s24 offen offset:1024
  s_waitcnt lgkmcnt(4)
  v_cndmask_b32 v40, 0, v40, s[34:35]
  v_cndmask_b32 v41, 0, v41, s[34:35]
  v_cndmask_b32 v42, 0, v42, s[34:35]
  v_cndmask_b32 v43, 0, v43, s[34:35]
  buffer_store_dwordx4 v[40:43], v5, s[12:15], s24 offen offset:2048
  s_waitcnt lgkmcnt(2)
  v_cndmask_b32 v44, 0, v44, s[34:35]
  v_cndmask_b32 v45, 0, v45, s[34:35]
  v_cndmask_b32 v46, 0, v46, s[34:35]
  v_cndmask_b32 v47, 0, v47, s[34:35]
  buffer_store_dwordx4 v[44:47], v5, s[12:15], s24 offen offset:3072
  s_waitcnt lgkmcnt(0)
  v_cndmask_b32 v48, 0, v48, s[34:35]
  v_cndmask_b32 v49, 0, v49, s[34:35]
  v_cndmask_b32 v50, 0, v50, s[34:35]
  v_cndmask_b32 v51, 0, v51, s[34:35]
  buffer_store_dwordx4 v[48:51], v5, s[12:15], s44 offen offset:0
  s_branch K0_END
K0_J5:
  s_load_dwordx2 s[6:7], s[0:1], 0
  s_sub_u32 s29, s2, 84
  s_mul_i32 s30, s29, 20480
  s_mul_i32 s31, s3, 320
  s_add_u32 s31, s31, s30
  s_mul_i32 s32, s3, 5120
  s_add_u32 s32, s32, s30
  s_add_u32 s34, s32, 4096
  v_mul_u32_u24 v6, 1280, v4
  v_lshl_add_u32 v6, v3, 3, v6
  v_lshlrev_b32 v7, 3, v2
  s_waitcnt lgkmcnt(0)
  s_mov_b32 s8, s6
  s_mov_b32 s9, s7
  s_mov_b32 s10, 0x280000
  s_mov_b32 s11, 0x00020000
  s_add_u32 s12, s4, 0x9de000
  s_addc_u32 s13, s5, 0
  s_mov_b32 s14, 0x280000
  s_mov_b32 s15, 0x00020000
  s_add_u32 s40, s4, 0x13de000
  s_addc_u32 s41, s5, 0
  s_mov_b32 s42, 0x20000
  s_mov_b32 s43, 0x00020000
  buffer_load_dwordx2 v[16:17], v6, s[8:11], s31 offen offset:0
  buffer_load_dwordx2 v[18:19], v6, s[8:11], s31 offen offset:32
  buffer_load_dwordx2 v[20:21], v6, s[8:11], s31 offen offset:64
  buffer_load_dwordx2 v[22:23], v6, s[8:11], s31 offen offset:96
  buffer_load_dwordx2 v[24:25], v6, s[8:11], s31 offen offset:128
  buffer_load_dwordx2 v[26:27], v6, s[8:11], s31 offen offset:160
  buffer_load_dwordx2 v[28:29], v6, s[8:11], s31 offen offset:192
  buffer_load_dwordx2 v[30:31], v6, s[8:11], s31 offen offset:224
  buffer_load_dwordx2 v[32:33], v6, s[8:11], s31 offen offset:256
  buffer_load_dwordx2 v[34:35], v6, s[8:11], s31 offen offset:288
  v_mov_b32 v8, 0
  v_mov_b32 v9, 0
  v_mov_b32 v10, 0
  v_mov_b32 v11, 0
  s_mov_b32 s33, 0x3f803f80
  v_lshlrev_b32 v12, 7, v3
  v_lshl_add_u32 v12, v4, 3, v12
  v_cmp_gt_u32 vcc, 2, v3
  s_nop 1
  v_cndmask_b32 v12, v15, v12, vcc
  s_lshl_b32 s35, s29, 10
  s_lshl_b32 s36, s3, 8
  s_add_u32 s35, s35, s36
  s_waitcnt vmcnt(8)
  buffer_store_dwordx4 v[16:19], v5, s[12:15], s32 offen offset:0
  v_dot2_f32_bf16 v8, v16, s33, v8
  v_dot2_f32_bf16 v10, v16, v16, v10
  v_dot2_f32_bf16 v9, v17, s33, v9
  v_dot2_f32_bf16 v11, v17, v17, v11
  v_dot2_f32_bf16 v8, v18, s33, v8
  v_dot2_f32_bf16 v10, v18, v18, v10
  v_dot2_f32_bf16 v9, v19, s33, v9
  v_dot2_f32_bf16 v11, v19, v19, v11
  s_waitcnt vmcnt(7)
  buffer_store_dwordx4 v[20:23], v5, s[12:15], s32 offen offset:1024
  v_dot2_f32_bf16 v8, v20, s33, v8
  v_dot2_f32_bf16 v10, v20, v20, v10
  v_dot2_f32_bf16 v9, v21, s33, v9
  v_dot2_f32_bf16 v11, v21, v21, v11
  v_dot2_f32_bf16 v8, v22, s33, v8
  v_dot2_f32_bf16 v10, v22, v22, v10
  v_dot2_f32_bf16 v9, v23, s33, v9
  v_dot2_f32_bf16 v11, v23, v23, v11
  s_waitcnt vmcnt(6)
  buffer_store_dwordx2 v[24:25], v7, s[12:15], s32 offen offset:2048
  buffer_store_dwordx2 v[26:27], v7, s[12:15], s32 offen offset:2560
  v_dot2_f32_bf16 v8, v24, s33, v8
  v_dot2_f32_bf16 v10, v24, v24, v10
  v_dot2_f32_bf16 v9, v25, s33, v9
  v_dot2_f32_bf16 v11, v25, v25, v11
  v_dot2_f32_bf16 v8, v26, s33, v8
  v_dot2_f32_bf16 v10, v26, v26, v10
  v_dot2_f32_bf16 v9, v27, s33, v9
  v_dot2_f32_bf16 v11, v27, v27, v11
  s_waitcnt vmcnt(6)
  buffer_store_dwordx4 v[28:31], v5, s[12:15], s32 offen offset:3072
  v_dot2_f32_bf16 v8, v28, s33, v8
  v_dot2_f32_bf16 v10, v28, v28, v10
  v_dot2_f32_bf16 v9, v29, s33, v9
  v_dot2_f32_bf16 v11, v29, v29, v11
  v_dot2_f32_bf16 v8, v30, s33, v8
  v_dot2_f32_bf16 v10, v30, v30, v10
  v_dot2_f32_bf16 v9, v31, s33, v9
  v_dot2_f32_bf16 v11, v31, v31, v11
  s_waitcnt vmcnt(5)
  buffer_store_dwordx4 v[32:35], v5, s[12:15], s34 offen
  v_dot2_f32_bf16 v8, v32, s33, v8
  v_dot2_f32_bf16 v10, v32, v32, v10
  v_dot2_f32_bf16 v9, v33, s33, v9
  v_dot2_f32_bf16 v11, v33, v33, v11
  v_dot2_f32_bf16 v8, v34, s33, v8
  v_dot2_f32_bf16 v10, v34, v34, v10
  v_dot2_f32_bf16 v9, v35, s33, v9
  v_dot2_f32_bf16 v11, v35, v35, v11
  s_nop 1
  v_add_f32 v8, v8, v9
  v_add_f32 v10, v10, v11
  v_mov_b32 v9, v8
  v_mov_b32 v11, v10
  s_nop 0
  v_permlane16_swap_b32 v8, v9
  v_permlane16_swap_b32 v10, v11
  v_add_f32 v8, v8, v9
  v_add_f32 v10, v10, v11
  v_mov_b32 v9, v8
  v_mov_b32 v11, v10
  s_nop 0
  v_permlane32_swap_b32 v8, v9
  v_permlane32_swap_b32 v10, v11
  v_add_f32 v8, v8, v9
  v_add_f32 v10, v10, v11
  v_cmp_eq_u32 vcc, 0, v3
  s_nop 1
  v_cndmask_b32 v8, 0, v8, vcc
  v_cndmask_b32 v9, 0, v10, vcc
  buffer_store_dwordx2 v[8:9], v12, s[40:43], s35 offen
  s_branch K0_END
K0_J6:
  s_cmp_ge_u32 s2, 30
  s_cbranch_scc1 K0_J6B
  s_sub_u32 s29, s2, 0
  s_load_dwordx2 s[6:7], s[0:1], 8
  s_mov_b32 s30, 3840
  s_waitcnt lgkmcnt(0)
  s_mov_b32 s8, s6
  s_mov_b32 s9, s7
  s_mov_b32 s10, 0x258000
  s_mov_b32 s11, 0x00020000
  s_add_u32 s12, s4, 0x9d8000
  s_addc_u32 s13, s5, 0
  s_mov_b32 s14, 0x1e00
  s_mov_b32 s15, 0x00020000
  s_branch K0_J6C
K0_J6B:
  s_sub_u32 s29, s2, 30
  s_cmp_ge_u32 s29, 27
  s_cbranch_scc1 K0_J6U
  s_load_dwordx2 s[6:7], s[0:1], 32
  s_waitcnt lgkmcnt(0)
  s_add_u32 s12, s4, 0x9da000
  s_addc_u32 s13, s5, 0
  s_mov_b32 s14, 0x1b00
  s_mov_b32 s15, 0x00020000
  s_branch K0_J6D
K0_J6U:
  s_load_dwordx2 s[6:7], s[0:1], 40
  s_sub_u32 s29, s29, 27
  s_waitcnt lgkmcnt(0)
  s_add_u32 s12, s4, 0x9dc000
  s_addc_u32 s13, s5, 0
  s_mov_b32 s14, 0x1b00
  s_mov_b32 s15, 0x00020000
K0_J6D:
  s_mov_b32 s30, 3456
  s_mov_b32 s8, s6
  s_mov_b32 s9, s7
  s_mov_b32 s10, 0x21c000
  s_mov_b32 s11, 0x00020000
K0_J6C:
  v_lshrrev_b32 v6, 3, v2
  v_mul_lo_u32 v6, v6, s30
  v_and_b32 v7, 7, v2
  v_lshl_add_u32 v6, v7, 4, v6
  s_lshl_b32 s31, s29, 7
  v_add_u32 v6, s31, v6
  s_mul_i32 s32, s3, 160
  s_mul_i32 s32, s32, s30
  s_lshl_b32 s33, s30, 3
  buffer_load_dwordx4 v[24:27], v6, s[8:11], s32 offen
  s_add_u32 s32, s32, s33
  buffer_load_dwordx4 v[28:31], v6, s[8:11], s32 offen
  s_add_u32 s32, s32, s33
  buffer_load_dwordx4 v[32:35], v6, s[8:11], s32 offen
  s_add_u32 s32, s32, s33
  buffer_load_dwordx4 v[36:39], v6, s[8:11], s32 offen
  s_add_u32 s32, s32, s33
  buffer_load_dwordx4 v[40:43], v6, s[8:11], s32 offen
  s_add_u32 s32, s32, s33
  buffer_load_dwordx4 v[44:47], v6, s[8:11], s32 offen
  s_add_u32 s32, s32, s33
  buffer_load_dwordx4 v[48:51], v6, s[8:11], s32 offen
  s_add_u32 s32, s32, s33
  buffer_load_dwordx4 v[52:55], v6, s[8:11], s32 offen
  s_add_u32 s32, s32, s33
  buffer_load_dwordx4 v[56:59], v6, s[8:11], s32 offen
  s_add_u32 s32, s32, s33
  buffer_load_dwordx4 v[60:63], v6, s[8:11], s32 offen
  s_add_u32 s32, s32, s33
  buffer_load_dwordx4 v[64:67], v6, s[8:11], s32 offen
  s_add_u32 s32, s32, s33
  buffer_load_dwordx4 v[68:71], v6, s[8:11], s32 offen
  s_add_u32 s32, s32, s33
  buffer_load_dwordx4 v[72:75], v6, s[8:11], s32 offen
  s_add_u32 s32, s32, s33
  buffer_load_dwordx4 v[76:79], v6, s[8:11], s32 offen
  s_add_u32 s32, s32, s33
  buffer_load_dwordx4 v[80:83], v6, s[8:11], s32 offen
  s_add_u32 s32, s32, s33
  buffer_load_dwordx4 v[84:87], v6, s[8:11], s32 offen
  s_add_u32 s32, s32, s33
  buffer_load_dwordx4 v[88:91], v6, s[8:11], s32 offen
  s_add_u32 s32, s32, s33
  buffer_load_dwordx4 v[92:95], v6, s[8:11], s32 offen
  s_add_u32 s32, s32, s33
  buffer_load_dwordx4 v[96:99], v6, s[8:11], s32 offen
  s_add_u32 s32, s32, s33
  buffer_load_dwordx4 v[100:103], v6, s[8:11], s32 offen
  s_add_u32 s32, s32, s33
  v_mov_b32 v8, 0
  v_mov_b32 v9, 0
  v_mov_b32 v10, 0
  v_mov_b32 v11, 0
  v_mov_b32 v12, 0
  v_mov_b32 v13, 0
  v_mov_b32 v14, 0
  v_mov_b32 v15, 0
  s_mov_b32 s34, 0x00003f80
  s_mov_b32 s35, 0x3f800000
  s_waitcnt vmcnt(19)
  v_dot2_f32_bf16 v8, v24, s34, v8
  v_dot2_f32_bf16 v9, v24, s35, v9
  v_dot2_f32_bf16 v10, v25, s34, v10
  v_dot2_f32_bf16 v11, v25, s35, v11
  v_dot2_f32_bf16 v12, v26, s34, v12
  v_dot2_f32_bf16 v13, v26, s35, v13
  v_dot2_f32_bf16 v14, v27, s34, v14
  v_dot2_f32_bf16 v15, v27, s35, v15
  s_waitcnt vmcnt(18)
  v_dot2_f32_bf16 v8, v28, s34, v8
  v_dot2_f32_bf16 v9, v28, s35, v9
  v_dot2_f32_bf16 v10, v29, s34, v10
  v_dot2_f32_bf16 v11, v29, s35, v11
  v_dot2_f32_bf16 v12, v30, s34, v12
  v_dot2_f32_bf16 v13, v30, s35, v13
  v_dot2_f32_bf16 v14, v31, s34, v14
  v_dot2_f32_bf16 v15, v31, s35, v15
  s_waitcnt vmcnt(17)
  v_dot2_f32_bf16 v8, v32, s34, v8
  v_dot2_f32_bf16 v9, v32, s35, v9
  v_dot2_f32_bf16 v10, v33, s34, v10
  v_dot2_f32_bf16 v11, v33, s35, v11
  v_dot2_f32_bf16 v12, v34, s34, v12
  v_dot2_f32_bf16 v13, v34, s35, v13
  v_dot2_f32_bf16 v14, v35, s34, v14
  v_dot2_f32_bf16 v15, v35, s35, v15
  s_waitcnt vmcnt(16)
  v_dot2_f32_bf16 v8, v36, s34, v8
  v_dot2_f32_bf16 v9, v36, s35, v9
  v_dot2_f32_bf16 v10, v37, s34, v10
  v_dot2_f32_bf16 v11, v37, s35, v11
  v_dot2_f32_bf16 v12, v38, s34, v12
  v_dot2_f32_bf16 v13, v38, s35, v13
  v_dot2_f32_bf16 v14, v39, s34, v14
  v_dot2_f32_bf16 v15, v39, s35, v15
  s_waitcnt vmcnt(15)
  v_dot2_f32_bf16 v8, v40, s34, v8
  v_dot2_f32_bf16 v9, v40, s35, v9
  v_dot2_f32_bf16 v10, v41, s34, v10
  v_dot2_f32_bf16 v11, v41, s35, v11
  v_dot2_f32_bf16 v12, v42, s34, v12
  v_dot2_f32_bf16 v13, v42, s35, v13
  v_dot2_f32_bf16 v14, v43, s34, v14
  v_dot2_f32_bf16 v15, v43, s35, v15
  s_waitcnt vmcnt(14)
  v_dot2_f32_bf16 v8, v44, s34, v8
  v_dot2_f32_bf16 v9, v44, s35, v9
  v_dot2_f32_bf16 v10, v45, s34, v10
  v_dot2_f32_bf16 v11, v45, s35, v11
  v_dot2_f32_bf16 v12, v46, s34, v12
  v_dot2_f32_bf16 v13, v46, s35, v13
  v_dot2_f32_bf16 v14, v47, s34, v14
  v_dot2_f32_bf16 v15, v47, s35, v15
  s_waitcnt vmcnt(13)
  v_dot2_f32_bf16 v8, v48, s34, v8
  v_dot2_f32_bf16 v9, v48, s35, v9
  v_dot2_f32_bf16 v10, v49, s34, v10
  v_dot2_f32_bf16 v11, v49, s35, v11
  v_dot2_f32_bf16 v12, v50, s34, v12
  v_dot2_f32_bf16 v13, v50, s35, v13
  v_dot2_f32_bf16 v14, v51, s34, v14
  v_dot2_f32_bf16 v15, v51, s35, v15
  s_waitcnt vmcnt(12)
  v_dot2_f32_bf16 v8, v52, s34, v8
  v_dot2_f32_bf16 v9, v52, s35, v9
  v_dot2_f32_bf16 v10, v53, s34, v10
  v_dot2_f32_bf16 v11, v53, s35, v11
  v_dot2_f32_bf16 v12, v54, s34, v12
  v_dot2_f32_bf16 v13, v54, s35, v13
  v_dot2_f32_bf16 v14, v55, s34, v14
  v_dot2_f32_bf16 v15, v55, s35, v15
  s_waitcnt vmcnt(11)
  v_dot2_f32_bf16 v8, v56, s34, v8
  v_dot2_f32_bf16 v9, v56, s35, v9
  v_dot2_f32_bf16 v10, v57, s34, v10
  v_dot2_f32_bf16 v11, v57, s35, v11
  v_dot2_f32_bf16 v12, v58, s34, v12
  v_dot2_f32_bf16 v13, v58, s35, v13
  v_dot2_f32_bf16 v14, v59, s34, v14
  v_dot2_f32_bf16 v15, v59, s35, v15
  s_waitcnt vmcnt(10)
  v_dot2_f32_bf16 v8, v60, s34, v8
  v_dot2_f32_bf16 v9, v60, s35, v9
  v_dot2_f32_bf16 v10, v61, s34, v10
  v_dot2_f32_bf16 v11, v61, s35, v11
  v_dot2_f32_bf16 v12, v62, s34, v12
  v_dot2_f32_bf16 v13, v62, s35, v13
  v_dot2_f32_bf16 v14, v63, s34, v14
  v_dot2_f32_bf16 v15, v63, s35, v15
  s_waitcnt vmcnt(9)
  v_dot2_f32_bf16 v8, v64, s34, v8
  v_dot2_f32_bf16 v9, v64, s35, v9
  v_dot2_f32_bf16 v10, v65, s34, v10
  v_dot2_f32_bf16 v11, v65, s35, v11
  v_dot2_f32_bf16 v12, v66, s34, v12
  v_dot2_f32_bf16 v13, v66, s35, v13
  v_dot2_f32_bf16 v14, v67, s34, v14
  v_dot2_f32_bf16 v15, v67, s35, v15
  s_waitcnt vmcnt(8)
  v_dot2_f32_bf16 v8, v68, s34, v8
  v_dot2_f32_bf16 v9, v68, s35, v9
  v_dot2_f32_bf16 v10, v69, s34, v10
  v_dot2_f32_bf16 v11, v69, s35, v11
  v_dot2_f32_bf16 v12, v70, s34, v12
  v_dot2_f32_bf16 v13, v70, s35, v13
  v_dot2_f32_bf16 v14, v71, s34, v14
  v_dot2_f32_bf16 v15, v71, s35, v15
  s_waitcnt vmcnt(7)
  v_dot2_f32_bf16 v8, v72, s34, v8
  v_dot2_f32_bf16 v9, v72, s35, v9
  v_dot2_f32_bf16 v10, v73, s34, v10
  v_dot2_f32_bf16 v11, v73, s35, v11
  v_dot2_f32_bf16 v12, v74, s34, v12
  v_dot2_f32_bf16 v13, v74, s35, v13
  v_dot2_f32_bf16 v14, v75, s34, v14
  v_dot2_f32_bf16 v15, v75, s35, v15
  s_waitcnt vmcnt(6)
  v_dot2_f32_bf16 v8, v76, s34, v8
  v_dot2_f32_bf16 v9, v76, s35, v9
  v_dot2_f32_bf16 v10, v77, s34, v10
  v_dot2_f32_bf16 v11, v77, s35, v11
  v_dot2_f32_bf16 v12, v78, s34, v12
  v_dot2_f32_bf16 v13, v78, s35, v13
  v_dot2_f32_bf16 v14, v79, s34, v14
  v_dot2_f32_bf16 v15, v79, s35, v15
  s_waitcnt vmcnt(5)
  v_dot2_f32_bf16 v8, v80, s34, v8
  v_dot2_f32_bf16 v9, v80, s35, v9
  v_dot2_f32_bf16 v10, v81, s34, v10
  v_dot2_f32_bf16 v11, v81, s35, v11
  v_dot2_f32_bf16 v12, v82, s34, v12
  v_dot2_f32_bf16 v13, v82, s35, v13
  v_dot2_f32_bf16 v14, v83, s34, v14
  v_dot2_f32_bf16 v15, v83, s35, v15
  s_waitcnt vmcnt(4)
  v_dot2_f32_bf16 v8, v84, s34, v8
  v_dot2_f32_bf16 v9, v84, s35, v9
  v_dot2_f32_bf16 v10, v85, s34, v10
  v_dot2_f32_bf16 v11, v85, s35, v11
  v_dot2_f32_bf16 v12, v86, s34, v12
  v_dot2_f32_bf16 v13, v86, s35, v13
  v_dot2_f32_bf16 v14, v87, s34, v14
  v_dot2_f32_bf16 v15, v87, s35, v15
  s_waitcnt vmcnt(3)
  v_dot2_f32_bf16 v8, v88, s34, v8
  v_dot2_f32_bf16 v9, v88, s35, v9
  v_dot2_f32_bf16 v10, v89, s34, v10
  v_dot2_f32_bf16 v11, v89, s35, v11
  v_dot2_f32_bf16 v12, v90, s34, v12
  v_dot2_f32_bf16 v13, v90, s35, v13
  v_dot2_f32_bf16 v14, v91, s34, v14
  v_dot2_f32_bf16 v15, v91, s35, v15
  s_waitcnt vmcnt(2)
  v_dot2_f32_bf16 v8, v92, s34, v8
  v_dot2_f32_bf16 v9, v92, s35, v9
  v_dot2_f32_bf16 v10, v93, s34, v10
  v_dot2_f32_bf16 v11, v93, s35, v11
  v_dot2_f32_bf16 v12, v94, s34, v12
  v_dot2_f32_bf16 v13, v94, s35, v13
  v_dot2_f32_bf16 v14, v95, s34, v14
  v_dot2_f32_bf16 v15, v95, s35, v15
  s_waitcnt vmcnt(1)
  v_dot2_f32_bf16 v8, v96, s34, v8
  v_dot2_f32_bf16 v9, v96, s35, v9
  v_dot2_f32_bf16 v10, v97, s34, v10
  v_dot2_f32_bf16 v11, v97, s35, v11
  v_dot2_f32_bf16 v12, v98, s34, v12
  v_dot2_f32_bf16 v13, v98, s35, v13
  v_dot2_f32_bf16 v14, v99, s34, v14
  v_dot2_f32_bf16 v15, v99, s35, v15
  s_waitcnt vmcnt(0)
  v_dot2_f32_bf16 v8, v100, s34, v8
  v_dot2_f32_bf16 v9, v100, s35, v9
  v_dot2_f32_bf16 v10, v101, s34, v10
  v_dot2_f32_bf16 v11, v101, s35, v11
  v_dot2_f32_bf16 v12, v102, s34, v12
  v_dot2_f32_bf16 v13, v102, s35, v13
  v_dot2_f32_bf16 v14, v103, s34, v14
  v_dot2_f32_bf16 v15, v103, s35, v15
  v_add_f32_dpp v8, v8, v8 row_ror:8 row_mask:0xf bank_mask:0xf
  v_add_f32_dpp v9, v9, v9 row_ror:8 row_mask:0xf bank_mask:0xf
  v_add_f32_dpp v10, v10, v10 row_ror:8 row_mask:0xf bank_mask:0xf
  v_add_f32_dpp v11, v11, v11 row_ror:8 row_mask:0xf bank_mask:0xf
  v_add_f32_dpp v12, v12, v12 row_ror:8 row_mask:0xf bank_mask:0xf
  v_add_f32_dpp v13, v13, v13 row_ror:8 row_mask:0xf bank_mask:0xf
  v_add_f32_dpp v14, v14, v14 row_ror:8 row_mask:0xf bank_mask:0xf
  v_add_f32_dpp v15, v15, v15 row_ror:8 row_mask:0xf bank_mask:0xf
  v_mov_b32 v16, v8
  v_mov_b32 v17, v9
  v_mov_b32 v18, v10
  v_mov_b32 v19, v11
  v_mov_b32 v20, v12
  v_mov_b32 v21, v13
  v_mov_b32 v22, v14
  v_mov_b32 v23, v15
  v_permlane16_swap_b32 v8, v16
  v_permlane16_swap_b32 v9, v17
  v_permlane16_swap_b32 v10, v18
  v_permlane16_swap_b32 v11, v19
  v_permlane16_swap_b32 v12, v20
  v_permlane16_swap_b32 v13, v21
  v_permlane16_swap_b32 v14, v22
  v_permlane16_swap_b32 v15, v23
  v_add_f32 v8, v8, v16
  v_add_f32 v9, v9, v17
  v_add_f32 v10, v10, v18
  v_add_f32 v11, v11, v19
  v_add_f32 v12, v12, v20
  v_add_f32 v13, v13, v21
  v_add_f32 v14, v14, v22
  v_add_f32 v15, v15, v23
  v_mov_b32 v16, v8
  v_mov_b32 v17, v9
  v_mov_b32 v18, v10
  v_mov_b32 v19, v11
  v_mov_b32 v20, v12
  v_mov_b32 v21, v13
  v_mov_b32 v22, v14
  v_mov_b32 v23, v15
  v_permlane32_swap_b32 v8, v16
  v_permlane32_swap_b32 v9, v17
  v_permlane32_swap_b32 v10, v18
  v_permlane32_swap_b32 v11, v19
  v_permlane32_swap_b32 v12, v20
  v_permlane32_swap_b32 v13, v21
  v_permlane32_swap_b32 v14, v22
  v_permlane32_swap_b32 v15, v23
  v_add_f32 v8, v8, v16
  v_add_f32 v9, v9, v17
  v_add_f32 v10, v10, v18
  v_add_f32 v11, v11, v19
  v_add_f32 v12, v12, v20
  v_add_f32 v13, v13, v21
  v_add_f32 v14, v14, v22
  v_add_f32 v15, v15, v23
  s_lshl_b32 s36, s3, 8
  v_lshlrev_b32 v16, 5, v7
  v_add_u32 v16, s36, v16
  ds_write_b128 v16, v[8:11]
  ds_write_b128 v16, v[12:15] offset:16
  s_waitcnt lgkmcnt(0)
  s_barrier
  v_lshlrev_b32 v17, 2, v2
  ds_read_b32 v18, v17
  ds_read_b32 v19, v17 offset:256
  ds_read_b32 v20, v17 offset:512
  ds_read_b32 v21, v17 offset:768
  s_waitcnt lgkmcnt(0)
  v_add_f32 v18, v18, v19
  v_add_f32 v20, v20, v21
  v_add_f32 v18, v18, v20
  s_lshl_b32 s31, s29, 8
  buffer_store_dword v18, v17, s[12:15], s31 offen
  s_branch K0_END
K0_J7:
  s_sub_u32 s29, s2, 212
  s_lshl_b32 s29, s29, 2
  s_add_u32 s29, s29, s3
  s_lshl_b32 s29, s29, 12
  s_waitcnt lgkmcnt(0)
  s_add_u32 s12, s4, 0x195e000
  s_addc_u32 s13, s5, 0
  s_mov_b32 s14, 0x24000
  s_mov_b32 s15, 0x00020000
  v_mov_b32 v8, 0
  v_mov_b32 v9, 0
  v_mov_b32 v10, 0
  v_mov_b32 v11, 0
  buffer_store_dwordx4 v[8:11], v5, s[12:15], s29 offen offset:0
  buffer_store_dwordx4 v[8:11], v5, s[12:15], s29 offen offset:1024
  buffer_store_dwordx4 v[8:11], v5, s[12:15], s29 offen offset:2048
  buffer_store_dwordx4 v[8:11], v5, s[12:15], s29 offen offset:3072
K0_END:
  s_endpgm

.globl main_kernel
.p2align 8
.type main_kernel,@function
main_kernel:
  s_cmp_ge_u32 s2, 256
  s_cbranch_scc1 MAIN_END
  s_load_dwordx2 s[10:11], s[0:1], 72
  s_load_dwordx2 s[36:37], s[0:1], 56
  s_and_b32 s24, s2, 7
  s_lshr_b32 s25, s2, 3
  s_lshr_b32 s26, s24, 1
  s_and_b32 s24, s24, 1
  s_lshl_b32 s4, s26, 2
  s_lshr_b32 s27, s25, 3
  s_add_u32 s4, s4, s27
  s_lshl_b32 s5, s24, 3
  s_and_b32 s27, s25, 7
  s_add_u32 s5, s5, s27
  s_lshl_b32 s6, s26, 3
  s_lshr_b32 s27, s25, 2
  s_add_u32 s6, s6, s27
  s_lshl_b32 s7, s24, 2
  s_and_b32 s27, s25, 3
  s_add_u32 s7, s7, s27
  v_lshrrev_b32 v1, 6, v0
  v_and_b32 v2, 63, v0
  v_readfirstlane_b32 s3, v1
  v_lshrrev_b32 v3, 4, v2
  v_and_b32 v4, 15, v2
  v_lshlrev_b32 v5, 4, v2
  v_lshlrev_b32 v6, 3, v2
  v_add_u32 v7, 0x10000, v5
  v_add_u32 v8, 0x20000, v5
  v_add_u32 v9, 4096, v5
  v_lshlrev_b32 v29, 2, v4
  v_mov_b32 v28, 0x40000000
  v_cmp_eq_u32 vcc, 0, v2
  s_nop 1
  v_cndmask_b32 v28, v28, v2, vcc
  s_lshl_b32 s20, s4, 3
  s_lshl_b32 s27, s3, 1
  s_add_u32 s20, s20, s27
  s_lshl_b32 s21, s6, 2
  s_add_u32 s21, s21, s3
  s_mov_b32 s9, 0
  s_mov_b32 s22, 1
  s_mov_b32 s23, 0
  s_mul_i32 s51, s3, 7168
  s_mul_i32 s52, s5, 0x46000
  s_add_u32 s52, s52, s51
  s_add_u32 s52, s52, 0x348000
  s_waitcnt lgkmcnt(0)
  s_mov_b32 s12, s10
  s_mov_b32 s13, s11
  s_mov_b32 s14, 0x2802000
  s_mov_b32 s15, 0x00020000
  s_mov_b32 s16, s36
  s_mov_b32 s17, s37
  s_mov_b32 s18, 0x280000
  s_mov_b32 s19, 0x00020000
  s_mov_b32 s60, s10
  s_mov_b32 s61, s11
  s_mov_b32 s62, 0x2802000
  s_mov_b32 s63, 0x00020000
  s_mul_i32 s54, s3, 25600
  s_mul_i32 s55, s5, 0x28000
  s_add_u32 s55, s55, s54
  s_add_u32 m0, s54, 0
  s_add_u32 s53, s55, 0x0
  buffer_load_dwordx4 v5, s[12:15], s53 offen offset:0 lds
  buffer_load_dwordx4 v5, s[12:15], s53 offen offset:1024 lds
  buffer_load_dwordx4 v5, s[12:15], s53 offen offset:2048 lds
  buffer_load_dwordx4 v5, s[12:15], s53 offen offset:3072 lds
  s_add_u32 m0, s54, 4096
  s_add_u32 s53, s55, 0x1000
  buffer_load_dwordx4 v5, s[12:15], s53 offen offset:0 lds
  buffer_load_dwordx4 v5, s[12:15], s53 offen offset:1024 lds
  buffer_load_dwordx4 v5, s[12:15], s53 offen offset:2048 lds
  buffer_load_dwordx4 v5, s[12:15], s53 offen offset:3072 lds
  s_add_u32 m0, s54, 8192
  s_add_u32 s53, s55, 0x2000
  buffer_load_dwordx4 v5, s[12:15], s53 offen offset:0 lds
  buffer_load_dwordx4 v5, s[12:15], s53 offen offset:1024 lds
  buffer_load_dwordx4 v5, s[12:15], s53 offen offset:2048 lds
  buffer_load_dwordx4 v5, s[12:15], s53 offen offset:3072 lds
  s_add_u32 m0, s54, 12288
  s_add_u32 s53, s55, 0x3000
  buffer_load_dwordx4 v5, s[12:15], s53 offen offset:0 lds
  buffer_load_dwordx4 v5, s[12:15], s53 offen offset:1024 lds
  buffer_load_dwordx4 v5, s[12:15], s53 offen offset:2048 lds
  buffer_load_dwordx4 v5, s[12:15], s53 offen offset:3072 lds
  s_add_u32 m0, s54, 16384
  s_add_u32 s53, s55, 0x4000
  buffer_load_dwordx4 v5, s[12:15], s53 offen offset:0 lds
  buffer_load_dwordx4 v5, s[12:15], s53 offen offset:1024 lds
  buffer_load_dwordx4 v5, s[12:15], s53 offen offset:2048 lds
  buffer_load_dwordx4 v5, s[12:15], s53 offen offset:3072 lds
  s_add_u32 m0, s54, 20480
  s_add_u32 s53, s55, 0x5000
  buffer_load_dwordx4 v5, s[12:15], s53 offen offset:0 lds
  buffer_load_dwordx4 v5, s[12:15], s53 offen offset:1024 lds
  buffer_load_dwordx4 v5, s[12:15], s53 offen offset:2048 lds
  buffer_load_dwordx4 v5, s[12:15], s53 offen offset:3072 lds
  s_add_u32 m0, s54, 24576
  s_add_u32 s53, s55, 0x6000
  buffer_load_dwordx4 v5, s[12:15], s53 offen offset:0 lds
  s_mul_i32 s77, s5, 0x100
  s_add_u32 s77, s77, 0x197a000
  s_mov_b32 s76, s77
  s_mul_i32 s8, s4, 0x4
  s_add_u32 s76, s76, s8
  s_mul_i32 s79, s4, 0x100
  s_add_u32 s79, s79, 0x197b000
  s_mov_b32 s78, s79
  s_mul_i32 s8, s5, 0x4
  s_add_u32 s78, s78, s8
  s_mul_i32 s48, s7, 0x46000
  s_mul_i32 s8, s3, 0x11800
  s_add_u32 s48, s48, s8
  s_add_u32 s48, s48, 0x7a8000
  s_mul_i32 s49, s7, 0x19000
  s_mul_i32 s8, s3, 0x6400
  s_add_u32 s49, s49, s8
  s_add_u32 s49, s49, 0x280000
  s_mul_i32 s66, s21, 0x5000
  s_and_b32 s46, s7, 1
  s_mul_i32 s47, s7, 5
  s_lshr_b32 s47, s47, 1
  s_lshl_b32 s47, s47, 10
  s_add_u32 s66, s66, s47
  s_cmp_eq_u32 s46, 1
  s_mov_b32 s47, 2048
  s_cselect_b32 s47, 512, s47
  s_add_u32 s67, s66, s47
  s_cmp_eq_u32 s46, 1
  s_cselect_b32 s47, 1024, 0
  s_add_u32 s66, s66, s47
  s_mul_i32 s45, s9, 0x500000
  s_add_u32 s45, s45, 0x9de000
  s_add_u32 s44, s45, s66
  s_add_u32 s45, s45, s67
  buffer_load_dwordx4 v[16:19], v5, s[12:15], s44 offen
  buffer_load_dwordx4 v[20:23], v5, s[12:15], s44 offen offset:1024
  buffer_load_dwordx2 v[24:25], v6, s[12:15], s45 offen
  s_mul_i32 s24, s9, 0x500000
  s_mul_i32 s8, s20, 0x5000
  s_add_u32 s24, s24, s8
  s_add_u32 s24, s24, 0x9de000
  s_add_u32 s25, s24, 20480
  s_add_u32 s35, s3, 1
  s_and_b32 s35, s35, 3
  s_lshl_b32 s8, s6, 2
  s_add_u32 s35, s35, s8
  s_mul_i32 s36, s35, 0x5000
  s_mul_i32 s8, s3, 0x1400
  s_add_u32 s36, s36, s8
  s_add_u32 s36, s36, 0x145e000
  s_add_u32 s35, s3, 2
  s_and_b32 s35, s35, 3
  s_lshl_b32 s8, s6, 2
  s_add_u32 s35, s35, s8
  s_mul_i32 s37, s35, 0x5000
  s_mul_i32 s8, s3, 0x1400
  s_add_u32 s37, s37, s8
  s_add_u32 s37, s37, 0x145e000
  s_add_u32 s35, s3, 3
  s_and_b32 s35, s35, 3
  s_lshl_b32 s8, s6, 2
  s_add_u32 s35, s35, s8
  s_mul_i32 s38, s35, 0x5000
  s_mul_i32 s8, s3, 0x1400
  s_add_u32 s38, s38, s8
  s_add_u32 s38, s38, 0x145e000
  s_add_u32 s35, s3, 4
  s_and_b32 s35, s35, 3
  s_lshl_b32 s8, s6, 2
  s_add_u32 s35, s35, s8
  s_mul_i32 s39, s35, 0x5000
  s_mul_i32 s8, s3, 0x1400
  s_add_u32 s39, s39, s8
  s_add_u32 s39, s39, 0x145e000
  s_add_u32 s35, s3, 1
  s_and_b32 s35, s35, 3
  s_lshl_b32 s8, s6, 2
  s_add_u32 s35, s35, s8
  s_mul_i32 s82, s35, 0xe000
  s_mul_i32 s8, s3, 0x3800
  s_add_u32 s82, s82, s8
  s_add_u32 s82, s82, 0x1982000
  s_add_u32 s83, s82, 4096
  s_add_u32 s84, s82, 8192
  s_add_u32 s85, s82, 12288
  s_add_u32 s35, s3, 2
  s_and_b32 s35, s35, 3
  s_lshl_b32 s8, s6, 2
  s_add_u32 s35, s35, s8
  s_mul_i32 s86, s35, 0xe000
  s_mul_i32 s8, s3, 0x3800
  s_add_u32 s86, s86, s8
  s_add_u32 s86, s86, 0x1982000
  s_add_u32 s87, s86, 4096
  s_add_u32 s88, s86, 8192
  s_add_u32 s89, s86, 12288
  s_add_u32 s35, s3, 3
  s_and_b32 s35, s35, 3
  s_lshl_b32 s8, s6, 2
  s_add_u32 s35, s35, s8
  s_mul_i32 s90, s35, 0xe000
  s_mul_i32 s8, s3, 0x3800
  s_add_u32 s90, s90, s8
  s_add_u32 s90, s90, 0x1982000
  s_add_u32 s91, s90, 4096
  s_add_u32 s92, s90, 8192
  s_add_u32 s93, s90, 12288
  s_add_u32 s35, s3, 4
  s_and_b32 s35, s35, 3
  s_lshl_b32 s8, s6, 2
  s_add_u32 s35, s35, s8
  s_mul_i32 s94, s35, 0xe000
  s_mul_i32 s8, s3, 0x3800
  s_add_u32 s94, s94, s8
  s_add_u32 s94, s94, 0x1982000
  s_add_u32 s95, s94, 4096
  s_add_u32 s96, s94, 8192
  s_add_u32 s97, s94, 12288
  s_add_u32 s40, s3, 1
  s_and_b32 s40, s40, 3
  s_mul_i32 s40, s40, 15360
  s_add_u32 s40, s40, 102400
  s_add_u32 s41, s3, 2
  s_and_b32 s41, s41, 3
  s_mul_i32 s41, s41, 15360
  s_add_u32 s41, s41, 107520
  s_add_u32 s42, s3, 3
  s_and_b32 s42, s42, 3
  s_mul_i32 s42, s42, 15360
  s_add_u32 s42, s42, 112640
  s_mul_i32 s43, s3, 15360
  s_add_u32 s43, s43, 102400
LOOP:
  buffer_load_dwordx4 a[0:3], v5, s[12:15], s24 offen offset:0 sc1
  buffer_load_dwordx4 a[4:7], v5, s[12:15], s25 offen offset:0 sc1
  buffer_load_dwordx4 a[8:11], v5, s[12:15], s24 offen offset:1024 sc1
  buffer_load_dwordx4 a[12:15], v5, s[12:15], s25 offen offset:1024 sc1
  buffer_load_dwordx2 a[16:17], v6, s[12:15], s24 offen offset:2048 sc1
  buffer_load_dwordx2 a[18:19], v6, s[12:15], s24 offen offset:2560 sc1
  buffer_load_dwordx2 a[20:21], v6, s[12:15], s25 offen offset:2048 sc1
  buffer_load_dwordx2 a[22:23], v6, s[12:15], s25 offen offset:2560 sc1
  buffer_load_dwordx4 a[24:27], v5, s[12:15], s24 offen offset:3072 sc1
  buffer_load_dwordx4 a[28:31], v5, s[12:15], s25 offen offset:3072 sc1
  s_add_u32 s24, s24, 4096
  buffer_load_dwordx4 a[32:35], v5, s[12:15], s24 offen offset:0 sc1
  s_add_u32 s25, s25, 4096
  buffer_load_dwordx4 a[36:39], v5, s[12:15], s25 offen offset:0 sc1
  buffer_load_dwordx4 a[40:43], v5, s[12:15], s24 offen offset:1024 sc1
  buffer_load_dwordx4 a[44:47], v5, s[12:15], s25 offen offset:1024 sc1
  buffer_load_dwordx4 a[48:51], v5, s[12:15], s24 offen offset:2048 sc1
  buffer_load_dwordx4 a[52:55], v5, s[12:15], s25 offen offset:2048 sc1
  buffer_load_dwordx2 a[56:57], v6, s[12:15], s24 offen offset:3072 sc1
  buffer_load_dwordx2 a[58:59], v6, s[12:15], s24 offen offset:3584 sc1
  buffer_load_dwordx2 a[60:61], v6, s[12:15], s25 offen offset:3072 sc1
  buffer_load_dwordx2 a[62:63], v6, s[12:15], s25 offen offset:3584 sc1
  s_add_u32 s24, s24, 4096
  buffer_load_dwordx4 a[64:67], v5, s[12:15], s24 offen offset:0 sc1
  s_add_u32 s25, s25, 4096
  buffer_load_dwordx4 a[68:71], v5, s[12:15], s25 offen offset:0 sc1
  buffer_load_dwordx4 a[72:75], v5, s[12:15], s24 offen offset:1024 sc1
  buffer_load_dwordx4 a[76:79], v5, s[12:15], s25 offen offset:1024 sc1
  s_mul_i32 s26, s9, 0x40000
  s_mul_i32 s8, s20, 0x400
  s_add_u32 s26, s26, s8
  s_add_u32 s26, s26, 0x13de000
  v_lshlrev_b32 v10, 8, v3
  v_lshl_add_u32 v10, v4, 3, v10
  buffer_load_dwordx2 v[136:137], v10, s[12:15], s26 offen offset:0 sc1
  buffer_load_dwordx2 v[138:139], v10, s[12:15], s26 offen offset:128 sc1
  buffer_load_dwordx2 v[140:141], v10, s[12:15], s26 offen offset:1024 sc1
  buffer_load_dwordx2 v[142:143], v10, s[12:15], s26 offen offset:1152 sc1
  s_mul_i32 s27, s5, 0xa0
  s_add_u32 s27, s27, 0x9d8000
  v_lshlrev_b32 v10, 2, v4
  buffer_load_dword v144, v10, s[12:15], s27 offen offset:2560
  buffer_load_dword v146, v10, s[12:15], s27 offen offset:2624
  v_add_u32 v11, 2688, v10
  v_add_u32 v12, 5088, v10
  v_cmp_gt_u32 vcc, 8, v4
  s_nop 1
  v_cndmask_b32 v11, v12, v11, vcc
  buffer_load_dword v148, v11, s[12:15], s27 offen
  buffer_load_dword v150, v12, s[12:15], s27 offen offset:64
  buffer_load_dword v151, v12, s[12:15], s27 offen offset:128
  v_lshlrev_b32 v10, 4, v3
  buffer_load_dwordx4 v[152:155], v10, s[12:15], s27 offen
  buffer_load_dwordx4 v[156:159], v10, s[12:15], s27 offen offset:64
  v_mov_b32 v11, 0x40000000
  v_cmp_gt_u32 vcc, 2, v3
  s_nop 1
  v_cndmask_b32 v10, v11, v10, vcc
  buffer_load_dwordx4 v[160:163], v10, s[12:15], s27 offen offset:128
  s_cmp_lg_u32 s9, 0
  s_cbranch_scc1 JE_3
  s_cmp_lt_u32 s2, 184
  s_cselect_b32 s80, 2211840, 0
  s_cmp_ge_u32 s2, 72
  s_cbranch_scc1 J4_1
  s_add_u32 s47, s2, 88
  s_and_b32 s31, s47, 1
  s_lshl_b32 s28, s31, 3
  s_add_u32 s56, s0, s28
  s_addc_u32 s57, s1, 0
  s_load_dwordx2 s[56:57], s[56:57], 32
  s_lshr_b32 s30, s47, 1
  s_and_b32 s30, s30, 3
  s_lshl_b32 s30, s30, 2
  s_add_u32 s30, s30, s3
  s_lshr_b32 s29, s47, 3
  s_mul_i32 s75, s29, 110592
  s_mul_i32 s55, s30, 216
  s_mul_i32 s53, s30, 280
  s_mul_i32 s71, s29, 6
  s_mul_i32 s33, s31, 3
  s_add_u32 s71, s71, s33
  s_add_u32 s71, s71, s53
  s_add_u32 s71, s71, 160
  s_lshl_b32 s71, s71, 10
  s_lshl_b32 s33, s29, 3
  s_add_u32 s53, s53, s33
  s_lshl_b32 s31, s31, 2
  s_add_u32 s53, s53, s31
  s_lshl_b32 s53, s53, 10
  s_add_u32 s68, s53, 0x348000
  s_add_u32 s69, s71, 0x348000
  s_movk_i32 s81, 13824
  s_mov_b32 s101, 55296
  s_mov_b32 s100, 4
  s_movk_i32 s72, 3456
  s_mov_b32 s35, 14
  s_mov_b32 s70, 0
  v_mov_b32 v232, v5
  s_branch JC_2
J4_1:
  s_load_dwordx2 s[56:57], s[0:1], 48
  s_sub_u32 s29, s2, 72
  s_min_u32 s29, s29, 111
  s_and_b32 s30, s29, 1
  s_lshl_b32 s30, s30, 2
  s_add_u32 s30, s30, s3
  s_lshr_b32 s29, s29, 1
  s_mul_i32 s31, s29, 37
  s_lshr_b32 s31, s31, 8
  s_mul_i32 s32, s31, 7
  s_sub_u32 s32, s29, s32
  s_mul_i32 s33, s31, 216
  s_cmp_ge_u32 s32, 3
  s_cselect_b32 s34, 12, 0
  s_lshl_b32 s35, s32, 5
  s_add_u32 s26, s33, s35
  s_add_u32 s26, s26, s34
  s_add_u32 s35, s33, 96
  s_cmp_eq_u32 s32, 6
  s_cselect_b32 s26, s35, s26
  s_movk_i32 s101, 20480
  s_cselect_b32 s101, 138240, s101
  s_cselect_b32 s100, 3, 4
  s_movk_i32 s81, 5120
  s_mul_i32 s53, s30, 56
  s_add_u32 s53, s53, s29
  s_mul_i32 s53, s53, 5120
  s_add_u32 s68, s53, 0x7a8000
  s_add_u32 s69, s68, 4096
  s_mul_i32 s75, s26, 1280
  s_mul_i32 s55, s30, 160
  s_movk_i32 s72, 1280
  s_mov_b32 s35, 10
  s_and_b32 s70, s30, 1
  v_mov_b32 v232, 0x40000000
JC_2:
  v_lshlrev_b32 v184, 4, v4
  v_min_u32 v184, 200, v184
  v_add_u32 v184, s55, v184
  v_mad_u32_u24 v228, v3, s72, v184
  v_mov_b32 v184, 0x40000000
  v_cmp_gt_u32 vcc, s35, v4
  s_nop 1
  v_cndmask_b32 v228, v184, v228, vcc
  s_mul_i32 s46, s3, 8192
  v_lshrrev_b32 v184, 2, v2
  v_lshlrev_b32 v184, 8, v184
  v_and_b32 v185, 3, v2
  v_lshl_add_u32 v184, v185, 3, v184
  v_add_u32 v184, s46, v184
  s_lshl_b32 s70, s70, 5
  v_add_u32 v229, s70, v184
  s_cmp_eq_u32 s70, 0
  s_cselect_b32 s70, 128, 0
  v_add_u32 v230, s70, v184
  v_add_u32 v231, 192, v184
  v_add_u32 v184, 200, v184
  v_cmp_eq_u32 vcc, 2, v185
  s_nop 1
  v_cndmask_b32 v231, v231, v184, vcc
  s_waitcnt lgkmcnt(0)
JE_3:
  s_waitcnt vmcnt(34)
  s_barrier
  ds_read_b128 v[32:35], v5 offset:0
  ds_read_b128 v[36:39], v5 offset:1024
  ds_read_b128 v[40:43], v5 offset:2048
  ds_read_b128 v[44:47], v5 offset:3072
  ds_read_b128 v[48:51], v5 offset:4096
  s_waitcnt lgkmcnt(0)
  v_mfma_f32_16x16x32_bf16 v[72:75], a[0:3], v[32:35], 0
  ds_read_b128 v[52:55], v5 offset:5120
  v_mfma_f32_16x16x32_bf16 v[92:95], a[4:7], v[32:35], 0
  ds_read_b128 v[56:59], v5 offset:6144
  v_lshlrev_b32 v184, 4, v3
  v_mfma_f32_16x16x32_bf16 v[76:79], a[0:3], v[36:39], 0
  ds_read_b128 v[60:63], v5 offset:7168
  v_mfma_f32_16x16x32_bf16 v[96:99], a[4:7], v[36:39], 0
  ds_read_b128 v[64:67], v5 offset:8192
  v_mov_b32 v187, 0
  v_mfma_f32_16x16x32_bf16 v[80:83], a[0:3], v[40:43], 0
  ds_read_b128 v[68:71], v5 offset:9216
  v_mfma_f32_16x16x32_bf16 v[100:103], a[4:7], v[40:43], 0
  buffer_load_dwordx4 a[80:83], v5, s[12:15], s24 offen offset:2048 sc1
  v_add_u32 v196, 1664, v184
  v_mfma_f32_16x16x32_bf16 v[84:87], a[0:3], v[44:47], 0
  buffer_load_dwordx4 a[84:87], v5, s[12:15], s25 offen offset:2048 sc1
  v_mov_b32 v197, 64
  v_mfma_f32_16x16x32_bf16 v[104:107], a[4:7], v[44:47], 0
  v_cmp_eq_u32 vcc, 0, v3
  s_nop 1
  v_cndmask_b32 v185, v196, v197, vcc
  v_cndmask_b32 v188, 1, v187, vcc
  v_mfma_f32_16x16x32_bf16 v[88:91], a[0:3], v[48:51], 0
  v_add_u32 v186, 1728, v184
  v_mfma_f32_16x16x32_bf16 v[108:111], a[4:7], v[48:51], 0
  v_mov_b32 v197, 1
  s_waitcnt vmcnt(34)
  s_waitcnt lgkmcnt(0)
  v_mfma_f32_16x16x32_bf16 v[72:75], a[8:11], v[52:55], v[72:75]
  ds_read_b128 v[32:35], v5 offset:10240
  v_mfma_f32_16x16x32_bf16 v[92:95], a[12:15], v[52:55], v[92:95]
  ds_read_b128 v[36:39], v5 offset:11264
  v_cmp_gt_u32 vcc, 2, v3
  s_nop 1
  v_cndmask_b32 v189, 2, v197, vcc
  v_mfma_f32_16x16x32_bf16 v[76:79], a[8:11], v[56:59], v[76:79]
  ds_read_b128 v[40:43], v5 offset:12288
  v_mfma_f32_16x16x32_bf16 v[96:99], a[12:15], v[56:59], v[96:99]
  ds_read_b128 v[44:47], v5 offset:13312
  v_mul_u32_u24 v196, 80, v4
  v_mfma_f32_16x16x32_bf16 v[80:83], a[8:11], v[60:63], v[80:83]
  ds_read_b128 v[48:51], v5 offset:14336
  v_mfma_f32_16x16x32_bf16 v[100:103], a[12:15], v[60:63], v[100:103]
  buffer_load_dwordx4 a[88:91], v5, s[12:15], s24 offen offset:3072 sc1
  v_subrev_u32 v190, 640, v196
  v_mfma_f32_16x16x32_bf16 v[84:87], a[8:11], v[64:67], v[84:87]
  buffer_load_dwordx4 a[92:95], v5, s[12:15], s25 offen offset:3072 sc1
  v_cmp_le_u32 vcc, 8, v4
  s_nop 1
  v_cndmask_b32 v193, 3, v187, vcc
  v_mfma_f32_16x16x32_bf16 v[104:107], a[12:15], v[64:67], v[104:107]
  v_add_u32 v197, 640, v196
  v_mfma_f32_16x16x32_bf16 v[88:91], a[8:11], v[68:71], v[88:91]
  v_subrev_u32 v198, 960, v196
  v_mfma_f32_16x16x32_bf16 v[108:111], a[12:15], v[68:71], v[108:111]
  v_mov_b32 v195, 1
  s_waitcnt vmcnt(32)
  s_waitcnt lgkmcnt(0)
  v_mfma_f32_16x16x32_bf16 v[72:75], a[16:19], v[32:35], v[72:75]
  ds_read_b128 v[52:55], v5 offset:15360
  v_mfma_f32_16x16x32_bf16 v[92:95], a[20:23], v[32:35], v[92:95]
  ds_read_b128 v[56:59], v5 offset:16384
  v_cmp_gt_u32 vcc, 12, v4
  s_nop 1
  v_cndmask_b32 v191, v198, v197, vcc
  v_cndmask_b32 v194, 1, v187, vcc
  v_mfma_f32_16x16x32_bf16 v[76:79], a[16:19], v[36:39], v[76:79]
  ds_read_b128 v[60:63], v5 offset:17408
  v_mfma_f32_16x16x32_bf16 v[96:99], a[20:23], v[36:39], v[96:99]
  ds_read_b128 v[64:67], v5 offset:18432
  v_add_u32 v192, 320, v196
  v_mfma_f32_16x16x32_bf16 v[80:83], a[16:19], v[40:43], v[80:83]
  ds_read_b128 v[68:71], v5 offset:19456
  v_mfma_f32_16x16x32_bf16 v[100:103], a[20:23], v[40:43], v[100:103]
  s_add_u32 s24, s24, 4096
  buffer_load_dwordx2 a[96:97], v6, s[12:15], s24 offen offset:0 sc1
  buffer_load_dwordx2 a[98:99], v6, s[12:15], s24 offen offset:512 sc1
  s_mul_i32 s28, s3, 3584
  v_mfma_f32_16x16x32_bf16 v[84:87], a[16:19], v[44:47], v[84:87]
  s_add_u32 s25, s25, 4096
  buffer_load_dwordx2 a[100:101], v6, s[12:15], s25 offen offset:0 sc1
  buffer_load_dwordx2 a[102:103], v6, s[12:15], s25 offen offset:512 sc1
  s_add_u32 s28, s28, 86016
  v_mfma_f32_16x16x32_bf16 v[104:107], a[20:23], v[44:47], v[104:107]
  v_and_b32 v199, 7, v2
  v_mfma_f32_16x16x32_bf16 v[88:91], a[16:19], v[48:51], v[88:91]
  v_lshlrev_b32 v199, 4, v199
  v_mfma_f32_16x16x32_bf16 v[108:111], a[20:23], v[48:51], v[108:111]
  v_add_u32 v199, 3360, v199
  s_waitcnt vmcnt(34)
  s_waitcnt lgkmcnt(0)
  v_mfma_f32_16x16x32_bf16 v[72:75], a[24:27], v[52:55], v[72:75]
  ds_read_b128 v[32:35], v5 offset:20480
  v_mfma_f32_16x16x32_bf16 v[92:95], a[28:31], v[52:55], v[92:95]
  ds_read_b128 v[36:39], v5 offset:21504
  v_add_u32 v13, v184, v190
  v_mfma_f32_16x16x32_bf16 v[76:79], a[24:27], v[56:59], v[76:79]
  ds_read_b128 v[40:43], v5 offset:22528
  v_mfma_f32_16x16x32_bf16 v[96:99], a[28:31], v[56:59], v[96:99]
  ds_read_b128 v[44:47], v5 offset:23552
  v_cmp_eq_u32 vcc, v187, v193
  s_nop 1
  v_cndmask_b32 v13, v199, v13, vcc
  v_mfma_f32_16x16x32_bf16 v[80:83], a[24:27], v[60:63], v[80:83]
  ds_read_b128 v[48:51], v5 offset:24576
  v_mfma_f32_16x16x32_bf16 v[100:103], a[28:31], v[60:63], v[100:103]
  buffer_load_dwordx4 a[104:107], v5, s[12:15], s24 offen offset:1024 sc1
  v_add_u32 v236, s28, v13
  v_mfma_f32_16x16x32_bf16 v[84:87], a[24:27], v[64:67], v[84:87]
  buffer_load_dwordx4 a[108:111], v5, s[12:15], s25 offen offset:1024 sc1
  v_add_u32 v13, v184, v191
  v_mfma_f32_16x16x32_bf16 v[104:107], a[28:31], v[64:67], v[104:107]
  v_cmp_eq_u32 vcc, v187, v194
  s_nop 1
  v_cndmask_b32 v13, v199, v13, vcc
  v_mfma_f32_16x16x32_bf16 v[88:91], a[24:27], v[68:71], v[88:91]
  v_add_u32 v237, s28, v13
  v_mfma_f32_16x16x32_bf16 v[108:111], a[28:31], v[68:71], v[108:111]
  v_add_u32 v13, v185, v190
  s_waitcnt vmcnt(34)
  s_waitcnt lgkmcnt(0)
  v_mfma_f32_16x16x32_bf16 v[72:75], a[32:35], v[32:35], v[72:75]
  ds_read_b128 v[52:55], v5 offset:25600
  v_mfma_f32_16x16x32_bf16 v[92:95], a[36:39], v[32:35], v[92:95]
  ds_read_b128 v[56:59], v5 offset:26624
  v_cmp_eq_u32 vcc, v188, v193
  s_nop 1
  v_cndmask_b32 v13, v199, v13, vcc
  v_mfma_f32_16x16x32_bf16 v[76:79], a[32:35], v[36:39], v[76:79]
  ds_read_b128 v[60:63], v5 offset:27648
  v_mfma_f32_16x16x32_bf16 v[96:99], a[36:39], v[36:39], v[96:99]
  ds_read_b128 v[64:67], v5 offset:28672
  v_add_u32 v238, s28, v13
  v_mfma_f32_16x16x32_bf16 v[80:83], a[32:35], v[40:43], v[80:83]
  ds_read_b128 v[68:71], v5 offset:29696
  v_mfma_f32_16x16x32_bf16 v[100:103], a[36:39], v[40:43], v[100:103]
  buffer_load_dwordx4 a[112:115], v5, s[12:15], s24 offen offset:2048 sc1
  v_add_u32 v13, v185, v191
  v_mfma_f32_16x16x32_bf16 v[84:87], a[32:35], v[44:47], v[84:87]
  buffer_load_dwordx4 a[116:119], v5, s[12:15], s25 offen offset:2048 sc1
  v_cmp_eq_u32 vcc, v188, v194
  s_nop 1
  v_cndmask_b32 v13, v199, v13, vcc
  v_mfma_f32_16x16x32_bf16 v[104:107], a[36:39], v[44:47], v[104:107]
  v_add_u32 v239, s28, v13
  v_mfma_f32_16x16x32_bf16 v[88:91], a[32:35], v[48:51], v[88:91]
  v_add_u32 v13, v185, v192
  v_mfma_f32_16x16x32_bf16 v[108:111], a[36:39], v[48:51], v[108:111]
  v_cmp_eq_u32 vcc, v188, v195
  s_nop 1
  v_cndmask_b32 v13, v199, v13, vcc
  s_waitcnt vmcnt(34)
  s_waitcnt lgkmcnt(0)
  v_mfma_f32_16x16x32_bf16 v[72:75], a[40:43], v[52:55], v[72:75]
  ds_read_b128 v[32:35], v5 offset:30720
  v_mfma_f32_16x16x32_bf16 v[92:95], a[44:47], v[52:55], v[92:95]
  ds_read_b128 v[36:39], v5 offset:31744
  v_add_u32 v240, s28, v13
  v_mfma_f32_16x16x32_bf16 v[76:79], a[40:43], v[56:59], v[76:79]
  ds_read_b128 v[40:43], v5 offset:32768
  v_mfma_f32_16x16x32_bf16 v[96:99], a[44:47], v[56:59], v[96:99]
  ds_read_b128 v[44:47], v5 offset:33792
  v_add_u32 v13, v186, v191
  v_mfma_f32_16x16x32_bf16 v[80:83], a[40:43], v[60:63], v[80:83]
  ds_read_b128 v[48:51], v5 offset:34816
  v_mfma_f32_16x16x32_bf16 v[100:103], a[44:47], v[60:63], v[100:103]
  buffer_load_dwordx4 a[120:123], v5, s[12:15], s24 offen offset:3072 sc1
  v_cmp_eq_u32 vcc, v189, v194
  s_nop 1
  v_cndmask_b32 v13, v199, v13, vcc
  v_mfma_f32_16x16x32_bf16 v[84:87], a[40:43], v[64:67], v[84:87]
  buffer_load_dwordx4 a[124:127], v5, s[12:15], s25 offen offset:3072 sc1
  v_add_u32 v241, s28, v13
  v_mfma_f32_16x16x32_bf16 v[104:107], a[44:47], v[64:67], v[104:107]
  v_add_u32 v13, v186, v192
  v_mfma_f32_16x16x32_bf16 v[88:91], a[40:43], v[68:71], v[88:91]
  v_cmp_eq_u32 vcc, v189, v195
  s_nop 1
  v_cndmask_b32 v13, v199, v13, vcc
  v_mfma_f32_16x16x32_bf16 v[108:111], a[44:47], v[68:71], v[108:111]
  v_add_u32 v242, s28, v13
  s_waitcnt vmcnt(34)
  s_waitcnt lgkmcnt(0)
  v_mfma_f32_16x16x32_bf16 v[72:75], a[48:51], v[32:35], v[72:75]
  ds_read_b128 v[52:55], v5 offset:35840
  v_mfma_f32_16x16x32_bf16 v[92:95], a[52:55], v[32:35], v[92:95]
  ds_read_b128 v[56:59], v5 offset:36864
  v_add_u32 v13, 1600, v184
  v_mfma_f32_16x16x32_bf16 v[76:79], a[48:51], v[36:39], v[76:79]
  ds_read_b128 v[60:63], v5 offset:37888
  v_mfma_f32_16x16x32_bf16 v[96:99], a[52:55], v[36:39], v[96:99]
  ds_read_b128 v[64:67], v5 offset:38912
  v_cmp_gt_u32 vcc, 2, v187
  s_nop 1
  v_cndmask_b32 v13, v199, v13, vcc
  v_mfma_f32_16x16x32_bf16 v[80:83], a[48:51], v[40:43], v[80:83]
  ds_read_b128 v[68:71], v5 offset:39936
  v_mfma_f32_16x16x32_bf16 v[100:103], a[52:55], v[40:43], v[100:103]
  s_add_u32 s24, s24, 4096
  buffer_load_dwordx4 a[128:131], v5, s[12:15], s24 offen offset:0 sc1
  v_cmp_eq_u32 vcc, 0, v4
  s_nop 1
  v_cndmask_b32 v13, v199, v13, vcc
  v_mfma_f32_16x16x32_bf16 v[84:87], a[48:51], v[44:47], v[84:87]
  s_add_u32 s25, s25, 4096
  buffer_load_dwordx4 a[132:135], v5, s[12:15], s25 offen offset:0 sc1
  v_add_u32 v243, s28, v13
  v_mfma_f32_16x16x32_bf16 v[104:107], a[52:55], v[44:47], v[104:107]
  v_add_u32 v13, 1600, v185
  v_mfma_f32_16x16x32_bf16 v[88:91], a[48:51], v[48:51], v[88:91]
  v_cmp_gt_u32 vcc, 2, v188
  s_nop 1
  v_cndmask_b32 v13, v199, v13, vcc
  v_mfma_f32_16x16x32_bf16 v[108:111], a[52:55], v[48:51], v[108:111]
  v_cmp_eq_u32 vcc, 0, v4
  s_nop 1
  v_cndmask_b32 v13, v199, v13, vcc
  s_waitcnt vmcnt(32)
  s_waitcnt lgkmcnt(0)
  v_mfma_f32_16x16x32_bf16 v[72:75], a[56:59], v[52:55], v[72:75]
  ds_read_b128 v[32:35], v5 offset:40960
  v_mfma_f32_16x16x32_bf16 v[92:95], a[60:63], v[52:55], v[92:95]
  ds_read_b128 v[36:39], v5 offset:41984
  v_add_u32 v244, s28, v13
  v_mfma_f32_16x16x32_bf16 v[76:79], a[56:59], v[56:59], v[76:79]
  ds_read_b128 v[40:43], v5 offset:43008
  v_mfma_f32_16x16x32_bf16 v[96:99], a[60:63], v[56:59], v[96:99]
  ds_read_b128 v[44:47], v5 offset:44032
  v_add_u32 v13, 1600, v186
  v_mfma_f32_16x16x32_bf16 v[80:83], a[56:59], v[60:63], v[80:83]
  ds_read_b128 v[48:51], v5 offset:45056
  v_mfma_f32_16x16x32_bf16 v[100:103], a[60:63], v[60:63], v[100:103]
  buffer_load_dwordx2 a[136:137], v6, s[12:15], s24 offen offset:1024 sc1
  buffer_load_dwordx2 a[138:139], v6, s[12:15], s24 offen offset:1536 sc1
  v_cmp_gt_u32 vcc, 2, v189
  s_nop 1
  v_cndmask_b32 v13, v199, v13, vcc
  v_mfma_f32_16x16x32_bf16 v[84:87], a[56:59], v[64:67], v[84:87]
  buffer_load_dwordx2 a[140:141], v6, s[12:15], s25 offen offset:1024 sc1
  buffer_load_dwordx2 a[142:143], v6, s[12:15], s25 offen offset:1536 sc1
  v_cmp_eq_u32 vcc, 0, v4
  s_nop 1
  v_cndmask_b32 v13, v199, v13, vcc
  v_mfma_f32_16x16x32_bf16 v[104:107], a[60:63], v[64:67], v[104:107]
  v_add_u32 v245, s28, v13
  v_mfma_f32_16x16x32_bf16 v[88:91], a[56:59], v[68:71], v[88:91]
  v_mov_b32 v220, 0x3f803f80
  v_mfma_f32_16x16x32_bf16 v[108:111], a[60:63], v[68:71], v[108:111]
  v_mov_b32 v221, 0x3f803f80
  s_waitcnt vmcnt(34)
  s_waitcnt lgkmcnt(0)
  v_mfma_f32_16x16x32_bf16 v[72:75], a[64:67], v[32:35], v[72:75]
  ds_read_b128 v[52:55], v5 offset:46080
  v_mfma_f32_16x16x32_bf16 v[92:95], a[68:71], v[32:35], v[92:95]
  ds_read_b128 v[56:59], v5 offset:47104
  v_mov_b32 v222, 0x3f803f80
  v_mfma_f32_16x16x32_bf16 v[76:79], a[64:67], v[36:39], v[76:79]
  ds_read_b128 v[60:63], v5 offset:48128
  v_mfma_f32_16x16x32_bf16 v[96:99], a[68:71], v[36:39], v[96:99]
  ds_read_b128 v[64:67], v5 offset:49152
  v_mov_b32 v223, 0x3f803f80
  v_mfma_f32_16x16x32_bf16 v[80:83], a[64:67], v[40:43], v[80:83]
  ds_read_b128 v[68:71], v5 offset:50176
  v_mfma_f32_16x16x32_bf16 v[100:103], a[68:71], v[40:43], v[100:103]
  buffer_load_dwordx4 a[144:147], v5, s[12:15], s24 offen offset:2048 sc1
  s_mov_b32 s72, 0x3fb8aa3b
  v_mfma_f32_16x16x32_bf16 v[84:87], a[64:67], v[44:47], v[84:87]
  buffer_load_dwordx4 a[148:151], v5, s[12:15], s25 offen offset:2048 sc1
  s_mov_b32 s73, 0x3fb8aa3b
  v_mfma_f32_16x16x32_bf16 v[104:107], a[68:71], v[44:47], v[104:107]
  s_mov_b32 s70, 0x358637bd
  v_mfma_f32_16x16x32_bf16 v[88:91], a[64:67], v[48:51], v[88:91]
  s_mov_b32 s71, 0x358637bd
  v_mfma_f32_16x16x32_bf16 v[108:111], a[68:71], v[48:51], v[108:111]
  v_cmp_gt_u32 s[64:65], 8, v4
  s_waitcnt vmcnt(34)
  s_waitcnt lgkmcnt(0)
  v_mfma_f32_16x16x32_bf16 v[72:75], a[72:75], v[52:55], v[72:75]
  ds_read_b128 v[32:35], v5 offset:51200
  v_mfma_f32_16x16x32_bf16 v[92:95], a[76:79], v[52:55], v[92:95]
  ds_read_b128 v[36:39], v5 offset:52224
  s_mul_i32 s29, s9, 0xe000
  v_mfma_f32_16x16x32_bf16 v[76:79], a[72:75], v[56:59], v[76:79]
  ds_read_b128 v[40:43], v5 offset:53248
  v_mfma_f32_16x16x32_bf16 v[96:99], a[76:79], v[56:59], v[96:99]
  ds_read_b128 v[44:47], v5 offset:54272
  s_mul_i32 s30, s5, 0xe00
  v_mfma_f32_16x16x32_bf16 v[80:83], a[72:75], v[60:63], v[80:83]
  ds_read_b128 v[48:51], v5 offset:55296
  v_mfma_f32_16x16x32_bf16 v[100:103], a[76:79], v[60:63], v[100:103]
  buffer_load_dwordx4 a[152:155], v5, s[12:15], s24 offen offset:3072 sc1
  s_add_u32 s29, s29, s30
  v_mfma_f32_16x16x32_bf16 v[84:87], a[72:75], v[64:67], v[84:87]
  buffer_load_dwordx4 a[156:159], v5, s[12:15], s25 offen offset:3072 sc1
  s_add_u32 s29, s29, 0x195e000
  v_mfma_f32_16x16x32_bf16 v[104:107], a[76:79], v[64:67], v[104:107]
  v_mfma_f32_16x16x32_bf16 v[88:91], a[72:75], v[68:71], v[88:91]
  v_mfma_f32_16x16x32_bf16 v[108:111], a[76:79], v[68:71], v[108:111]
  s_waitcnt vmcnt(22)
  s_waitcnt lgkmcnt(0)
  v_mfma_f32_16x16x32_bf16 v[72:75], a[80:83], v[32:35], v[72:75]
  ds_read_b128 v[52:55], v5 offset:56320
  v_mfma_f32_16x16x32_bf16 v[92:95], a[84:87], v[32:35], v[92:95]
  ds_read_b128 v[56:59], v5 offset:57344
  v_mfma_f32_16x16x32_bf16 v[76:79], a[80:83], v[36:39], v[76:79]
  ds_read_b128 v[60:63], v5 offset:58368
  v_mfma_f32_16x16x32_bf16 v[96:99], a[84:87], v[36:39], v[96:99]
  ds_read_b128 v[64:67], v5 offset:59392
  v_mfma_f32_16x16x32_bf16 v[80:83], a[80:83], v[40:43], v[80:83]
  ds_read_b128 v[68:71], v5 offset:60416
  v_mfma_f32_16x16x32_bf16 v[100:103], a[84:87], v[40:43], v[100:103]
  s_mul_i32 s54, s3, 15360
  s_mul_i32 s55, s5, 0x28000
  s_add_u32 s55, s55, s54
  s_add_u32 m0, s54, 102400
  s_add_u32 s53, s55, 0x19000
  buffer_load_dwordx4 v5, s[12:15], s53 offen offset:0 lds
  v_mfma_f32_16x16x32_bf16 v[84:87], a[80:83], v[44:47], v[84:87]
  buffer_load_dwordx4 v5, s[12:15], s53 offen offset:1024 lds
  v_mfma_f32_16x16x32_bf16 v[104:107], a[84:87], v[44:47], v[104:107]
  buffer_load_dwordx4 v5, s[12:15], s53 offen offset:2048 lds
  v_mfma_f32_16x16x32_bf16 v[88:91], a[80:83], v[48:51], v[88:91]
  v_mfma_f32_16x16x32_bf16 v[108:111], a[84:87], v[48:51], v[108:111]
  s_waitcnt vmcnt(23)
  s_waitcnt vmcnt(27)
  s_waitcnt lgkmcnt(0)
  v_mfma_f32_16x16x32_bf16 v[72:75], a[88:91], v[52:55], v[72:75]
  ds_read_b128 v[32:35], v5 offset:61440
  v_mfma_f32_16x16x32_bf16 v[92:95], a[92:95], v[52:55], v[92:95]
  ds_read_b128 v[36:39], v5 offset:62464
  v_mfma_f32_16x16x32_bf16 v[76:79], a[88:91], v[56:59], v[76:79]
  ds_read_b128 v[40:43], v5 offset:63488
  v_mfma_f32_16x16x32_bf16 v[96:99], a[92:95], v[56:59], v[96:99]
  ds_read_b128 v[44:47], v5 offset:64512
  v_mfma_f32_16x16x32_bf16 v[80:83], a[88:91], v[60:63], v[80:83]
  ds_read_b128 v[48:51], v7 offset:0
  v_mfma_f32_16x16x32_bf16 v[100:103], a[92:95], v[60:63], v[100:103]
  buffer_load_dwordx4 v5, s[12:15], s53 offen offset:3072 lds
  v_mfma_f32_16x16x32_bf16 v[84:87], a[88:91], v[64:67], v[84:87]
  s_add_u32 m0, s54, 106496
  s_add_u32 s53, s55, 0x1a000
  buffer_load_dwordx4 v5, s[12:15], s53 offen offset:0 lds
  v_mfma_f32_16x16x32_bf16 v[104:107], a[92:95], v[64:67], v[104:107]
  buffer_load_dwordx4 v5, s[12:15], s53 offen offset:1024 lds
  v_mfma_f32_16x16x32_bf16 v[88:91], a[88:91], v[68:71], v[88:91]
  v_mfma_f32_16x16x32_bf16 v[108:111], a[92:95], v[68:71], v[108:111]
  s_waitcnt vmcnt(22)
  s_waitcnt lgkmcnt(0)
  v_mfma_f32_16x16x32_bf16 v[72:75], a[96:99], v[32:35], v[72:75]
  ds_read_b128 v[52:55], v7 offset:1024
  v_mfma_f32_16x16x32_bf16 v[92:95], a[100:103], v[32:35], v[92:95]
  ds_read_b128 v[56:59], v7 offset:2048
  v_add_f32 v136, v136, v138
  v_mfma_f32_16x16x32_bf16 v[76:79], a[96:99], v[36:39], v[76:79]
  ds_read_b128 v[60:63], v7 offset:3072
  v_mfma_f32_16x16x32_bf16 v[96:99], a[100:103], v[36:39], v[96:99]
  ds_read_b128 v[64:67], v7 offset:4096
  v_add_f32 v137, v137, v139
  v_mfma_f32_16x16x32_bf16 v[80:83], a[96:99], v[40:43], v[80:83]
  ds_read_b128 v[68:71], v7 offset:5120
  v_mfma_f32_16x16x32_bf16 v[100:103], a[100:103], v[40:43], v[100:103]
  buffer_load_dwordx4 v5, s[12:15], s53 offen offset:2048 lds
  v_mov_b32 v138, v136
  v_mfma_f32_16x16x32_bf16 v[84:87], a[96:99], v[44:47], v[84:87]
  buffer_load_dwordx4 v5, s[12:15], s53 offen offset:3072 lds
  v_mov_b32 v139, v137
  v_mfma_f32_16x16x32_bf16 v[104:107], a[100:103], v[44:47], v[104:107]
  s_add_u32 m0, s54, 110592
  s_add_u32 s53, s55, 0x1b000
  buffer_load_dwordx4 v5, s[12:15], s53 offen offset:0 lds
  v_permlane16_swap_b32 v136, v138
  v_mfma_f32_16x16x32_bf16 v[88:91], a[96:99], v[48:51], v[88:91]
  v_permlane16_swap_b32 v137, v139
  v_mfma_f32_16x16x32_bf16 v[108:111], a[100:103], v[48:51], v[108:111]
  v_add_f32 v136, v136, v138
  s_waitcnt vmcnt(23)
  s_waitcnt lgkmcnt(0)
  v_mfma_f32_16x16x32_bf16 v[72:75], a[104:107], v[52:55], v[72:75]
  ds_read_b128 v[32:35], v7 offset:6144
  v_mfma_f32_16x16x32_bf16 v[92:95], a[108:111], v[52:55], v[92:95]
  ds_read_b128 v[36:39], v7 offset:7168
  v_add_f32 v137, v137, v139
  v_mfma_f32_16x16x32_bf16 v[76:79], a[104:107], v[56:59], v[76:79]
  ds_read_b128 v[40:43], v7 offset:8192
  v_mfma_f32_16x16x32_bf16 v[96:99], a[108:111], v[56:59], v[96:99]
  ds_read_b128 v[44:47], v7 offset:9216
  v_mov_b32 v138, v136
  v_mfma_f32_16x16x32_bf16 v[80:83], a[104:107], v[60:63], v[80:83]
  ds_read_b128 v[48:51], v7 offset:10240
  v_mfma_f32_16x16x32_bf16 v[100:103], a[108:111], v[60:63], v[100:103]
  buffer_load_dwordx4 v5, s[12:15], s53 offen offset:1024 lds
  v_mov_b32 v139, v137
  v_mfma_f32_16x16x32_bf16 v[84:87], a[104:107], v[64:67], v[84:87]
  buffer_load_dwordx4 v5, s[12:15], s53 offen offset:2048 lds
  v_permlane32_swap_b32 v136, v138
  v_mfma_f32_16x16x32_bf16 v[104:107], a[108:111], v[64:67], v[104:107]
  v_permlane32_swap_b32 v137, v139
  v_mfma_f32_16x16x32_bf16 v[88:91], a[104:107], v[68:71], v[88:91]
  v_add_f32 v136, v136, v138
  v_mfma_f32_16x16x32_bf16 v[108:111], a[108:111], v[68:71], v[108:111]
  v_add_f32 v137, v137, v139
  s_waitcnt vmcnt(23)
  s_waitcnt lgkmcnt(0)
  v_mfma_f32_16x16x32_bf16 v[72:75], a[112:115], v[32:35], v[72:75]
  ds_read_b128 v[52:55], v7 offset:11264
  v_mfma_f32_16x16x32_bf16 v[92:95], a[116:119], v[32:35], v[92:95]
  ds_read_b128 v[56:59], v7 offset:12288
  v_mul_f32 v136, 0x3acccccd, v136
  v_mfma_f32_16x16x32_bf16 v[76:79], a[112:115], v[36:39], v[76:79]
  ds_read_b128 v[60:63], v7 offset:13312
  v_mfma_f32_16x16x32_bf16 v[96:99], a[116:119], v[36:39], v[96:99]
  ds_read_b128 v[64:67], v7 offset:14336
  v_mul_f32 v137, 0x3acccccd, v137
  v_mfma_f32_16x16x32_bf16 v[80:83], a[112:115], v[40:43], v[80:83]
  ds_read_b128 v[68:71], v7 offset:15360
  v_mfma_f32_16x16x32_bf16 v[100:103], a[116:119], v[40:43], v[100:103]
  buffer_load_dwordx4 v5, s[12:15], s53 offen offset:3072 lds
  v_fma_f32 v137, -v136, v136, v137
  v_mfma_f32_16x16x32_bf16 v[84:87], a[112:115], v[44:47], v[84:87]
  s_add_u32 m0, s54, 114688
  s_add_u32 s53, s55, 0x1c000
  buffer_load_dwordx4 v5, s[12:15], s53 offen offset:0 lds
  v_max_f32 v137, 0, v137
  v_mfma_f32_16x16x32_bf16 v[104:107], a[116:119], v[44:47], v[104:107]
  buffer_load_dwordx4 v5, s[12:15], s53 offen offset:1024 lds
  v_add_f32 v137, 0x3727c5ac, v137
  v_mfma_f32_16x16x32_bf16 v[88:91], a[112:115], v[48:51], v[88:91]
  v_rsq_f32 v164, v137
  v_mfma_f32_16x16x32_bf16 v[108:111], a[116:119], v[48:51], v[108:111]
  v_mul_f32 v166, v136, v164
  s_cmp_lg_u32 s9, 0
  s_cbranch_scc1 JQ_4
  s_barrier
  s_mov_b32 s46, m0
  s_mov_b32 s47, s53
  s_mov_b32 s26, s59
  s_mov_b32 s58, s80
  s_mov_b32 s59, 0x20000
  s_mul_i32 s53, s3, 8192
  s_add_u32 m0, s53, 0
  s_mov_b32 s74, s75
  buffer_load_dwordx4 v228, s[56:59], s74 offen lds
  s_add_u32 m0, s53, 1024
  s_add_u32 s74, s74, s81
  buffer_load_dwordx4 v228, s[56:59], s74 offen lds
  s_add_u32 m0, s53, 2048
  s_add_u32 s74, s74, s81
  buffer_load_dwordx4 v228, s[56:59], s74 offen lds
  s_add_u32 m0, s53, 3072
  s_cmp_eq_u32 s100, 4
  s_cselect_b32 s27, s81, 0
  s_add_u32 s74, s74, s27
  buffer_load_dwordx4 v228, s[56:59], s74 offen lds
  s_add_u32 m0, s53, 4096
  s_add_u32 s74, s75, s101
  s_mov_b32 s75, s74
  buffer_load_dwordx4 v228, s[56:59], s74 offen lds
  s_add_u32 m0, s53, 5120
  s_add_u32 s74, s74, s81
  buffer_load_dwordx4 v228, s[56:59], s74 offen lds
  s_add_u32 m0, s53, 6144
  s_add_u32 s74, s74, s81
  buffer_load_dwordx4 v228, s[56:59], s74 offen lds
  s_add_u32 m0, s53, 7168
  s_cmp_eq_u32 s100, 4
  s_cselect_b32 s101, s81, 0
  s_add_u32 s74, s74, s101
  buffer_load_dwordx4 v228, s[56:59], s74 offen lds
  s_mov_b32 s59, s26
  s_mov_b32 m0, s46
  s_mov_b32 s53, s47
JQ_4:
  s_waitcnt vmcnt(24)
  s_waitcnt lgkmcnt(0)
  v_mfma_f32_16x16x32_bf16 v[72:75], a[120:123], v[52:55], v[72:75]
  ds_read_b128 v[32:35], v7 offset:16384
  v_mfma_f32_16x16x32_bf16 v[92:95], a[124:127], v[52:55], v[92:95]
  ds_read_b128 v[36:39], v7 offset:17408
  v_sub_f32 v166, 0, v166
  v_mfma_f32_16x16x32_bf16 v[76:79], a[120:123], v[56:59], v[76:79]
  ds_read_b128 v[40:43], v7 offset:18432
  v_mfma_f32_16x16x32_bf16 v[96:99], a[124:127], v[56:59], v[96:99]
  ds_read_b128 v[44:47], v7 offset:19456
  v_add_f32 v140, v140, v142
  v_mfma_f32_16x16x32_bf16 v[80:83], a[120:123], v[60:63], v[80:83]
  ds_read_b128 v[48:51], v7 offset:20480
  v_mfma_f32_16x16x32_bf16 v[100:103], a[124:127], v[60:63], v[100:103]
  buffer_load_dwordx4 v5, s[12:15], s53 offen offset:2048 lds
  v_add_f32 v141, v141, v143
  v_mfma_f32_16x16x32_bf16 v[84:87], a[120:123], v[64:67], v[84:87]
  s_add_u32 s59, s49, 0
  buffer_load_dwordx4 a[160:163], v5, s[12:15], s59 offen offset:0
  v_mov_b32 v142, v140
  v_mfma_f32_16x16x32_bf16 v[104:107], a[124:127], v[64:67], v[104:107]
  buffer_load_dwordx4 a[164:167], v5, s[12:15], s59 offen offset:1024
  v_mov_b32 v143, v141
  v_mfma_f32_16x16x32_bf16 v[88:91], a[120:123], v[68:71], v[88:91]
  v_permlane16_swap_b32 v140, v142
  v_mfma_f32_16x16x32_bf16 v[108:111], a[124:127], v[68:71], v[108:111]
  v_permlane16_swap_b32 v141, v143
  s_waitcnt vmcnt(25)
  s_waitcnt lgkmcnt(0)
  v_mfma_f32_16x16x32_bf16 v[72:75], a[128:131], v[32:35], v[72:75]
  ds_read_b128 v[52:55], v7 offset:21504
  v_mfma_f32_16x16x32_bf16 v[92:95], a[132:135], v[32:35], v[92:95]
  ds_read_b128 v[56:59], v7 offset:22528
  v_add_f32 v140, v140, v142
  v_mfma_f32_16x16x32_bf16 v[76:79], a[128:131], v[36:39], v[76:79]
  ds_read_b128 v[60:63], v7 offset:23552
  v_mfma_f32_16x16x32_bf16 v[96:99], a[132:135], v[36:39], v[96:99]
  ds_read_b128 v[64:67], v7 offset:24576
  v_add_f32 v141, v141, v143
  v_mfma_f32_16x16x32_bf16 v[80:83], a[128:131], v[40:43], v[80:83]
  ds_read_b128 v[68:71], v7 offset:25600
  v_mfma_f32_16x16x32_bf16 v[100:103], a[132:135], v[40:43], v[100:103]
  buffer_load_dwordx4 a[168:171], v5, s[12:15], s59 offen offset:2048
  v_mov_b32 v142, v140
  v_mfma_f32_16x16x32_bf16 v[84:87], a[128:131], v[44:47], v[84:87]
  buffer_load_dwordx4 a[172:175], v5, s[12:15], s59 offen offset:3072
  v_mov_b32 v143, v141
  v_mfma_f32_16x16x32_bf16 v[104:107], a[132:135], v[44:47], v[104:107]
  v_permlane32_swap_b32 v140, v142
  v_mfma_f32_16x16x32_bf16 v[88:91], a[128:131], v[48:51], v[88:91]
  v_permlane32_swap_b32 v141, v143
  v_mfma_f32_16x16x32_bf16 v[108:111], a[132:135], v[48:51], v[108:111]
  v_add_f32 v140, v140, v142
  s_waitcnt vmcnt(23)
  s_waitcnt lgkmcnt(0)
  v_mfma_f32_16x16x32_bf16 v[72:75], a[136:139], v[52:55], v[72:75]
  ds_read_b128 v[32:35], v7 offset:26624
  v_mfma_f32_16x16x32_bf16 v[92:95], a[140:143], v[52:55], v[92:95]
  ds_read_b128 v[36:39], v7 offset:27648
  v_add_f32 v141, v141, v143
  v_mfma_f32_16x16x32_bf16 v[76:79], a[136:139], v[56:59], v[76:79]
  ds_read_b128 v[40:43], v7 offset:28672
  v_mfma_f32_16x16x32_bf16 v[96:99], a[140:143], v[56:59], v[96:99]
  ds_read_b128 v[44:47], v7 offset:29696
  v_mul_f32 v140, 0x3acccccd, v140
  v_mfma_f32_16x16x32_bf16 v[80:83], a[136:139], v[60:63], v[80:83]
  ds_read_b128 v[48:51], v7 offset:30720
  v_mfma_f32_16x16x32_bf16 v[100:103], a[140:143], v[60:63], v[100:103]
  s_add_u32 s59, s49, 4096
  buffer_load_dwordx4 a[176:179], v5, s[12:15], s59 offen offset:0
  v_mul_f32 v141, 0x3acccccd, v141
  v_mfma_f32_16x16x32_bf16 v[84:87], a[136:139], v[64:67], v[84:87]
  buffer_load_dwordx4 a[180:183], v5, s[12:15], s59 offen offset:1024
  v_fma_f32 v141, -v140, v140, v141
  v_mfma_f32_16x16x32_bf16 v[104:107], a[140:143], v[64:67], v[104:107]
  buffer_load_dwordx4 a[184:187], v5, s[12:15], s59 offen offset:2048
  v_max_f32 v141, 0, v141
  v_mfma_f32_16x16x32_bf16 v[88:91], a[136:139], v[68:71], v[88:91]
  v_add_f32 v141, 0x3727c5ac, v141
  v_mfma_f32_16x16x32_bf16 v[108:111], a[140:143], v[68:71], v[108:111]
  v_rsq_f32 v165, v141
  s_waitcnt vmcnt(24)
  s_waitcnt lgkmcnt(0)
  v_mfma_f32_16x16x32_bf16 v[72:75], a[144:147], v[32:35], v[72:75]
  ds_read_b128 v[52:55], v7 offset:31744
  v_mfma_f32_16x16x32_bf16 v[92:95], a[148:151], v[32:35], v[92:95]
  ds_read_b128 v[56:59], v7 offset:32768
  v_mul_f32 v167, v140, v165
  v_mfma_f32_16x16x32_bf16 v[76:79], a[144:147], v[36:39], v[76:79]
  ds_read_b128 v[60:63], v7 offset:33792
  v_mfma_f32_16x16x32_bf16 v[96:99], a[148:151], v[36:39], v[96:99]
  ds_read_b128 v[64:67], v7 offset:34816
  v_sub_f32 v167, 0, v167
  v_mfma_f32_16x16x32_bf16 v[80:83], a[144:147], v[40:43], v[80:83]
  ds_read_b128 v[68:71], v7 offset:35840
  v_mfma_f32_16x16x32_bf16 v[100:103], a[148:151], v[40:43], v[100:103]
  buffer_load_dwordx4 a[188:191], v5, s[12:15], s59 offen offset:3072
  v_lshlrev_b32 v10, 4, v3
  v_mfma_f32_16x16x32_bf16 v[84:87], a[144:147], v[44:47], v[84:87]
  s_add_u32 s59, s49, 8192
  buffer_load_dwordx4 a[192:195], v5, s[12:15], s59 offen offset:0
  v_add_u32 v11, 4, v10
  v_mfma_f32_16x16x32_bf16 v[104:107], a[148:151], v[44:47], v[104:107]
  buffer_load_dwordx4 a[196:199], v5, s[12:15], s59 offen offset:1024
  v_add_u32 v12, 8, v10
  v_mfma_f32_16x16x32_bf16 v[88:91], a[144:147], v[48:51], v[88:91]
  v_add_u32 v13, 12, v10
  v_mfma_f32_16x16x32_bf16 v[108:111], a[148:151], v[48:51], v[108:111]
  ds_bpermute_b32 v168, v10, v164
  s_waitcnt vmcnt(25)
  s_waitcnt lgkmcnt(1)
  v_mfma_f32_16x16x32_bf16 v[72:75], a[152:155], v[52:55], v[72:75]
  v_mfma_f32_16x16x32_bf16 v[92:95], a[156:159], v[52:55], v[92:95]
  ds_bpermute_b32 v176, v10, v166
  v_mfma_f32_16x16x32_bf16 v[76:79], a[152:155], v[56:59], v[76:79]
  v_mfma_f32_16x16x32_bf16 v[96:99], a[156:159], v[56:59], v[96:99]
  ds_bpermute_b32 v169, v11, v164
  v_mfma_f32_16x16x32_bf16 v[80:83], a[152:155], v[60:63], v[80:83]
  v_mfma_f32_16x16x32_bf16 v[100:103], a[156:159], v[60:63], v[100:103]
  buffer_load_dwordx4 a[200:203], v5, s[12:15], s59 offen offset:2048
  ds_bpermute_b32 v177, v11, v166
  v_mfma_f32_16x16x32_bf16 v[84:87], a[152:155], v[64:67], v[84:87]
  buffer_load_dwordx4 a[204:207], v5, s[12:15], s59 offen offset:3072
  ds_bpermute_b32 v170, v12, v164
  v_mfma_f32_16x16x32_bf16 v[104:107], a[156:159], v[64:67], v[104:107]
  ds_bpermute_b32 v178, v12, v166
  v_mfma_f32_16x16x32_bf16 v[88:91], a[152:155], v[68:71], v[88:91]
  ds_bpermute_b32 v171, v13, v164
  v_mfma_f32_16x16x32_bf16 v[108:111], a[156:159], v[68:71], v[108:111]
  ds_bpermute_b32 v179, v13, v166
  ds_bpermute_b32 v172, v10, v165
  ds_bpermute_b32 v180, v10, v167
  ds_bpermute_b32 v173, v11, v165
  ds_bpermute_b32 v181, v11, v167
  ds_bpermute_b32 v174, v12, v165
  ds_bpermute_b32 v182, v12, v167
  ds_bpermute_b32 v175, v13, v165
  ds_bpermute_b32 v183, v13, v167
  s_waitcnt lgkmcnt(0)
  v_pk_mul_f32 v[184:185], v[176:177], v[144:145] op_sel:[0,0] op_sel_hi:[1,0]
  v_pk_mul_f32 v[186:187], v[178:179], v[144:145] op_sel:[0,0] op_sel_hi:[1,0]
  v_pk_mul_f32 v[188:189], v[180:181], v[144:145] op_sel:[0,0] op_sel_hi:[1,0]
  v_pk_mul_f32 v[190:191], v[182:183], v[144:145] op_sel:[0,0] op_sel_hi:[1,0]
  v_pk_fma_f32 v[72:73], v[168:169], v[72:73], v[184:185]
  v_pk_fma_f32 v[74:75], v[170:171], v[74:75], v[186:187]
  v_pk_fma_f32 v[92:93], v[172:173], v[92:93], v[188:189]
  v_pk_fma_f32 v[94:95], v[174:175], v[94:95], v[190:191]
  s_add_u32 s59, s49, 12288
  buffer_load_dwordx4 a[208:211], v5, s[12:15], s59 offen offset:0
  buffer_load_dwordx4 a[212:215], v5, s[12:15], s59 offen offset:1024
  v_pk_mul_f32 v[184:185], v[72:73], s[72:73]
  v_pk_mul_f32 v[186:187], v[74:75], s[72:73]
  v_pk_mul_f32 v[188:189], v[92:93], s[72:73]
  v_pk_mul_f32 v[190:191], v[94:95], s[72:73]
  v_exp_f32_e64 v184, v184 clamp
  v_exp_f32_e64 v185, v185 clamp
  v_exp_f32_e64 v186, v186 clamp
  v_exp_f32_e64 v187, v187 clamp
  v_exp_f32_e64 v188, v188 clamp
  v_exp_f32_e64 v189, v189 clamp
  v_exp_f32_e64 v190, v190 clamp
  v_exp_f32_e64 v191, v191 clamp
  v_max_f32 v72, 0, v72
  v_max_f32 v73, 0, v73
  v_max_f32 v74, 0, v74
  v_max_f32 v75, 0, v75
  v_max_f32 v92, 0, v92
  v_max_f32 v93, 0, v93
  v_max_f32 v94, 0, v94
  v_max_f32 v95, 0, v95
  v_pk_add_f32 v[184:185], v[184:185], s[70:71]
  v_pk_add_f32 v[186:187], v[186:187], s[70:71]
  v_pk_add_f32 v[188:189], v[188:189], s[70:71]
  v_pk_add_f32 v[190:191], v[190:191], s[70:71]
  v_pk_add_f32 v[72:73], v[72:73], v[184:185]
  v_pk_add_f32 v[74:75], v[74:75], v[186:187]
  v_pk_add_f32 v[92:93], v[92:93], v[188:189]
  v_pk_add_f32 v[94:95], v[94:95], v[190:191]
  v_cvt_pk_bf16_f32 v200, v72, v73
  v_cvt_pk_bf16_f32 v201, v74, v75
  v_cvt_pk_bf16_f32 v202, v92, v93
  v_cvt_pk_bf16_f32 v203, v94, v95
  buffer_load_dwordx4 a[216:219], v5, s[12:15], s59 offen offset:2048
  v_pk_mul_f32 v[184:185], v[176:177], v[146:147] op_sel:[0,0] op_sel_hi:[1,0]
  v_pk_mul_f32 v[186:187], v[178:179], v[146:147] op_sel:[0,0] op_sel_hi:[1,0]
  v_pk_mul_f32 v[188:189], v[180:181], v[146:147] op_sel:[0,0] op_sel_hi:[1,0]
  v_pk_mul_f32 v[190:191], v[182:183], v[146:147] op_sel:[0,0] op_sel_hi:[1,0]
  v_pk_fma_f32 v[76:77], v[168:169], v[76:77], v[184:185]
  v_pk_fma_f32 v[78:79], v[170:171], v[78:79], v[186:187]
  v_pk_fma_f32 v[96:97], v[172:173], v[96:97], v[188:189]
  v_pk_fma_f32 v[98:99], v[174:175], v[98:99], v[190:191]
  buffer_load_dwordx4 a[220:223], v5, s[12:15], s59 offen offset:3072
  s_add_u32 s59, s49, 16384
  buffer_load_dwordx4 a[224:227], v5, s[12:15], s59 offen offset:0
  v_pk_mul_f32 v[184:185], v[76:77], s[72:73]
  v_pk_mul_f32 v[186:187], v[78:79], s[72:73]
  v_pk_mul_f32 v[188:189], v[96:97], s[72:73]
  v_pk_mul_f32 v[190:191], v[98:99], s[72:73]
  v_exp_f32_e64 v184, v184 clamp
  v_exp_f32_e64 v185, v185 clamp
  v_exp_f32_e64 v186, v186 clamp
  v_exp_f32_e64 v187, v187 clamp
  v_exp_f32_e64 v188, v188 clamp
  v_exp_f32_e64 v189, v189 clamp
  v_exp_f32_e64 v190, v190 clamp
  v_exp_f32_e64 v191, v191 clamp
  v_max_f32 v76, 0, v76
  v_max_f32 v77, 0, v77
  v_max_f32 v78, 0, v78
  v_max_f32 v79, 0, v79
  v_max_f32 v96, 0, v96
  v_max_f32 v97, 0, v97
  v_max_f32 v98, 0, v98
  v_max_f32 v99, 0, v99
  v_pk_add_f32 v[184:185], v[184:185], s[70:71]
  v_pk_add_f32 v[186:187], v[186:187], s[70:71]
  v_pk_add_f32 v[188:189], v[188:189], s[70:71]
  v_pk_add_f32 v[190:191], v[190:191], s[70:71]
  v_pk_add_f32 v[76:77], v[76:77], v[184:185]
  v_pk_add_f32 v[78:79], v[78:79], v[186:187]
  v_pk_add_f32 v[96:97], v[96:97], v[188:189]
  v_pk_add_f32 v[98:99], v[98:99], v[190:191]
  v_cvt_pk_bf16_f32 v204, v76, v77
  v_cvt_pk_bf16_f32 v205, v78, v79
  v_cvt_pk_bf16_f32 v206, v96, v97
  v_cvt_pk_bf16_f32 v207, v98, v99
  buffer_load_dwordx4 a[228:231], v5, s[12:15], s59 offen offset:1024
  v_pk_mul_f32 v[184:185], v[176:177], v[148:149] op_sel:[0,0] op_sel_hi:[1,0]
  v_pk_mul_f32 v[186:187], v[178:179], v[148:149] op_sel:[0,0] op_sel_hi:[1,0]
  v_pk_mul_f32 v[188:189], v[180:181], v[148:149] op_sel:[0,0] op_sel_hi:[1,0]
  v_pk_mul_f32 v[190:191], v[182:183], v[148:149] op_sel:[0,0] op_sel_hi:[1,0]
  v_pk_fma_f32 v[80:81], v[168:169], v[80:81], v[184:185]
  v_pk_fma_f32 v[82:83], v[170:171], v[82:83], v[186:187]
  v_pk_fma_f32 v[100:101], v[172:173], v[100:101], v[188:189]
  v_pk_fma_f32 v[102:103], v[174:175], v[102:103], v[190:191]
  buffer_load_dwordx4 a[232:235], v5, s[12:15], s59 offen offset:2048
  buffer_load_dwordx4 a[236:239], v5, s[12:15], s59 offen offset:3072
  v_mov_b32 v192, v80
  v_mov_b32 v193, v81
  v_mov_b32 v194, v82
  v_mov_b32 v195, v83
  v_mov_b32 v196, v100
  v_mov_b32 v197, v101
  v_mov_b32 v198, v102
  v_mov_b32 v199, v103
  v_pk_mul_f32 v[184:185], v[80:81], s[72:73]
  v_pk_mul_f32 v[186:187], v[82:83], s[72:73]
  v_pk_mul_f32 v[188:189], v[100:101], s[72:73]
  v_pk_mul_f32 v[190:191], v[102:103], s[72:73]
  v_exp_f32_e64 v184, v184 clamp
  v_exp_f32_e64 v185, v185 clamp
  v_exp_f32_e64 v186, v186 clamp
  v_exp_f32_e64 v187, v187 clamp
  v_exp_f32_e64 v188, v188 clamp
  v_exp_f32_e64 v189, v189 clamp
  v_exp_f32_e64 v190, v190 clamp
  v_exp_f32_e64 v191, v191 clamp
  v_max_f32 v80, 0, v80
  v_max_f32 v81, 0, v81
  v_max_f32 v82, 0, v82
  v_max_f32 v83, 0, v83
  v_max_f32 v100, 0, v100
  v_max_f32 v101, 0, v101
  v_max_f32 v102, 0, v102
  v_max_f32 v103, 0, v103
  v_pk_add_f32 v[184:185], v[184:185], s[70:71]
  v_pk_add_f32 v[186:187], v[186:187], s[70:71]
  v_pk_add_f32 v[188:189], v[188:189], s[70:71]
  v_pk_add_f32 v[190:191], v[190:191], s[70:71]
  v_pk_add_f32 v[80:81], v[80:81], v[184:185]
  v_pk_add_f32 v[82:83], v[82:83], v[186:187]
  v_pk_add_f32 v[100:101], v[100:101], v[188:189]
  v_pk_add_f32 v[102:103], v[102:103], v[190:191]
  v_cndmask_b32 v80, v192, v80, s[64:65]
  v_cndmask_b32 v81, v193, v81, s[64:65]
  v_cndmask_b32 v82, v194, v82, s[64:65]
  v_cndmask_b32 v83, v195, v83, s[64:65]
  v_cndmask_b32 v100, v196, v100, s[64:65]
  v_cndmask_b32 v101, v197, v101, s[64:65]
  v_cndmask_b32 v102, v198, v102, s[64:65]
  v_cndmask_b32 v103, v199, v103, s[64:65]
  v_cvt_pk_bf16_f32 v208, v80, v81
  v_cvt_pk_bf16_f32 v209, v82, v83
  v_cvt_pk_bf16_f32 v210, v100, v101
  v_cvt_pk_bf16_f32 v211, v102, v103
  s_add_u32 s59, s49, 20480
  buffer_load_dwordx4 a[240:243], v5, s[12:15], s59 offen offset:0
  v_pk_mul_f32 v[184:185], v[176:177], v[150:151] op_sel:[0,0] op_sel_hi:[1,0]
  v_pk_mul_f32 v[186:187], v[178:179], v[150:151] op_sel:[0,0] op_sel_hi:[1,0]
  v_pk_mul_f32 v[188:189], v[180:181], v[150:151] op_sel:[0,0] op_sel_hi:[1,0]
  v_pk_mul_f32 v[190:191], v[182:183], v[150:151] op_sel:[0,0] op_sel_hi:[1,0]
  v_pk_fma_f32 v[84:85], v[168:169], v[84:85], v[184:185]
  v_pk_fma_f32 v[86:87], v[170:171], v[86:87], v[186:187]
  v_pk_fma_f32 v[104:105], v[172:173], v[104:105], v[188:189]
  v_pk_fma_f32 v[106:107], v[174:175], v[106:107], v[190:191]
  buffer_load_dwordx4 a[244:247], v5, s[12:15], s59 offen offset:1024
  buffer_load_dwordx4 a[248:251], v5, s[12:15], s59 offen offset:2048
  v_cvt_pk_bf16_f32 v212, v84, v85
  v_cvt_pk_bf16_f32 v213, v86, v87
  v_cvt_pk_bf16_f32 v214, v104, v105
  v_cvt_pk_bf16_f32 v215, v106, v107
  buffer_load_dwordx4 a[252:255], v5, s[12:15], s59 offen offset:3072
  v_pk_mul_f32 v[184:185], v[176:177], v[150:151] op_sel:[0,1] op_sel_hi:[1,1]
  v_pk_mul_f32 v[186:187], v[178:179], v[150:151] op_sel:[0,1] op_sel_hi:[1,1]
  v_pk_mul_f32 v[188:189], v[180:181], v[150:151] op_sel:[0,1] op_sel_hi:[1,1]
  v_pk_mul_f32 v[190:191], v[182:183], v[150:151] op_sel:[0,1] op_sel_hi:[1,1]
  v_pk_fma_f32 v[88:89], v[168:169], v[88:89], v[184:185]
  v_pk_fma_f32 v[90:91], v[170:171], v[90:91], v[186:187]
  v_pk_fma_f32 v[108:109], v[172:173], v[108:109], v[188:189]
  v_pk_fma_f32 v[110:111], v[174:175], v[110:111], v[190:191]
  s_add_u32 s59, s49, 24576
  buffer_load_dwordx4 v[252:255], v5, s[12:15], s59 offen offset:0
  v_cvt_pk_bf16_f32 v216, v88, v89
  v_cvt_pk_bf16_f32 v217, v90, v91
  v_cvt_pk_bf16_f32 v218, v108, v109
  v_cvt_pk_bf16_f32 v219, v110, v111
  v_mfma_f32_16x16x32_bf16 v[32:35], v[200:203], v[208:211], 0
  v_mfma_f32_16x16x32_bf16 v[36:39], v[200:203], v[212:215], 0
  v_mfma_f32_16x16x32_bf16 v[40:43], v[204:207], v[208:211], 0
  v_mfma_f32_16x16x32_bf16 v[44:47], v[204:207], v[212:215], 0
  v_mfma_f32_16x16x32_bf16 v[48:51], v[204:207], v[216:219], 0
  v_mfma_f32_16x16x32_bf16 v[52:55], v[208:211], v[212:215], 0
  v_mfma_f32_16x16x32_bf16 v[56:59], v[208:211], v[216:219], 0
  v_mfma_f32_16x16x32_bf16 v[60:63], v[200:203], v[220:223], 0
  v_mfma_f32_16x16x32_bf16 v[64:67], v[204:207], v[220:223], 0
  v_mfma_f32_16x16x32_bf16 v[68:71], v[208:211], v[220:223], 0
  s_cmp_lg_u32 s9, 0
  s_cbranch_scc1 JU_5
  s_cmp_eq_u32 s80, 0
  s_cbranch_scc1 JU_5
  s_waitcnt vmcnt(26)
  ds_read_b64_tr_b16 v[112:113], v229 offset:0
  ds_read_b64_tr_b16 v[114:115], v229 offset:4096
  ds_read_b64_tr_b16 v[116:117], v229 offset:32
  ds_read_b64_tr_b16 v[118:119], v229 offset:4128
  ds_read_b64_tr_b16 v[120:121], v229 offset:64
  ds_read_b64_tr_b16 v[122:123], v229 offset:4160
  ds_read_b64_tr_b16 v[124:125], v229 offset:96
  ds_read_b64_tr_b16 v[126:127], v229 offset:4192
  ds_read_b64_tr_b16 v[128:129], v230 offset:0
  ds_read_b64_tr_b16 v[130:131], v230 offset:4096
  ds_read_b64_tr_b16 v[132:133], v229 offset:160
  ds_read_b64_tr_b16 v[134:135], v229 offset:4256
  ds_read_b64_tr_b16 v[224:225], v231 offset:0
  ds_read_b64_tr_b16 v[226:227], v231 offset:4096
  v_cmp_gt_u32 s[100:101], s100, v3
  s_waitcnt lgkmcnt(0)
  s_nop 0
  v_cndmask_b32 v112, 0, v112, s[100:101]
  v_cndmask_b32 v113, 0, v113, s[100:101]
  v_cndmask_b32 v114, 0, v114, s[100:101]
  v_cndmask_b32 v115, 0, v115, s[100:101]
  buffer_store_dwordx4 v[112:115], v5, s[12:15], s68 offen offset:0 sc1
  v_cndmask_b32 v116, 0, v116, s[100:101]
  v_cndmask_b32 v117, 0, v117, s[100:101]
  v_cndmask_b32 v118, 0, v118, s[100:101]
  v_cndmask_b32 v119, 0, v119, s[100:101]
  buffer_store_dwordx4 v[116:119], v5, s[12:15], s68 offen offset:1024 sc1
  v_cndmask_b32 v120, 0, v120, s[100:101]
  v_cndmask_b32 v121, 0, v121, s[100:101]
  v_cndmask_b32 v122, 0, v122, s[100:101]
  v_cndmask_b32 v123, 0, v123, s[100:101]
  buffer_store_dwordx4 v[120:123], v5, s[12:15], s68 offen offset:2048 sc1
  v_cndmask_b32 v124, 0, v124, s[100:101]
  v_cndmask_b32 v125, 0, v125, s[100:101]
  v_cndmask_b32 v126, 0, v126, s[100:101]
  v_cndmask_b32 v127, 0, v127, s[100:101]
  buffer_store_dwordx4 v[124:127], v5, s[12:15], s68 offen offset:3072 sc1
  v_cndmask_b32 v128, 0, v128, s[100:101]
  v_cndmask_b32 v129, 0, v129, s[100:101]
  v_cndmask_b32 v130, 0, v130, s[100:101]
  v_cndmask_b32 v131, 0, v131, s[100:101]
  buffer_store_dwordx4 v[128:131], v5, s[12:15], s69 offen offset:0 sc1
  buffer_store_dwordx4 v[132:135], v232, s[12:15], s69 offen offset:1024 sc1
  v_cmp_gt_u32 s[100:101], 12, v4
  s_nop 1
  v_cndmask_b32 v224, 0, v224, s[100:101]
  v_cndmask_b32 v225, 0, v225, s[100:101]
  v_cndmask_b32 v226, 0, v226, s[100:101]
  v_cndmask_b32 v227, 0, v227, s[100:101]
  buffer_store_dwordx4 v[224:227], v232, s[12:15], s69 offen offset:2048 sc1
JU_5:
  s_barrier
  v_lshlrev_b32 v10, 2, v0
  v_add_u32 v11, 86016, v10
  ds_write_b128 v236, v[32:35]
  ds_write_b128 v237, v[36:39]
  ds_write_b128 v238, v[40:43]
  ds_write_b128 v239, v[44:47]
  ds_write_b128 v240, v[48:51]
  ds_write_b128 v241, v[52:55]
  ds_write_b128 v242, v[56:59]
  ds_write_b128 v243, v[60:63]
  ds_write_b128 v244, v[64:67]
  ds_write_b128 v245, v[68:71]
  s_waitcnt vmcnt(25)
  s_add_u32 m0, s51, 0
  s_add_u32 s53, s52, 0x0
  buffer_load_dwordx4 v5, s[12:15], s53 offen offset:0 lds
  buffer_load_dwordx4 v5, s[12:15], s53 offen offset:1024 lds
  buffer_load_dwordx4 v5, s[12:15], s53 offen offset:2048 lds
  buffer_load_dwordx4 v5, s[12:15], s53 offen offset:3072 lds
  s_waitcnt lgkmcnt(0)
  s_barrier
  ds_read_b32 v184, v11 offset:0
  ds_read_b32 v185, v11 offset:3584
  ds_read_b32 v186, v11 offset:7168
  ds_read_b32 v187, v11 offset:10752
  ds_read_b32 v188, v11 offset:1024
  ds_read_b32 v189, v11 offset:4608
  ds_read_b32 v190, v11 offset:8192
  ds_read_b32 v191, v11 offset:11776
  ds_read_b32 v192, v11 offset:2048
  ds_read_b32 v193, v11 offset:5632
  ds_read_b32 v194, v11 offset:9216
  ds_read_b32 v195, v11 offset:12800
  ds_read_b32 v196, v11 offset:3072
  ds_read_b32 v197, v11 offset:6656
  ds_read_b32 v198, v11 offset:10240
  ds_read_b32 v199, v11 offset:13824
  ds_read_b128 v[32:35], v7 offset:36864
  ds_read_b128 v[36:39], v7 offset:37888
  ds_read_b128 v[40:43], v7 offset:38912
  v_mov_b32 v12, 0x40000000
  v_cmp_gt_u32 vcc, 72, v0
  s_nop 1
  v_cndmask_b32 v11, v12, v10, vcc
  s_waitcnt lgkmcnt(15)
  v_pk_add_f32 v[184:185], v[184:185], v[186:187]
  v_add_f32 v184, v184, v185
  buffer_atomic_add_f32 v184, v10, s[12:15], s29 offen offset:0 sc1
  s_waitcnt lgkmcnt(11)
  v_pk_add_f32 v[188:189], v[188:189], v[190:191]
  v_add_f32 v188, v188, v189
  buffer_atomic_add_f32 v188, v10, s[12:15], s29 offen offset:1024 sc1
  s_waitcnt lgkmcnt(7)
  v_pk_add_f32 v[192:193], v[192:193], v[194:195]
  v_add_f32 v192, v192, v193
  buffer_atomic_add_f32 v192, v10, s[12:15], s29 offen offset:2048 sc1
  s_waitcnt lgkmcnt(3)
  v_pk_add_f32 v[196:197], v[196:197], v[198:199]
  v_add_f32 v196, v196, v197
  buffer_atomic_add_f32 v196, v11, s[12:15], s29 offen offset:3072 sc1
  s_waitcnt lgkmcnt(0)
  v_mfma_f32_16x16x32_bf16 v[112:115], v[32:35], a[0:3], 0
  ds_read_b128 v[44:47], v7 offset:39936
  v_mfma_f32_16x16x32_bf16 v[124:127], v[32:35], a[4:7], 0
  ds_read_b128 v[48:51], v7 offset:40960
  v_mfma_f32_16x16x32_bf16 v[116:119], v[36:39], a[0:3], 0
  ds_read_b128 v[52:55], v7 offset:41984
  v_mfma_f32_16x16x32_bf16 v[128:131], v[36:39], a[4:7], 0
  s_add_u32 m0, s51, 4096
  s_add_u32 s53, s52, 0x1000
  buffer_load_dwordx4 v5, s[12:15], s53 offen offset:0 lds
  v_mfma_f32_16x16x32_bf16 v[120:123], v[40:43], a[0:3], 0
  v_mfma_f32_16x16x32_bf16 v[132:135], v[40:43], a[4:7], 0
  s_waitcnt lgkmcnt(0)
  v_mfma_f32_16x16x32_bf16 v[112:115], v[44:47], a[8:11], v[112:115]
  ds_read_b128 v[32:35], v7 offset:43008
  v_mov_b32 v10, 0x40000000
  v_mfma_f32_16x16x32_bf16 v[124:127], v[44:47], a[12:15], v[124:127]
  ds_read_b128 v[36:39], v7 offset:44032
  v_lshlrev_b32 v184, 4, v3
  v_mfma_f32_16x16x32_bf16 v[116:119], v[48:51], a[8:11], v[116:119]
  ds_read_b128 v[40:43], v7 offset:45056
  v_mov_b32 v11, 64
  v_mfma_f32_16x16x32_bf16 v[128:131], v[48:51], a[12:15], v[128:131]
  buffer_load_dwordx4 v5, s[12:15], s53 offen offset:1024 lds
  v_mfma_f32_16x16x32_bf16 v[120:123], v[52:55], a[8:11], v[120:123]
  v_subrev_u32 v12, 16, v184
  v_cmp_eq_u32 vcc, 0, v3
  s_nop 1
  v_cndmask_b32 v185, v10, v11, vcc
  v_cndmask_b32 v186, v12, v10, vcc
  v_mfma_f32_16x16x32_bf16 v[132:135], v[52:55], a[12:15], v[132:135]
  v_add_u32 v11, 48, v184
  v_cmp_gt_u32 vcc, 2, v3
  s_nop 1
  v_cndmask_b32 v187, v10, v11, vcc
  s_waitcnt lgkmcnt(0)
  v_mfma_f32_16x16x32_bf16 v[112:115], v[32:35], a[16:19], v[112:115]
  ds_read_b128 v[44:47], v7 offset:46080
  v_mul_u32_u24 v188, 80, v4
  v_mfma_f32_16x16x32_bf16 v[124:127], v[32:35], a[20:23], v[124:127]
  ds_read_b128 v[48:51], v7 offset:47104
  v_and_b32 v11, 3, v4
  v_mfma_f32_16x16x32_bf16 v[116:119], v[36:39], a[16:19], v[116:119]
  ds_read_b128 v[52:55], v7 offset:48128
  v_mul_u32_u24 v11, 80, v11
  v_mfma_f32_16x16x32_bf16 v[128:131], v[36:39], a[20:23], v[128:131]
  buffer_load_dwordx4 v5, s[12:15], s53 offen offset:2048 lds
  v_mfma_f32_16x16x32_bf16 v[120:123], v[40:43], a[16:19], v[120:123]
  v_add_u32 v11, 1280, v11
  v_lshrrev_b32 v12, 2, v4
  v_mfma_f32_16x16x32_bf16 v[132:135], v[40:43], a[20:23], v[132:135]
  v_cmp_eq_u32 vcc, 0, v12
  s_nop 1
  v_cndmask_b32 v189, v10, v11, vcc
  v_cmp_eq_u32 vcc, 1, v12
  s_nop 1
  v_cndmask_b32 v190, v10, v11, vcc
  s_waitcnt lgkmcnt(0)
  v_mfma_f32_16x16x32_bf16 v[112:115], v[44:47], a[24:27], v[112:115]
  ds_read_b128 v[32:35], v7 offset:49152
  v_add_u32 v236, v188, v184
  v_mfma_f32_16x16x32_bf16 v[124:127], v[44:47], a[28:31], v[124:127]
  ds_read_b128 v[36:39], v7 offset:50176
  v_add_u32 v237, v188, v185
  v_mfma_f32_16x16x32_bf16 v[116:119], v[48:51], a[24:27], v[116:119]
  ds_read_b128 v[40:43], v7 offset:51200
  v_add_u32 v238, v189, v184
  v_mfma_f32_16x16x32_bf16 v[128:131], v[48:51], a[28:31], v[128:131]
  s_add_u32 m0, s51, 28672
  s_add_u32 s53, s52, 0x7000
  buffer_load_dwordx4 v5, s[12:15], s53 offen offset:0 lds
  v_mfma_f32_16x16x32_bf16 v[120:123], v[52:55], a[24:27], v[120:123]
  v_add_u32 v239, v189, v185
  v_add_u32 v240, v188, v186
  v_mfma_f32_16x16x32_bf16 v[132:135], v[52:55], a[28:31], v[132:135]
  v_add_u32 v241, v188, v187
  v_add_u32 v242, v190, v186
  s_waitcnt lgkmcnt(0)
  v_mfma_f32_16x16x32_bf16 v[112:115], v[32:35], a[32:35], v[112:115]
  ds_read_b128 v[44:47], v7 offset:52224
  v_add_u32 v243, v190, v187
  v_mfma_f32_16x16x32_bf16 v[124:127], v[32:35], a[36:39], v[124:127]
  ds_read_b128 v[48:51], v7 offset:53248
  s_lshr_b32 s30, s5, 2
  v_mfma_f32_16x16x32_bf16 v[116:119], v[36:39], a[32:35], v[116:119]
  ds_read_b128 v[52:55], v7 offset:54272
  s_and_b32 s31, s5, 3
  v_mfma_f32_16x16x32_bf16 v[128:131], v[36:39], a[36:39], v[128:131]
  buffer_load_dwordx4 v5, s[12:15], s53 offen offset:1024 lds
  v_mfma_f32_16x16x32_bf16 v[120:123], v[40:43], a[32:35], v[120:123]
  s_mul_i32 s32, s9, 0x280000
  s_mul_i32 s34, s20, 0x5000
  v_mfma_f32_16x16x32_bf16 v[132:135], v[40:43], a[36:39], v[132:135]
  s_add_u32 s32, s32, s34
  s_mul_i32 s34, s30, 0x1400
  s_waitcnt lgkmcnt(0)
  v_mfma_f32_16x16x32_bf16 v[112:115], v[44:47], a[40:43], v[112:115]
  ds_read_b128 v[32:35], v7 offset:55296
  s_add_u32 s32, s32, s34
  v_mfma_f32_16x16x32_bf16 v[124:127], v[44:47], a[44:47], v[124:127]
  ds_read_b128 v[36:39], v7 offset:56320
  s_add_u32 s32, s32, 0x145e000
  v_mfma_f32_16x16x32_bf16 v[116:119], v[48:51], a[40:43], v[116:119]
  ds_read_b128 v[40:43], v7 offset:57344
  s_lshl_b32 s33, s31, 8
  v_mfma_f32_16x16x32_bf16 v[128:131], v[48:51], a[44:47], v[128:131]
  buffer_load_dwordx4 v5, s[12:15], s53 offen offset:2048 lds
  v_mfma_f32_16x16x32_bf16 v[120:123], v[52:55], a[40:43], v[120:123]
  s_add_u32 s33, s33, s32
  s_add_u32 s33, s33, 2048
  v_mfma_f32_16x16x32_bf16 v[132:135], v[52:55], a[44:47], v[132:135]
  s_cmp_ge_u32 s31, 2
  s_cselect_b32 s34, 1, 0
  s_add_u32 s34, s34, s31
  s_waitcnt lgkmcnt(0)
  v_mfma_f32_16x16x32_bf16 v[112:115], v[32:35], a[48:51], v[112:115]
  ds_read_b128 v[44:47], v7 offset:58368
  s_lshl_b32 s34, s34, 10
  v_mfma_f32_16x16x32_bf16 v[124:127], v[32:35], a[52:55], v[124:127]
  ds_read_b128 v[48:51], v7 offset:59392
  s_add_u32 s32, s32, s34
  v_mfma_f32_16x16x32_bf16 v[116:119], v[36:39], a[48:51], v[116:119]
  ds_read_b128 v[52:55], v7 offset:60416
  v_lshlrev_b32 v11, 4, v4
  v_mfma_f32_16x16x32_bf16 v[128:131], v[36:39], a[52:55], v[128:131]
  buffer_load_dwordx4 v5, s[12:15], s53 offen offset:3072 lds
  v_mfma_f32_16x16x32_bf16 v[120:123], v[40:43], a[48:51], v[120:123]
  v_lshl_add_u32 v11, v3, 3, v11
  v_cmp_gt_u32 vcc, 2, v3
  s_nop 1
  v_cndmask_b32 v244, v10, v11, vcc
  v_mfma_f32_16x16x32_bf16 v[132:135], v[40:43], a[52:55], v[132:135]
  v_cmp_eq_u32 s[64:65], 0, v3
  s_mul_i32 s45, s9, 0x500000
  s_waitcnt lgkmcnt(0)
  v_mfma_f32_16x16x32_bf16 v[112:115], v[44:47], a[56:59], v[112:115]
  ds_read_b128 v[32:35], v7 offset:61440
  s_add_u32 s45, s45, 0xc5e000
  v_mfma_f32_16x16x32_bf16 v[124:127], v[44:47], a[60:63], v[124:127]
  ds_read_b128 v[36:39], v7 offset:62464
  s_add_u32 s44, s45, s66
  v_mfma_f32_16x16x32_bf16 v[116:119], v[48:51], a[56:59], v[116:119]
  ds_read_b128 v[40:43], v7 offset:63488
  s_add_u32 s45, s45, s67
  v_mfma_f32_16x16x32_bf16 v[128:131], v[48:51], a[60:63], v[128:131]
  s_add_u32 m0, s51, 32768
  s_add_u32 s53, s52, 0x8000
  buffer_load_dwordx4 v5, s[12:15], s53 offen offset:0 lds
  v_mfma_f32_16x16x32_bf16 v[120:123], v[52:55], a[56:59], v[120:123]
  v_mfma_f32_16x16x32_bf16 v[132:135], v[52:55], a[60:63], v[132:135]
  s_waitcnt vmcnt(8)
  s_barrier
  s_cmp_lg_u32 s3, 0
  s_cbranch_scc1 W0_6
  v_mov_b32 v26, 1
  buffer_atomic_add v26, v28, s[12:15], s76 offen sc1
W0_6:
  s_or_b32 s74, s9, s3
  s_cmp_lg_u32 s74, 0
  s_cbranch_scc1 JS_7
  s_lshr_b32 s74, s2, 4
  s_lshl_b32 s74, s74, 8
  s_and_b32 s75, s2, 15
  s_lshl_b32 s75, s75, 2
  s_add_u32 s74, s74, s75
  s_add_u32 s74, s74, 0x197c000
  v_mov_b32 v26, 1
  buffer_atomic_add v26, v28, s[12:15], s74 offen sc1
JS_7:
  s_waitcnt lgkmcnt(0)
  v_mfma_f32_16x16x32_bf16 v[112:115], v[32:35], a[64:67], v[112:115]
  ds_read_b128 v[44:47], v7 offset:64512
  v_mfma_f32_16x16x32_bf16 v[124:127], v[32:35], a[68:71], v[124:127]
  ds_read_b128 v[48:51], v8 offset:0
  v_mfma_f32_16x16x32_bf16 v[116:119], v[36:39], a[64:67], v[116:119]
  ds_read_b128 v[52:55], v8 offset:1024
  v_mfma_f32_16x16x32_bf16 v[128:131], v[36:39], a[68:71], v[128:131]
  buffer_load_dwordx4 v5, s[12:15], s53 offen offset:1024 lds
  v_mfma_f32_16x16x32_bf16 v[120:123], v[40:43], a[64:67], v[120:123]
  v_mfma_f32_16x16x32_bf16 v[132:135], v[40:43], a[68:71], v[132:135]
  s_waitcnt lgkmcnt(0)
  v_mfma_f32_16x16x32_bf16 v[112:115], v[44:47], a[72:75], v[112:115]
  ds_read_b128 v[32:35], v8 offset:2048
  v_mfma_f32_16x16x32_bf16 v[124:127], v[44:47], a[76:79], v[124:127]
  ds_read_b128 v[36:39], v8 offset:3072
  v_mfma_f32_16x16x32_bf16 v[116:119], v[48:51], a[72:75], v[116:119]
  ds_read_b128 v[40:43], v8 offset:4096
  v_mfma_f32_16x16x32_bf16 v[128:131], v[48:51], a[76:79], v[128:131]
  buffer_load_dwordx4 v5, s[12:15], s53 offen offset:2048 lds
  v_mfma_f32_16x16x32_bf16 v[120:123], v[52:55], a[72:75], v[120:123]
  v_mfma_f32_16x16x32_bf16 v[132:135], v[52:55], a[76:79], v[132:135]
  s_waitcnt lgkmcnt(0)
  v_mfma_f32_16x16x32_bf16 v[112:115], v[32:35], a[80:83], v[112:115]
  ds_read_b128 v[44:47], v8 offset:5120
  v_mfma_f32_16x16x32_bf16 v[124:127], v[32:35], a[84:87], v[124:127]
  ds_read_b128 v[48:51], v8 offset:6144
  v_mfma_f32_16x16x32_bf16 v[116:119], v[36:39], a[80:83], v[116:119]
  ds_read_b128 v[52:55], v8 offset:7168
  v_mfma_f32_16x16x32_bf16 v[128:131], v[36:39], a[84:87], v[128:131]
  s_add_u32 m0, s51, 57344
  s_add_u32 s53, s52, 0xe000
  buffer_load_dwordx4 v5, s[12:15], s53 offen offset:0 lds
  v_mfma_f32_16x16x32_bf16 v[120:123], v[40:43], a[80:83], v[120:123]
  v_mfma_f32_16x16x32_bf16 v[132:135], v[40:43], a[84:87], v[132:135]
  s_waitcnt lgkmcnt(0)
  v_mfma_f32_16x16x32_bf16 v[112:115], v[44:47], a[88:91], v[112:115]
  ds_read_b128 v[32:35], v8 offset:8192
  v_mfma_f32_16x16x32_bf16 v[124:127], v[44:47], a[92:95], v[124:127]
  ds_read_b128 v[36:39], v8 offset:9216
  v_mfma_f32_16x16x32_bf16 v[116:119], v[48:51], a[88:91], v[116:119]
  ds_read_b128 v[40:43], v8 offset:10240
  v_mfma_f32_16x16x32_bf16 v[128:131], v[48:51], a[92:95], v[128:131]
  buffer_load_dwordx4 v5, s[12:15], s53 offen offset:1024 lds
  v_mfma_f32_16x16x32_bf16 v[120:123], v[52:55], a[88:91], v[120:123]
  v_mfma_f32_16x16x32_bf16 v[132:135], v[52:55], a[92:95], v[132:135]
  s_waitcnt lgkmcnt(0)
  v_mfma_f32_16x16x32_bf16 v[112:115], v[32:35], a[96:99], v[112:115]
  ds_read_b128 v[44:47], v8 offset:11264
  v_mfma_f32_16x16x32_bf16 v[124:127], v[32:35], a[100:103], v[124:127]
  ds_read_b128 v[48:51], v8 offset:12288
  v_mfma_f32_16x16x32_bf16 v[116:119], v[36:39], a[96:99], v[116:119]
  ds_read_b128 v[52:55], v8 offset:13312
  v_mfma_f32_16x16x32_bf16 v[128:131], v[36:39], a[100:103], v[128:131]
  buffer_load_dwordx4 v5, s[12:15], s53 offen offset:2048 lds
  v_mfma_f32_16x16x32_bf16 v[120:123], v[40:43], a[96:99], v[120:123]
  v_mfma_f32_16x16x32_bf16 v[132:135], v[40:43], a[100:103], v[132:135]
  s_waitcnt lgkmcnt(0)
  v_mfma_f32_16x16x32_bf16 v[112:115], v[44:47], a[104:107], v[112:115]
  ds_read_b128 v[32:35], v8 offset:14336
  v_mfma_f32_16x16x32_bf16 v[124:127], v[44:47], a[108:111], v[124:127]
  ds_read_b128 v[36:39], v8 offset:15360
  v_mfma_f32_16x16x32_bf16 v[116:119], v[48:51], a[104:107], v[116:119]
  ds_read_b128 v[40:43], v8 offset:16384
  v_mfma_f32_16x16x32_bf16 v[128:131], v[48:51], a[108:111], v[128:131]
  buffer_load_dwordx4 v5, s[12:15], s53 offen offset:3072 lds
  v_mfma_f32_16x16x32_bf16 v[120:123], v[52:55], a[104:107], v[120:123]
  v_mfma_f32_16x16x32_bf16 v[132:135], v[52:55], a[108:111], v[132:135]
  s_waitcnt lgkmcnt(0)
  v_mfma_f32_16x16x32_bf16 v[112:115], v[32:35], a[112:115], v[112:115]
  ds_read_b128 v[44:47], v8 offset:17408
  v_mfma_f32_16x16x32_bf16 v[124:127], v[32:35], a[116:119], v[124:127]
  ds_read_b128 v[48:51], v8 offset:18432
  v_mfma_f32_16x16x32_bf16 v[116:119], v[36:39], a[112:115], v[116:119]
  ds_read_b128 v[52:55], v8 offset:19456
  v_mfma_f32_16x16x32_bf16 v[128:131], v[36:39], a[116:119], v[128:131]
  s_add_u32 m0, s51, 61440
  s_add_u32 s53, s52, 0xf000
  buffer_load_dwordx4 v5, s[12:15], s53 offen offset:0 lds
  v_mfma_f32_16x16x32_bf16 v[120:123], v[40:43], a[112:115], v[120:123]
  v_mfma_f32_16x16x32_bf16 v[132:135], v[40:43], a[116:119], v[132:135]
  s_waitcnt lgkmcnt(0)
  v_mfma_f32_16x16x32_bf16 v[112:115], v[44:47], a[120:123], v[112:115]
  ds_read_b128 v[32:35], v8 offset:20480
  v_mfma_f32_16x16x32_bf16 v[124:127], v[44:47], a[124:127], v[124:127]
  ds_read_b128 v[36:39], v8 offset:21504
  v_mfma_f32_16x16x32_bf16 v[116:119], v[48:51], a[120:123], v[116:119]
  ds_read_b128 v[40:43], v8 offset:22528
  v_mfma_f32_16x16x32_bf16 v[128:131], v[48:51], a[124:127], v[128:131]
  buffer_load_dwordx4 v5, s[12:15], s53 offen offset:1024 lds
  v_mfma_f32_16x16x32_bf16 v[120:123], v[52:55], a[120:123], v[120:123]
  v_mfma_f32_16x16x32_bf16 v[132:135], v[52:55], a[124:127], v[132:135]
  s_waitcnt lgkmcnt(0)
  v_mfma_f32_16x16x32_bf16 v[112:115], v[32:35], a[128:131], v[112:115]
  ds_read_b128 v[44:47], v8 offset:23552
  v_mfma_f32_16x16x32_bf16 v[124:127], v[32:35], a[132:135], v[124:127]
  ds_read_b128 v[48:51], v8 offset:24576
  v_mfma_f32_16x16x32_bf16 v[116:119], v[36:39], a[128:131], v[116:119]
  ds_read_b128 v[52:55], v8 offset:25600
  v_mfma_f32_16x16x32_bf16 v[128:131], v[36:39], a[132:135], v[128:131]
  buffer_load_dwordx4 v5, s[12:15], s53 offen offset:2048 lds
  v_mfma_f32_16x16x32_bf16 v[120:123], v[40:43], a[128:131], v[120:123]
  v_mfma_f32_16x16x32_bf16 v[132:135], v[40:43], a[132:135], v[132:135]
  s_cmp_lg_u32 s3, 0
  s_cbranch_scc1 W0_8
  buffer_load_dword v27, v29, s[12:15], s77 offen sc1
W0_8:
  s_waitcnt lgkmcnt(0)
  v_mfma_f32_16x16x32_bf16 v[112:115], v[44:47], a[136:139], v[112:115]
  ds_read_b128 v[32:35], v8 offset:26624
  v_mfma_f32_16x16x32_bf16 v[124:127], v[44:47], a[140:143], v[124:127]
  ds_read_b128 v[36:39], v8 offset:27648
  v_mfma_f32_16x16x32_bf16 v[116:119], v[48:51], a[136:139], v[116:119]
  ds_read_b128 v[40:43], v8 offset:28672
  v_mfma_f32_16x16x32_bf16 v[128:131], v[48:51], a[140:143], v[128:131]
  v_mfma_f32_16x16x32_bf16 v[120:123], v[52:55], a[136:139], v[120:123]
  v_mfma_f32_16x16x32_bf16 v[132:135], v[52:55], a[140:143], v[132:135]
  s_waitcnt lgkmcnt(0)
  v_mfma_f32_16x16x32_bf16 v[112:115], v[32:35], a[144:147], v[112:115]
  ds_read_b128 v[44:47], v8 offset:29696
  v_mfma_f32_16x16x32_bf16 v[124:127], v[32:35], a[148:151], v[124:127]
  ds_read_b128 v[48:51], v8 offset:30720
  v_mfma_f32_16x16x32_bf16 v[116:119], v[36:39], a[144:147], v[116:119]
  ds_read_b128 v[52:55], v8 offset:31744
  v_mfma_f32_16x16x32_bf16 v[128:131], v[36:39], a[148:151], v[128:131]
  v_mfma_f32_16x16x32_bf16 v[120:123], v[40:43], a[144:147], v[120:123]
  v_mfma_f32_16x16x32_bf16 v[132:135], v[40:43], a[148:151], v[132:135]
  s_waitcnt lgkmcnt(0)
  v_mfma_f32_16x16x32_bf16 v[112:115], v[44:47], a[152:155], v[112:115]
  v_mfma_f32_16x16x32_bf16 v[124:127], v[44:47], a[156:159], v[124:127]
  v_mfma_f32_16x16x32_bf16 v[116:119], v[48:51], a[152:155], v[116:119]
  v_mfma_f32_16x16x32_bf16 v[128:131], v[48:51], a[156:159], v[128:131]
  v_mfma_f32_16x16x32_bf16 v[120:123], v[52:55], a[152:155], v[120:123]
  v_mfma_f32_16x16x32_bf16 v[132:135], v[52:55], a[156:159], v[132:135]
  s_cmp_lg_u32 s3, 0
  s_cbranch_scc1 W0_9
  s_waitcnt vmcnt(0)
  v_cmp_gt_u32 vcc, s22, v27
  s_cmp_eq_u64 vcc, 0
  s_cbranch_scc1 W0_9
  s_mov_b32 s74, 0
PL_10:
  buffer_load_dword v26, v29, s[12:15], s77 offen sc1
  s_waitcnt vmcnt(0)
  v_cmp_gt_u32 vcc, s22, v26
  s_cmp_eq_u64 vcc, 0
  s_cbranch_scc1 PD_11
  s_add_u32 s74, s74, 1
  s_cmp_lt_u32 s74, 0x40000
  s_cbranch_scc1 PL_10
PD_11:
W0_9:
  s_barrier
  buffer_load_dwordx4 v[48:51], v184, s[12:15], s29 offen offset:1600 sc1
  buffer_load_dwordx4 v[52:55], v185, s[12:15], s29 offen offset:1600 sc1
  buffer_load_dwordx4 v[32:35], v236, s[12:15], s29 offen offset:0 sc1
  buffer_load_dwordx4 v[36:39], v237, s[12:15], s29 offen offset:0 sc1
  buffer_load_dwordx4 v[40:43], v238, s[12:15], s29 offen offset:0 sc1
  buffer_load_dwordx4 v[44:47], v239, s[12:15], s29 offen offset:0 sc1
  buffer_load_dwordx4 v[72:75], v186, s[12:15], s29 offen offset:3280 sc1
  buffer_load_dwordx4 v[76:79], v187, s[12:15], s29 offen offset:3280 sc1
  buffer_load_dwordx4 v[56:59], v240, s[12:15], s29 offen offset:1680 sc1
  buffer_load_dwordx4 v[60:63], v241, s[12:15], s29 offen offset:1680 sc1
  buffer_load_dwordx4 v[64:67], v242, s[12:15], s29 offen offset:1680 sc1
  buffer_load_dwordx4 v[68:71], v243, s[12:15], s29 offen offset:1680 sc1
  v_pk_mul_f32 v[136:137], v[152:153], v[166:167] op_sel:[0,0] op_sel_hi:[1,0]
  v_pk_mul_f32 v[138:139], v[154:155], v[166:167] op_sel:[0,0] op_sel_hi:[1,0]
  v_pk_mul_f32 v[140:141], v[152:153], v[166:167] op_sel:[0,1] op_sel_hi:[1,1]
  v_pk_mul_f32 v[142:143], v[154:155], v[166:167] op_sel:[0,1] op_sel_hi:[1,1]
  v_pk_fma_f32 v[112:113], v[112:113], v[164:165], v[136:137] op_sel:[0,0,0] op_sel_hi:[1,0,1]
  v_pk_fma_f32 v[114:115], v[114:115], v[164:165], v[138:139] op_sel:[0,0,0] op_sel_hi:[1,0,1]
  v_pk_fma_f32 v[124:125], v[124:125], v[164:165], v[140:141] op_sel:[0,1,0] op_sel_hi:[1,1,1]
  v_pk_fma_f32 v[126:127], v[126:127], v[164:165], v[142:143] op_sel:[0,1,0] op_sel_hi:[1,1,1]
  v_pk_mul_f32 v[136:137], v[112:113], s[72:73]
  v_pk_mul_f32 v[138:139], v[114:115], s[72:73]
  v_pk_mul_f32 v[140:141], v[124:125], s[72:73]
  v_pk_mul_f32 v[142:143], v[126:127], s[72:73]
  v_exp_f32_e64 v136, v136 clamp
  v_exp_f32_e64 v137, v137 clamp
  v_exp_f32_e64 v138, v138 clamp
  v_exp_f32_e64 v139, v139 clamp
  v_exp_f32_e64 v140, v140 clamp
  v_exp_f32_e64 v141, v141 clamp
  v_exp_f32_e64 v142, v142 clamp
  v_exp_f32_e64 v143, v143 clamp
  v_max_f32 v112, 0, v112
  v_max_f32 v113, 0, v113
  v_max_f32 v114, 0, v114
  v_max_f32 v115, 0, v115
  v_max_f32 v124, 0, v124
  v_max_f32 v125, 0, v125
  v_max_f32 v126, 0, v126
  v_max_f32 v127, 0, v127
  v_pk_add_f32 v[136:137], v[136:137], s[70:71]
  v_pk_add_f32 v[138:139], v[138:139], s[70:71]
  v_pk_add_f32 v[140:141], v[140:141], s[70:71]
  v_pk_add_f32 v[142:143], v[142:143], s[70:71]
  v_pk_add_f32 v[112:113], v[112:113], v[136:137]
  v_pk_add_f32 v[114:115], v[114:115], v[138:139]
  v_pk_add_f32 v[124:125], v[124:125], v[140:141]
  v_pk_add_f32 v[126:127], v[126:127], v[142:143]
  v_cvt_pk_bf16_f32 v224, v112, v113
  v_cvt_pk_bf16_f32 v225, v114, v115
  v_cvt_pk_bf16_f32 v230, v124, v125
  v_cvt_pk_bf16_f32 v231, v126, v127
  v_pk_mul_f32 v[136:137], v[156:157], v[166:167] op_sel:[0,0] op_sel_hi:[1,0]
  v_pk_mul_f32 v[138:139], v[158:159], v[166:167] op_sel:[0,0] op_sel_hi:[1,0]
  v_pk_mul_f32 v[140:141], v[156:157], v[166:167] op_sel:[0,1] op_sel_hi:[1,1]
  v_pk_mul_f32 v[142:143], v[158:159], v[166:167] op_sel:[0,1] op_sel_hi:[1,1]
  v_pk_fma_f32 v[116:117], v[116:117], v[164:165], v[136:137] op_sel:[0,0,0] op_sel_hi:[1,0,1]
  v_pk_fma_f32 v[118:119], v[118:119], v[164:165], v[138:139] op_sel:[0,0,0] op_sel_hi:[1,0,1]
  v_pk_fma_f32 v[128:129], v[128:129], v[164:165], v[140:141] op_sel:[0,1,0] op_sel_hi:[1,1,1]
  v_pk_fma_f32 v[130:131], v[130:131], v[164:165], v[142:143] op_sel:[0,1,0] op_sel_hi:[1,1,1]
  v_pk_mul_f32 v[136:137], v[116:117], s[72:73]
  v_pk_mul_f32 v[138:139], v[118:119], s[72:73]
  v_pk_mul_f32 v[140:141], v[128:129], s[72:73]
  v_pk_mul_f32 v[142:143], v[130:131], s[72:73]
  v_exp_f32_e64 v136, v136 clamp
  v_exp_f32_e64 v137, v137 clamp
  v_exp_f32_e64 v138, v138 clamp
  v_exp_f32_e64 v139, v139 clamp
  v_exp_f32_e64 v140, v140 clamp
  v_exp_f32_e64 v141, v141 clamp
  v_exp_f32_e64 v142, v142 clamp
  v_exp_f32_e64 v143, v143 clamp
  v_max_f32 v116, 0, v116
  v_max_f32 v117, 0, v117
  v_max_f32 v118, 0, v118
  v_max_f32 v119, 0, v119
  v_max_f32 v128, 0, v128
  v_max_f32 v129, 0, v129
  v_max_f32 v130, 0, v130
  v_max_f32 v131, 0, v131
  v_pk_add_f32 v[136:137], v[136:137], s[70:71]
  v_pk_add_f32 v[138:139], v[138:139], s[70:71]
  v_pk_add_f32 v[140:141], v[140:141], s[70:71]
  v_pk_add_f32 v[142:143], v[142:143], s[70:71]
  v_pk_add_f32 v[116:117], v[116:117], v[136:137]
  v_pk_add_f32 v[118:119], v[118:119], v[138:139]
  v_pk_add_f32 v[128:129], v[128:129], v[140:141]
  v_pk_add_f32 v[130:131], v[130:131], v[142:143]
  v_cvt_pk_bf16_f32 v226, v116, v117
  v_cvt_pk_bf16_f32 v227, v118, v119
  v_cvt_pk_bf16_f32 v232, v128, v129
  v_cvt_pk_bf16_f32 v233, v130, v131
  v_pk_mul_f32 v[136:137], v[160:161], v[166:167] op_sel:[0,0] op_sel_hi:[1,0]
  v_pk_mul_f32 v[138:139], v[162:163], v[166:167] op_sel:[0,0] op_sel_hi:[1,0]
  v_pk_mul_f32 v[140:141], v[160:161], v[166:167] op_sel:[0,1] op_sel_hi:[1,1]
  v_pk_mul_f32 v[142:143], v[162:163], v[166:167] op_sel:[0,1] op_sel_hi:[1,1]
  v_pk_fma_f32 v[120:121], v[120:121], v[164:165], v[136:137] op_sel:[0,0,0] op_sel_hi:[1,0,1]
  v_pk_fma_f32 v[122:123], v[122:123], v[164:165], v[138:139] op_sel:[0,0,0] op_sel_hi:[1,0,1]
  v_pk_fma_f32 v[132:133], v[132:133], v[164:165], v[140:141] op_sel:[0,1,0] op_sel_hi:[1,1,1]
  v_pk_fma_f32 v[134:135], v[134:135], v[164:165], v[142:143] op_sel:[0,1,0] op_sel_hi:[1,1,1]
  v_pk_mul_f32 v[136:137], v[120:121], s[72:73]
  v_pk_mul_f32 v[138:139], v[122:123], s[72:73]
  v_pk_mul_f32 v[140:141], v[132:133], s[72:73]
  v_pk_mul_f32 v[142:143], v[134:135], s[72:73]
  v_exp_f32_e64 v136, v136 clamp
  v_exp_f32_e64 v137, v137 clamp
  v_exp_f32_e64 v138, v138 clamp
  v_exp_f32_e64 v139, v139 clamp
  v_exp_f32_e64 v140, v140 clamp
  v_exp_f32_e64 v141, v141 clamp
  v_exp_f32_e64 v142, v142 clamp
  v_exp_f32_e64 v143, v143 clamp
  v_max_f32 v120, 0, v120
  v_max_f32 v121, 0, v121
  v_max_f32 v122, 0, v122
  v_max_f32 v123, 0, v123
  v_max_f32 v132, 0, v132
  v_max_f32 v133, 0, v133
  v_max_f32 v134, 0, v134
  v_max_f32 v135, 0, v135
  v_pk_add_f32 v[136:137], v[136:137], s[70:71]
  v_pk_add_f32 v[138:139], v[138:139], s[70:71]
  v_pk_add_f32 v[140:141], v[140:141], s[70:71]
  v_pk_add_f32 v[142:143], v[142:143], s[70:71]
  v_pk_add_f32 v[120:121], v[120:121], v[136:137]
  v_pk_add_f32 v[122:123], v[122:123], v[138:139]
  v_pk_add_f32 v[132:133], v[132:133], v[140:141]
  v_pk_add_f32 v[134:135], v[134:135], v[142:143]
  v_cvt_pk_bf16_f32 v228, v120, v121
  v_cvt_pk_bf16_f32 v229, v122, v123
  v_cvt_pk_bf16_f32 v234, v132, v133
  v_cvt_pk_bf16_f32 v235, v134, v135
  s_waitcnt vmcnt(0)
  v_cvt_pk_bf16_f32 v48, v48, v49
  v_cvt_pk_bf16_f32 v49, v50, v51
  v_cvt_pk_bf16_f32 v50, v52, v53
  v_cvt_pk_bf16_f32 v51, v54, v55
  v_cvt_pk_bf16_f32 v72, v72, v73
  v_cvt_pk_bf16_f32 v73, v74, v75
  v_cvt_pk_bf16_f32 v74, v76, v77
  v_cvt_pk_bf16_f32 v75, v78, v79
  v_cvt_pk_bf16_f32 v32, v32, v33
  v_cvt_pk_bf16_f32 v33, v34, v35
  v_cvt_pk_bf16_f32 v34, v36, v37
  v_cvt_pk_bf16_f32 v35, v38, v39
  v_cvt_pk_bf16_f32 v56, v56, v57
  v_cvt_pk_bf16_f32 v57, v58, v59
  v_cvt_pk_bf16_f32 v58, v60, v61
  v_cvt_pk_bf16_f32 v59, v62, v63
  v_cvt_pk_bf16_f32 v40, v40, v41
  v_cvt_pk_bf16_f32 v41, v42, v43
  v_cvt_pk_bf16_f32 v42, v44, v45
  v_cvt_pk_bf16_f32 v43, v46, v47
  v_cvt_pk_bf16_f32 v64, v64, v65
  v_cvt_pk_bf16_f32 v65, v66, v67
  v_cvt_pk_bf16_f32 v66, v68, v69
  v_cvt_pk_bf16_f32 v67, v70, v71
  v_mfma_f32_16x16x32_bf16 v[92:95], v[48:51], v[224:227], 0
  v_mfma_f32_16x16x32_bf16 v[96:99], v[72:75], v[226:229], 0
  v_mfma_f32_16x16x32_bf16 v[112:115], v[48:51], v[230:233], 0
  v_mfma_f32_16x16x32_bf16 v[116:119], v[72:75], v[232:235], 0
  v_mfma_f32_16x16x32_bf16 v[80:83], v[32:35], v[224:227], 0
  v_mfma_f32_16x16x32_bf16 v[84:87], v[56:59], v[226:229], 0
  v_mfma_f32_16x16x32_bf16 v[100:103], v[32:35], v[230:233], 0
  v_mfma_f32_16x16x32_bf16 v[104:107], v[56:59], v[232:235], 0
  v_mfma_f32_16x16x32_bf16 v[88:91], v[40:43], v[224:227], 0
  v_mfma_f32_16x16x32_bf16 v[88:91], v[64:67], v[226:229], v[88:91]
  v_mfma_f32_16x16x32_bf16 v[108:111], v[40:43], v[230:233], 0
  v_mfma_f32_16x16x32_bf16 v[108:111], v[64:67], v[232:235], v[108:111]
  v_add_f32 v92, s70, v92
  v_add_f32 v96, s70, v96
  v_add_f32 v112, s70, v112
  v_add_f32 v116, s70, v116
  v_rcp_f32 v92, v92
  v_rcp_f32 v96, v96
  v_rcp_f32 v112, v112
  v_rcp_f32 v116, v116
  v_cndmask_b32 v94, v96, v92, s[64:65]
  v_pk_mul_f32 v[80:81], v[80:81], v[92:93] op_sel:[0,0] op_sel_hi:[1,0]
  v_pk_mul_f32 v[84:85], v[84:85], v[96:97] op_sel:[0,0] op_sel_hi:[1,0]
  v_pk_mul_f32 v[82:83], v[82:83], v[92:93] op_sel:[0,0] op_sel_hi:[1,0]
  v_pk_mul_f32 v[86:87], v[86:87], v[96:97] op_sel:[0,0] op_sel_hi:[1,0]
  v_cndmask_b32 v114, v116, v112, s[64:65]
  v_pk_mul_f32 v[100:101], v[100:101], v[112:113] op_sel:[0,0] op_sel_hi:[1,0]
  v_pk_mul_f32 v[104:105], v[104:105], v[116:117] op_sel:[0,0] op_sel_hi:[1,0]
  v_pk_mul_f32 v[102:103], v[102:103], v[112:113] op_sel:[0,0] op_sel_hi:[1,0]
  v_pk_mul_f32 v[106:107], v[106:107], v[116:117] op_sel:[0,0] op_sel_hi:[1,0]
  v_cvt_pk_bf16_f32 v80, v80, v81
  v_cvt_pk_bf16_f32 v81, v82, v83
  v_cvt_pk_bf16_f32 v82, v84, v85
  v_cvt_pk_bf16_f32 v83, v86, v87
  buffer_store_dwordx4 v[80:83], v5, s[12:15], s32 offen sc1
  v_cvt_pk_bf16_f32 v100, v100, v101
  v_cvt_pk_bf16_f32 v101, v102, v103
  v_cvt_pk_bf16_f32 v102, v104, v105
  v_cvt_pk_bf16_f32 v103, v106, v107
  s_add_u32 s32, s32, 20480
  buffer_store_dwordx4 v[100:103], v5, s[12:15], s32 offen sc1
  v_pk_mul_f32 v[88:89], v[88:89], v[94:95] op_sel:[0,0] op_sel_hi:[1,0]
  v_pk_mul_f32 v[90:91], v[90:91], v[94:95] op_sel:[0,0] op_sel_hi:[1,0]
  v_cvt_pk_bf16_f32 v88, v88, v89
  v_cvt_pk_bf16_f32 v89, v90, v91
  buffer_store_dwordx2 v[88:89], v244, s[12:15], s33 offen sc1
  v_pk_mul_f32 v[108:109], v[108:109], v[114:115] op_sel:[0,0] op_sel_hi:[1,0]
  v_pk_mul_f32 v[110:111], v[110:111], v[114:115] op_sel:[0,0] op_sel_hi:[1,0]
  v_cvt_pk_bf16_f32 v108, v108, v109
  v_cvt_pk_bf16_f32 v109, v110, v111
  s_add_u32 s33, s33, 20480
  buffer_store_dwordx2 v[108:109], v244, s[12:15], s33 offen sc1
  s_waitcnt vmcnt(0)
  s_barrier
  s_cmp_lg_u32 s3, 0
  s_cbranch_scc1 W0_12
  v_mov_b32 v26, 1
  buffer_atomic_add v26, v28, s[12:15], s78 offen sc1
W0_12:
  s_add_u32 s23, s23, 1
  s_cmp_lg_u32 s9, 0
  s_cbranch_scc1 JL_13
  s_cmp_eq_u32 s3, 0
  s_cbranch_scc1 JL_13
  v_lshrrev_b32 v228, 2, v2
  v_lshlrev_b32 v228, 8, v228
  v_and_b32 v224, 3, v2
  v_lshl_add_u32 v228, v224, 4, v228
  s_mov_b32 s75, 0x197c000
  s_mov_b32 s74, 0
JP_14:
  buffer_load_dwordx4 v[224:227], v228, s[12:15], s75 offen sc1
  s_waitcnt vmcnt(0)
  v_min_u32 v224, v224, v225
  v_min_u32 v226, v226, v227
  v_min_u32 v224, v224, v226
  v_cmp_eq_u32 vcc, 0, v224
  s_cmp_eq_u64 vcc, 0
  s_cbranch_scc1 JD_15
  s_add_u32 s74, s74, 1
  s_cmp_lt_u32 s74, 0x40000
  s_cbranch_scc1 JP_14
JD_15:
JL_13:
  s_cmp_lg_u32 s3, 0
  s_cbranch_scc1 W0_16
  s_mov_b32 s74, 0
PL_17:
  buffer_load_dword v26, v29, s[12:15], s79 offen sc1
  s_waitcnt vmcnt(0)
  v_cmp_gt_u32 vcc, s23, v26
  s_cmp_eq_u64 vcc, 0
  s_cbranch_scc1 PD_18
  s_add_u32 s74, s74, 1
  s_cmp_lt_u32 s74, 0x40000
  s_cbranch_scc1 PL_17
PD_18:
W0_16:
  s_barrier
  buffer_load_dwordx4 a[0:3], v5, s[12:15], s36 offen offset:0 sc1
  buffer_load_dwordx4 a[20:23], v5, s[12:15], s37 offen offset:0 sc1
  buffer_load_dwordx4 a[40:43], v5, s[12:15], s38 offen offset:0 sc1
  buffer_load_dwordx4 a[60:63], v5, s[12:15], s39 offen offset:0 sc1
  buffer_load_dwordx4 a[4:7], v5, s[12:15], s36 offen offset:1024 sc1
  buffer_load_dwordx4 a[24:27], v5, s[12:15], s37 offen offset:1024 sc1
  buffer_load_dwordx4 a[44:47], v5, s[12:15], s38 offen offset:1024 sc1
  buffer_load_dwordx4 a[64:67], v5, s[12:15], s39 offen offset:1024 sc1
  s_mul_i32 s24, s9, 0x500000
  s_mul_i32 s8, s20, 0x5000
  s_add_u32 s24, s24, s8
  s_add_u32 s24, s24, 0xc5e000
  s_add_u32 s25, s24, 20480
  s_waitcnt vmcnt(7)
  v_mfma_f32_16x16x32_bf16 v[32:35], a[160:163], a[0:3], 0
  buffer_load_dwordx4 a[8:11], v5, s[12:15], s36 offen offset:2048 sc1
  v_mfma_f32_16x16x32_bf16 v[36:39], a[164:167], a[0:3], 0
  v_mfma_f32_16x16x32_bf16 v[40:43], a[168:171], a[0:3], 0
  v_mfma_f32_16x16x32_bf16 v[44:47], a[172:175], a[0:3], 0
  v_mfma_f32_16x16x32_bf16 v[48:51], a[176:179], a[0:3], 0
  s_waitcnt vmcnt(7)
  v_mfma_f32_16x16x32_bf16 v[52:55], a[160:163], a[20:23], 0
  buffer_load_dwordx4 a[28:31], v5, s[12:15], s37 offen offset:2048 sc1
  v_mfma_f32_16x16x32_bf16 v[56:59], a[164:167], a[20:23], 0
  v_mfma_f32_16x16x32_bf16 v[60:63], a[168:171], a[20:23], 0
  v_mfma_f32_16x16x32_bf16 v[64:67], a[172:175], a[20:23], 0
  v_mfma_f32_16x16x32_bf16 v[68:71], a[176:179], a[20:23], 0
  s_waitcnt vmcnt(7)
  v_mfma_f32_16x16x32_bf16 v[72:75], a[160:163], a[40:43], 0
  buffer_load_dwordx4 a[48:51], v5, s[12:15], s38 offen offset:2048 sc1
  v_mfma_f32_16x16x32_bf16 v[76:79], a[164:167], a[40:43], 0
  v_mfma_f32_16x16x32_bf16 v[80:83], a[168:171], a[40:43], 0
  v_mfma_f32_16x16x32_bf16 v[84:87], a[172:175], a[40:43], 0
  v_mfma_f32_16x16x32_bf16 v[88:91], a[176:179], a[40:43], 0
  s_waitcnt vmcnt(7)
  v_mfma_f32_16x16x32_bf16 v[92:95], a[160:163], a[60:63], 0
  buffer_load_dwordx4 a[68:71], v5, s[12:15], s39 offen offset:2048 sc1
  v_mfma_f32_16x16x32_bf16 v[96:99], a[164:167], a[60:63], 0
  v_mfma_f32_16x16x32_bf16 v[100:103], a[168:171], a[60:63], 0
  v_mfma_f32_16x16x32_bf16 v[104:107], a[172:175], a[60:63], 0
  v_mfma_f32_16x16x32_bf16 v[108:111], a[176:179], a[60:63], 0
  s_waitcnt vmcnt(7)
  v_mfma_f32_16x16x32_bf16 v[32:35], a[180:183], a[4:7], v[32:35]
  buffer_load_dwordx4 a[12:15], v5, s[12:15], s36 offen offset:3072 sc1
  v_mfma_f32_16x16x32_bf16 v[36:39], a[184:187], a[4:7], v[36:39]
  v_mfma_f32_16x16x32_bf16 v[40:43], a[188:191], a[4:7], v[40:43]
  v_mfma_f32_16x16x32_bf16 v[44:47], a[192:195], a[4:7], v[44:47]
  v_mfma_f32_16x16x32_bf16 v[48:51], a[196:199], a[4:7], v[48:51]
  s_waitcnt vmcnt(7)
  v_mfma_f32_16x16x32_bf16 v[52:55], a[180:183], a[24:27], v[52:55]
  buffer_load_dwordx4 a[32:35], v5, s[12:15], s37 offen offset:3072 sc1
  v_mfma_f32_16x16x32_bf16 v[56:59], a[184:187], a[24:27], v[56:59]
  v_mfma_f32_16x16x32_bf16 v[60:63], a[188:191], a[24:27], v[60:63]
  v_mfma_f32_16x16x32_bf16 v[64:67], a[192:195], a[24:27], v[64:67]
  v_mfma_f32_16x16x32_bf16 v[68:71], a[196:199], a[24:27], v[68:71]
  s_waitcnt vmcnt(7)
  v_mfma_f32_16x16x32_bf16 v[72:75], a[180:183], a[44:47], v[72:75]
  buffer_load_dwordx4 a[52:55], v5, s[12:15], s38 offen offset:3072 sc1
  v_mfma_f32_16x16x32_bf16 v[76:79], a[184:187], a[44:47], v[76:79]
  v_mfma_f32_16x16x32_bf16 v[80:83], a[188:191], a[44:47], v[80:83]
  v_mfma_f32_16x16x32_bf16 v[84:87], a[192:195], a[44:47], v[84:87]
  v_mfma_f32_16x16x32_bf16 v[88:91], a[196:199], a[44:47], v[88:91]
  s_waitcnt vmcnt(7)
  v_mfma_f32_16x16x32_bf16 v[92:95], a[180:183], a[64:67], v[92:95]
  buffer_load_dwordx4 a[72:75], v5, s[12:15], s39 offen offset:3072 sc1
  v_mfma_f32_16x16x32_bf16 v[96:99], a[184:187], a[64:67], v[96:99]
  v_mfma_f32_16x16x32_bf16 v[100:103], a[188:191], a[64:67], v[100:103]
  v_mfma_f32_16x16x32_bf16 v[104:107], a[192:195], a[64:67], v[104:107]
  v_mfma_f32_16x16x32_bf16 v[108:111], a[196:199], a[64:67], v[108:111]
  s_waitcnt vmcnt(7)
  v_mfma_f32_16x16x32_bf16 v[32:35], a[200:203], a[8:11], v[32:35]
  buffer_load_dwordx4 a[16:19], v9, s[12:15], s36 offen sc1
  v_mfma_f32_16x16x32_bf16 v[36:39], a[204:207], a[8:11], v[36:39]
  v_mfma_f32_16x16x32_bf16 v[40:43], a[208:211], a[8:11], v[40:43]
  v_mfma_f32_16x16x32_bf16 v[44:47], a[212:215], a[8:11], v[44:47]
  v_mfma_f32_16x16x32_bf16 v[48:51], a[216:219], a[8:11], v[48:51]
  s_waitcnt vmcnt(7)
  v_mfma_f32_16x16x32_bf16 v[52:55], a[200:203], a[28:31], v[52:55]
  buffer_load_dwordx4 a[36:39], v9, s[12:15], s37 offen sc1
  v_mfma_f32_16x16x32_bf16 v[56:59], a[204:207], a[28:31], v[56:59]
  v_mfma_f32_16x16x32_bf16 v[60:63], a[208:211], a[28:31], v[60:63]
  v_mfma_f32_16x16x32_bf16 v[64:67], a[212:215], a[28:31], v[64:67]
  v_mfma_f32_16x16x32_bf16 v[68:71], a[216:219], a[28:31], v[68:71]
  s_waitcnt vmcnt(7)
  v_mfma_f32_16x16x32_bf16 v[72:75], a[200:203], a[48:51], v[72:75]
  buffer_load_dwordx4 a[56:59], v9, s[12:15], s38 offen sc1
  v_mfma_f32_16x16x32_bf16 v[76:79], a[204:207], a[48:51], v[76:79]
  v_mfma_f32_16x16x32_bf16 v[80:83], a[208:211], a[48:51], v[80:83]
  v_mfma_f32_16x16x32_bf16 v[84:87], a[212:215], a[48:51], v[84:87]
  v_mfma_f32_16x16x32_bf16 v[88:91], a[216:219], a[48:51], v[88:91]
  s_waitcnt vmcnt(7)
  v_mfma_f32_16x16x32_bf16 v[92:95], a[200:203], a[68:71], v[92:95]
  buffer_load_dwordx4 a[76:79], v9, s[12:15], s39 offen sc1
  v_mfma_f32_16x16x32_bf16 v[96:99], a[204:207], a[68:71], v[96:99]
  v_mfma_f32_16x16x32_bf16 v[100:103], a[208:211], a[68:71], v[100:103]
  v_mfma_f32_16x16x32_bf16 v[104:107], a[212:215], a[68:71], v[104:107]
  v_mfma_f32_16x16x32_bf16 v[108:111], a[216:219], a[68:71], v[108:111]
  s_waitcnt vmcnt(7)
  v_mfma_f32_16x16x32_bf16 v[32:35], a[220:223], a[12:15], v[32:35]
  v_mfma_f32_16x16x32_bf16 v[36:39], a[224:227], a[12:15], v[36:39]
  s_add_u32 s58, s48, 0
  buffer_load_dwordx4 a[160:163], v5, s[12:15], s58 offen offset:0
  v_mfma_f32_16x16x32_bf16 v[40:43], a[228:231], a[12:15], v[40:43]
  v_mfma_f32_16x16x32_bf16 v[44:47], a[232:235], a[12:15], v[44:47]
  buffer_load_dwordx4 a[164:167], v5, s[12:15], s58 offen offset:1024
  v_mfma_f32_16x16x32_bf16 v[48:51], a[236:239], a[12:15], v[48:51]
  s_waitcnt vmcnt(8)
  v_mfma_f32_16x16x32_bf16 v[52:55], a[220:223], a[32:35], v[52:55]
  v_mfma_f32_16x16x32_bf16 v[56:59], a[224:227], a[32:35], v[56:59]
  buffer_load_dwordx4 a[168:171], v5, s[12:15], s58 offen offset:2048
  v_mfma_f32_16x16x32_bf16 v[60:63], a[228:231], a[32:35], v[60:63]
  v_mfma_f32_16x16x32_bf16 v[64:67], a[232:235], a[32:35], v[64:67]
  buffer_load_dwordx4 a[172:175], v5, s[12:15], s58 offen offset:3072
  v_mfma_f32_16x16x32_bf16 v[68:71], a[236:239], a[32:35], v[68:71]
  s_waitcnt vmcnt(9)
  v_mfma_f32_16x16x32_bf16 v[72:75], a[220:223], a[52:55], v[72:75]
  v_mfma_f32_16x16x32_bf16 v[76:79], a[224:227], a[52:55], v[76:79]
  buffer_load_dwordx4 a[176:179], v9, s[12:15], s58 offen
  v_mfma_f32_16x16x32_bf16 v[80:83], a[228:231], a[52:55], v[80:83]
  v_mfma_f32_16x16x32_bf16 v[84:87], a[232:235], a[52:55], v[84:87]
  s_add_u32 s58, s48, 15360
  buffer_load_dwordx4 a[180:183], v5, s[12:15], s58 offen offset:0
  v_mfma_f32_16x16x32_bf16 v[88:91], a[236:239], a[52:55], v[88:91]
  s_waitcnt vmcnt(10)
  v_mfma_f32_16x16x32_bf16 v[92:95], a[220:223], a[72:75], v[92:95]
  v_mfma_f32_16x16x32_bf16 v[96:99], a[224:227], a[72:75], v[96:99]
  buffer_load_dwordx4 a[184:187], v5, s[12:15], s58 offen offset:1024
  v_mfma_f32_16x16x32_bf16 v[100:103], a[228:231], a[72:75], v[100:103]
  v_mfma_f32_16x16x32_bf16 v[104:107], a[232:235], a[72:75], v[104:107]
  buffer_load_dwordx4 a[188:191], v5, s[12:15], s58 offen offset:2048
  v_mfma_f32_16x16x32_bf16 v[108:111], a[236:239], a[72:75], v[108:111]
  s_waitcnt vmcnt(11)
  v_mfma_f32_16x16x32_bf16 v[32:35], a[240:243], a[16:19], v[32:35]
  v_mfma_f32_16x16x32_bf16 v[36:39], a[244:247], a[16:19], v[36:39]
  buffer_load_dwordx4 a[192:195], v5, s[12:15], s58 offen offset:3072
  v_mfma_f32_16x16x32_bf16 v[40:43], a[248:251], a[16:19], v[40:43]
  v_mfma_f32_16x16x32_bf16 v[44:47], a[252:255], a[16:19], v[44:47]
  buffer_load_dwordx4 a[196:199], v9, s[12:15], s58 offen
  v_mfma_f32_16x16x32_bf16 v[48:51], v[252:255], a[16:19], v[48:51]
  s_waitcnt vmcnt(12)
  v_mfma_f32_16x16x32_bf16 v[52:55], a[240:243], a[36:39], v[52:55]
  v_mfma_f32_16x16x32_bf16 v[56:59], a[244:247], a[36:39], v[56:59]
  s_add_u32 s58, s48, 35840
  buffer_load_dwordx4 a[200:203], v5, s[12:15], s58 offen offset:0
  v_mfma_f32_16x16x32_bf16 v[60:63], a[248:251], a[36:39], v[60:63]
  v_mfma_f32_16x16x32_bf16 v[64:67], a[252:255], a[36:39], v[64:67]
  buffer_load_dwordx4 a[204:207], v5, s[12:15], s58 offen offset:1024
  v_mfma_f32_16x16x32_bf16 v[68:71], v[252:255], a[36:39], v[68:71]
  v_add_u32 v10, s40, v5
  ds_write_b128 v10, v[32:35] offset:0
  ds_write_b128 v10, v[36:39] offset:1024
  ds_write_b128 v10, v[40:43] offset:2048
  ds_write_b128 v10, v[44:47] offset:3072
  ds_write_b128 v10, v[48:51] offset:4096
  s_waitcnt vmcnt(13)
  v_mfma_f32_16x16x32_bf16 v[72:75], a[240:243], a[56:59], v[72:75]
  v_mfma_f32_16x16x32_bf16 v[76:79], a[244:247], a[56:59], v[76:79]
  buffer_load_dwordx4 a[208:211], v5, s[12:15], s58 offen offset:2048
  v_mfma_f32_16x16x32_bf16 v[80:83], a[248:251], a[56:59], v[80:83]
  v_mfma_f32_16x16x32_bf16 v[84:87], a[252:255], a[56:59], v[84:87]
  buffer_load_dwordx4 a[212:215], v5, s[12:15], s58 offen offset:3072
  v_mfma_f32_16x16x32_bf16 v[88:91], v[252:255], a[56:59], v[88:91]
  v_add_u32 v10, s41, v5
  ds_write_b128 v10, v[52:55] offset:0
  ds_write_b128 v10, v[56:59] offset:1024
  ds_write_b128 v10, v[60:63] offset:2048
  ds_write_b128 v10, v[64:67] offset:3072
  ds_write_b128 v10, v[68:71] offset:4096
  s_waitcnt vmcnt(14)
  v_mfma_f32_16x16x32_bf16 v[92:95], a[240:243], a[76:79], v[92:95]
  v_mfma_f32_16x16x32_bf16 v[96:99], a[244:247], a[76:79], v[96:99]
  buffer_load_dwordx4 a[216:219], v9, s[12:15], s58 offen
  v_mfma_f32_16x16x32_bf16 v[100:103], a[248:251], a[76:79], v[100:103]
  v_mfma_f32_16x16x32_bf16 v[104:107], a[252:255], a[76:79], v[104:107]
  v_mfma_f32_16x16x32_bf16 v[108:111], v[252:255], a[76:79], v[108:111]
  v_add_u32 v10, s42, v5
  ds_write_b128 v10, v[72:75] offset:0
  ds_write_b128 v10, v[76:79] offset:1024
  ds_write_b128 v10, v[80:83] offset:2048
  ds_write_b128 v10, v[84:87] offset:3072
  ds_write_b128 v10, v[88:91] offset:4096
  s_add_u32 s58, s48, 51200
  buffer_load_dwordx4 a[220:223], v5, s[12:15], s58 offen offset:0
  buffer_load_dwordx4 a[224:227], v5, s[12:15], s58 offen offset:1024
  buffer_load_dwordx4 a[228:231], v5, s[12:15], s58 offen offset:2048
  buffer_load_dwordx4 a[232:235], v5, s[12:15], s58 offen offset:3072
  s_waitcnt lgkmcnt(0)
  s_barrier
  v_add_u32 v10, s43, v5
  ds_read_b128 v[112:115], v10 offset:0
  ds_read_b128 v[116:119], v10 offset:1024
  ds_read_b128 v[120:123], v10 offset:2048
  ds_read_b128 v[124:127], v10 offset:3072
  ds_read_b128 v[128:131], v10 offset:4096
  ds_read_b128 v[132:135], v10 offset:5120
  ds_read_b128 v[136:139], v10 offset:6144
  ds_read_b128 v[140:143], v10 offset:7168
  ds_read_b128 v[144:147], v10 offset:8192
  ds_read_b128 v[148:151], v10 offset:9216
  ds_read_b128 v[152:155], v10 offset:10240
  ds_read_b128 v[156:159], v10 offset:11264
  ds_read_b128 v[160:163], v10 offset:12288
  ds_read_b128 v[164:167], v10 offset:13312
  ds_read_b128 v[168:171], v10 offset:14336
  v_lshlrev_b32 v172, 16, v16
  v_and_b32 v173, 0xffff0000, v16
  v_lshlrev_b32 v174, 16, v17
  v_and_b32 v175, 0xffff0000, v17
  v_lshlrev_b32 v176, 16, v18
  v_and_b32 v177, 0xffff0000, v18
  v_lshlrev_b32 v178, 16, v19
  v_and_b32 v179, 0xffff0000, v19
  v_lshlrev_b32 v180, 16, v20
  v_and_b32 v181, 0xffff0000, v20
  v_lshlrev_b32 v182, 16, v21
  v_and_b32 v183, 0xffff0000, v21
  v_lshlrev_b32 v184, 16, v22
  v_and_b32 v185, 0xffff0000, v22
  v_lshlrev_b32 v186, 16, v23
  v_and_b32 v187, 0xffff0000, v23
  v_lshlrev_b32 v188, 16, v24
  v_and_b32 v189, 0xffff0000, v24
  v_lshlrev_b32 v190, 16, v25
  v_and_b32 v191, 0xffff0000, v25
  v_pk_add_f32 v[92:93], v[92:93], v[172:173]
  v_pk_add_f32 v[94:95], v[94:95], v[174:175]
  v_pk_add_f32 v[96:97], v[96:97], v[176:177]
  v_pk_add_f32 v[98:99], v[98:99], v[178:179]
  v_pk_add_f32 v[100:101], v[100:101], v[180:181]
  v_pk_add_f32 v[102:103], v[102:103], v[182:183]
  v_pk_add_f32 v[104:105], v[104:105], v[184:185]
  v_pk_add_f32 v[106:107], v[106:107], v[186:187]
  v_pk_add_f32 v[108:109], v[108:109], v[188:189]
  v_pk_add_f32 v[110:111], v[110:111], v[190:191]
  s_waitcnt lgkmcnt(10)
  v_pk_add_f32 v[92:93], v[92:93], v[112:113]
  v_pk_add_f32 v[94:95], v[94:95], v[114:115]
  v_pk_add_f32 v[96:97], v[96:97], v[116:117]
  v_pk_add_f32 v[98:99], v[98:99], v[118:119]
  v_pk_add_f32 v[100:101], v[100:101], v[120:121]
  v_pk_add_f32 v[102:103], v[102:103], v[122:123]
  v_pk_add_f32 v[104:105], v[104:105], v[124:125]
  v_pk_add_f32 v[106:107], v[106:107], v[126:127]
  v_pk_add_f32 v[108:109], v[108:109], v[128:129]
  v_pk_add_f32 v[110:111], v[110:111], v[130:131]
  s_waitcnt lgkmcnt(5)
  v_pk_add_f32 v[92:93], v[92:93], v[132:133]
  v_pk_add_f32 v[94:95], v[94:95], v[134:135]
  v_pk_add_f32 v[96:97], v[96:97], v[136:137]
  v_pk_add_f32 v[98:99], v[98:99], v[138:139]
  v_pk_add_f32 v[100:101], v[100:101], v[140:141]
  v_pk_add_f32 v[102:103], v[102:103], v[142:143]
  v_pk_add_f32 v[104:105], v[104:105], v[144:145]
  v_pk_add_f32 v[106:107], v[106:107], v[146:147]
  v_pk_add_f32 v[108:109], v[108:109], v[148:149]
  v_pk_add_f32 v[110:111], v[110:111], v[150:151]
  s_waitcnt lgkmcnt(0)
  v_pk_add_f32 v[92:93], v[92:93], v[152:153]
  v_pk_add_f32 v[94:95], v[94:95], v[154:155]
  v_pk_add_f32 v[96:97], v[96:97], v[156:157]
  v_pk_add_f32 v[98:99], v[98:99], v[158:159]
  v_pk_add_f32 v[100:101], v[100:101], v[160:161]
  v_pk_add_f32 v[102:103], v[102:103], v[162:163]
  v_pk_add_f32 v[104:105], v[104:105], v[164:165]
  v_pk_add_f32 v[106:107], v[106:107], v[166:167]
  v_pk_add_f32 v[108:109], v[108:109], v[168:169]
  v_pk_add_f32 v[110:111], v[110:111], v[170:171]
  v_cvt_pk_bf16_f32 v16, v92, v93
  v_cvt_pk_bf16_f32 v17, v94, v95
  v_cvt_pk_bf16_f32 v18, v96, v97
  v_cvt_pk_bf16_f32 v19, v98, v99
  v_cvt_pk_bf16_f32 v20, v100, v101
  v_cvt_pk_bf16_f32 v21, v102, v103
  v_cvt_pk_bf16_f32 v22, v104, v105
  v_cvt_pk_bf16_f32 v23, v106, v107
  v_cvt_pk_bf16_f32 v24, v108, v109
  v_cvt_pk_bf16_f32 v25, v110, v111
  buffer_store_dwordx4 v[16:19], v5, s[12:15], s44 offen sc1
  buffer_store_dwordx4 v[20:23], v5, s[12:15], s44 offen offset:1024 sc1
  buffer_store_dwordx2 v[24:25], v6, s[12:15], s45 offen sc1
  s_mov_b32 s46, 0x3f803f80
  v_mov_b32 v10, 0
  v_mov_b32 v11, 0
  v_mov_b32 v12, 0
  v_mov_b32 v13, 0
  v_dot2_f32_bf16 v10, v16, s46, v10
  v_dot2_f32_bf16 v11, v16, v16, v11
  v_dot2_f32_bf16 v12, v17, s46, v12
  v_dot2_f32_bf16 v13, v17, v17, v13
  v_dot2_f32_bf16 v10, v18, s46, v10
  v_dot2_f32_bf16 v11, v18, v18, v11
  v_dot2_f32_bf16 v12, v19, s46, v12
  v_dot2_f32_bf16 v13, v19, v19, v13
  v_dot2_f32_bf16 v10, v20, s46, v10
  v_dot2_f32_bf16 v11, v20, v20, v11
  v_dot2_f32_bf16 v12, v21, s46, v12
  v_dot2_f32_bf16 v13, v21, v21, v13
  v_dot2_f32_bf16 v10, v22, s46, v10
  v_dot2_f32_bf16 v11, v22, v22, v11
  v_dot2_f32_bf16 v12, v23, s46, v12
  v_dot2_f32_bf16 v13, v23, v23, v13
  v_dot2_f32_bf16 v10, v24, s46, v10
  v_dot2_f32_bf16 v11, v24, v24, v11
  v_dot2_f32_bf16 v12, v25, s46, v12
  v_dot2_f32_bf16 v13, v25, v25, v13
  v_lshlrev_b32 v14, 3, v4
  v_mov_b32 v15, 0x40000000
  v_cmp_eq_u32 vcc, 0, v3
  s_nop 1
  v_cndmask_b32 v14, v15, v14, vcc
  s_mul_i32 s46, s9, 0x40000
  s_mul_i32 s8, s21, 0x400
  s_add_u32 s46, s46, s8
  s_mul_i32 s8, s7, 0x80
  s_add_u32 s46, s46, s8
  s_add_u32 s46, s46, 0x13fe000
  v_pk_add_f32 v[10:11], v[10:11], v[12:13]
  v_mov_b32 v12, v10
  v_mov_b32 v13, v11
  s_nop 0
  v_permlane16_swap_b32 v10, v12
  v_permlane16_swap_b32 v11, v13
  v_pk_add_f32 v[10:11], v[10:11], v[12:13]
  v_mov_b32 v12, v10
  v_mov_b32 v13, v11
  s_nop 0
  v_permlane32_swap_b32 v10, v12
  v_permlane32_swap_b32 v11, v13
  v_pk_add_f32 v[10:11], v[10:11], v[12:13]
  buffer_store_dwordx2 v[10:11], v14, s[12:15], s46 offen sc1
  buffer_load_dwordx4 a[236:239], v9, s[12:15], s58 offen
  s_add_u32 s58, s48, 5120
  buffer_load_dwordx4 a[240:243], v5, s[12:15], s58 offen offset:0
  buffer_load_dwordx4 a[244:247], v5, s[12:15], s58 offen offset:1024
  buffer_load_dwordx4 a[248:251], v5, s[12:15], s58 offen offset:2048
  buffer_load_dwordx4 a[252:255], v5, s[12:15], s58 offen offset:3072
  s_barrier
  s_add_u32 m0, s51, 86016
  s_add_u32 s53, s52, 0x15000
  buffer_load_dwordx4 v5, s[12:15], s53 offen offset:0 lds
  buffer_load_dwordx4 v5, s[12:15], s53 offen offset:1024 lds
  buffer_load_dwordx4 v5, s[12:15], s53 offen offset:2048 lds
  buffer_load_dwordx4 v5, s[12:15], s53 offen offset:3072 lds
  s_add_u32 m0, s51, 90112
  s_add_u32 s53, s52, 0x16000
  buffer_load_dwordx4 v5, s[12:15], s53 offen offset:0 lds
  buffer_load_dwordx4 v5, s[12:15], s53 offen offset:1024 lds
  buffer_load_dwordx4 v5, s[12:15], s53 offen offset:2048 lds
  s_waitcnt vmcnt(12)
  s_barrier
  s_cmp_lg_u32 s3, 0
  s_cbranch_scc1 W0_19
  v_mov_b32 v26, 1
  buffer_atomic_add v26, v28, s[12:15], s78 offen sc1
W0_19:
  s_add_u32 s23, s23, 1
  s_cmp_lg_u32 s3, 0
  s_cbranch_scc1 W0_20
  s_mov_b32 s74, 0
PL_21:
  buffer_load_dword v26, v29, s[12:15], s79 offen sc1
  s_waitcnt vmcnt(0)
  v_cmp_gt_u32 vcc, s23, v26
  s_cmp_eq_u64 vcc, 0
  s_cbranch_scc1 PD_22
  s_add_u32 s74, s74, 1
  s_cmp_lt_u32 s74, 0x40000
  s_cbranch_scc1 PL_21
PD_22:
W0_20:
  s_barrier
  buffer_load_dwordx4 a[0:3], v5, s[12:15], s24 offen offset:0 sc1
  buffer_load_dwordx4 a[4:7], v5, s[12:15], s25 offen offset:0 sc1
  buffer_load_dwordx4 a[8:11], v5, s[12:15], s24 offen offset:1024 sc1
  buffer_load_dwordx4 a[12:15], v5, s[12:15], s25 offen offset:1024 sc1
  buffer_load_dwordx2 a[16:17], v6, s[12:15], s24 offen offset:2048 sc1
  buffer_load_dwordx2 a[18:19], v6, s[12:15], s24 offen offset:2560 sc1
  buffer_load_dwordx2 a[20:21], v6, s[12:15], s25 offen offset:2048 sc1
  buffer_load_dwordx2 a[22:23], v6, s[12:15], s25 offen offset:2560 sc1
  buffer_load_dwordx4 a[24:27], v5, s[12:15], s24 offen offset:3072 sc1
  buffer_load_dwordx4 a[28:31], v5, s[12:15], s25 offen offset:3072 sc1
  s_add_u32 s24, s24, 4096
  buffer_load_dwordx4 a[32:35], v5, s[12:15], s24 offen offset:0 sc1
  s_add_u32 s25, s25, 4096
  buffer_load_dwordx4 a[36:39], v5, s[12:15], s25 offen offset:0 sc1
  buffer_load_dwordx4 a[40:43], v5, s[12:15], s24 offen offset:1024 sc1
  buffer_load_dwordx4 a[44:47], v5, s[12:15], s25 offen offset:1024 sc1
  buffer_load_dwordx4 a[48:51], v5, s[12:15], s24 offen offset:2048 sc1
  buffer_load_dwordx4 a[52:55], v5, s[12:15], s25 offen offset:2048 sc1
  buffer_load_dwordx2 a[56:57], v6, s[12:15], s24 offen offset:3072 sc1
  buffer_load_dwordx2 a[58:59], v6, s[12:15], s24 offen offset:3584 sc1
  buffer_load_dwordx2 a[60:61], v6, s[12:15], s25 offen offset:3072 sc1
  buffer_load_dwordx2 a[62:63], v6, s[12:15], s25 offen offset:3584 sc1
  s_mul_i32 s26, s9, 0x40000
  s_mul_i32 s8, s20, 0x400
  s_add_u32 s26, s26, s8
  s_add_u32 s26, s26, 0x13fe000
  v_lshlrev_b32 v14, 8, v3
  v_lshl_add_u32 v14, v4, 3, v14
  buffer_load_dwordx2 v[200:201], v14, s[12:15], s26 offen offset:0 sc1
  buffer_load_dwordx2 v[202:203], v14, s[12:15], s26 offen offset:128 sc1
  buffer_load_dwordx2 v[204:205], v14, s[12:15], s26 offen offset:1024 sc1
  buffer_load_dwordx2 v[206:207], v14, s[12:15], s26 offen offset:1152 sc1
  s_mul_i32 s27, s5, 0x1b0
  s_add_u32 s27, s27, 0x9da000
  s_mov_b32 m0, 143360
  s_nop 0
  buffer_load_dwordx4 v5, s[12:15], s27 offen lds
  s_add_u32 s27, s27, 8192
  s_mov_b32 m0, 144384
  s_nop 0
  buffer_load_dwordx4 v5, s[12:15], s27 offen lds
  s_waitcnt vmcnt(24)
  s_barrier
  ds_read_b128 v[32:35], v5 offset:0
  ds_read_b128 v[36:39], v5 offset:1024
  ds_read_b128 v[40:43], v5 offset:2048
  ds_read_b128 v[44:47], v5 offset:3072
  s_waitcnt lgkmcnt(0)
  v_mfma_f32_16x16x32_bf16 v[112:115], v[32:35], a[0:3], 0
  ds_read_b128 v[48:51], v5 offset:4096
  v_mfma_f32_16x16x32_bf16 v[144:147], v[32:35], a[4:7], 0
  ds_read_b128 v[52:55], v5 offset:5120
  v_mfma_f32_16x16x32_bf16 v[116:119], v[36:39], a[0:3], 0
  ds_read_b128 v[56:59], v5 offset:6144
  v_mfma_f32_16x16x32_bf16 v[148:151], v[36:39], a[4:7], 0
  ds_read_b128 v[60:63], v5 offset:7168
  v_mfma_f32_16x16x32_bf16 v[120:123], v[40:43], a[0:3], 0
  s_add_u32 s24, s24, 4096
  buffer_load_dwordx4 a[64:67], v5, s[12:15], s24 offen offset:0 sc1
  v_mfma_f32_16x16x32_bf16 v[152:155], v[40:43], a[4:7], 0
  v_mfma_f32_16x16x32_bf16 v[124:127], v[44:47], a[0:3], 0
  v_mfma_f32_16x16x32_bf16 v[156:159], v[44:47], a[4:7], 0
  s_waitcnt lgkmcnt(0)
  v_mfma_f32_16x16x32_bf16 v[128:131], v[48:51], a[0:3], 0
  ds_read_b128 v[32:35], v5 offset:8192
  v_mfma_f32_16x16x32_bf16 v[160:163], v[48:51], a[4:7], 0
  ds_read_b128 v[36:39], v5 offset:9216
  v_mfma_f32_16x16x32_bf16 v[132:135], v[52:55], a[0:3], 0
  ds_read_b128 v[40:43], v5 offset:10240
  v_mfma_f32_16x16x32_bf16 v[164:167], v[52:55], a[4:7], 0
  ds_read_b128 v[44:47], v5 offset:11264
  v_mfma_f32_16x16x32_bf16 v[136:139], v[56:59], a[0:3], 0
  s_add_u32 s25, s25, 4096
  buffer_load_dwordx4 a[68:71], v5, s[12:15], s25 offen offset:0 sc1
  v_mfma_f32_16x16x32_bf16 v[168:171], v[56:59], a[4:7], 0
  v_mfma_f32_16x16x32_bf16 v[140:143], v[60:63], a[0:3], 0
  v_mfma_f32_16x16x32_bf16 v[172:175], v[60:63], a[4:7], 0
  s_waitcnt vmcnt(24)
  s_waitcnt lgkmcnt(0)
  v_mfma_f32_16x16x32_bf16 v[112:115], v[32:35], a[8:11], v[112:115]
  ds_read_b128 v[48:51], v5 offset:12288
  v_mfma_f32_16x16x32_bf16 v[144:147], v[32:35], a[12:15], v[144:147]
  ds_read_b128 v[52:55], v5 offset:13312
  v_mfma_f32_16x16x32_bf16 v[116:119], v[36:39], a[8:11], v[116:119]
  ds_read_b128 v[56:59], v5 offset:14336
  v_mfma_f32_16x16x32_bf16 v[148:151], v[36:39], a[12:15], v[148:151]
  ds_read_b128 v[60:63], v5 offset:15360
  v_mfma_f32_16x16x32_bf16 v[120:123], v[40:43], a[8:11], v[120:123]
  buffer_load_dwordx4 a[72:75], v5, s[12:15], s24 offen offset:1024 sc1
  v_mfma_f32_16x16x32_bf16 v[152:155], v[40:43], a[12:15], v[152:155]
  v_mfma_f32_16x16x32_bf16 v[124:127], v[44:47], a[8:11], v[124:127]
  v_mfma_f32_16x16x32_bf16 v[156:159], v[44:47], a[12:15], v[156:159]
  s_waitcnt lgkmcnt(0)
  v_mfma_f32_16x16x32_bf16 v[128:131], v[48:51], a[8:11], v[128:131]
  ds_read_b128 v[32:35], v5 offset:16384
  v_mfma_f32_16x16x32_bf16 v[160:163], v[48:51], a[12:15], v[160:163]
  ds_read_b128 v[36:39], v5 offset:17408
  v_mfma_f32_16x16x32_bf16 v[132:135], v[52:55], a[8:11], v[132:135]
  ds_read_b128 v[40:43], v5 offset:18432
  v_mfma_f32_16x16x32_bf16 v[164:167], v[52:55], a[12:15], v[164:167]
  ds_read_b128 v[44:47], v5 offset:19456
  v_mfma_f32_16x16x32_bf16 v[136:139], v[56:59], a[8:11], v[136:139]
  buffer_load_dwordx4 a[76:79], v5, s[12:15], s25 offen offset:1024 sc1
  v_mfma_f32_16x16x32_bf16 v[168:171], v[56:59], a[12:15], v[168:171]
  v_mfma_f32_16x16x32_bf16 v[140:143], v[60:63], a[8:11], v[140:143]
  v_mfma_f32_16x16x32_bf16 v[172:175], v[60:63], a[12:15], v[172:175]
  s_waitcnt vmcnt(22)
  s_waitcnt lgkmcnt(0)
  v_mfma_f32_16x16x32_bf16 v[112:115], v[32:35], a[16:19], v[112:115]
  ds_read_b128 v[48:51], v5 offset:20480
  v_mfma_f32_16x16x32_bf16 v[144:147], v[32:35], a[20:23], v[144:147]
  ds_read_b128 v[52:55], v5 offset:21504
  v_mfma_f32_16x16x32_bf16 v[116:119], v[36:39], a[16:19], v[116:119]
  ds_read_b128 v[56:59], v5 offset:22528
  v_mfma_f32_16x16x32_bf16 v[148:151], v[36:39], a[20:23], v[148:151]
  ds_read_b128 v[60:63], v5 offset:23552
  v_mfma_f32_16x16x32_bf16 v[120:123], v[40:43], a[16:19], v[120:123]
  buffer_load_dwordx4 a[80:83], v5, s[12:15], s24 offen offset:2048 sc1
  v_mfma_f32_16x16x32_bf16 v[152:155], v[40:43], a[20:23], v[152:155]
  s_add_u32 m0, s51, 114688
  s_add_u32 s53, s52, 0x1c000
  buffer_load_dwordx4 v5, s[12:15], s53 offen offset:0 lds
  v_mfma_f32_16x16x32_bf16 v[124:127], v[44:47], a[16:19], v[124:127]
  v_mfma_f32_16x16x32_bf16 v[156:159], v[44:47], a[20:23], v[156:159]
  s_waitcnt lgkmcnt(0)
  v_mfma_f32_16x16x32_bf16 v[128:131], v[48:51], a[16:19], v[128:131]
  ds_read_b128 v[32:35], v5 offset:24576
  v_mfma_f32_16x16x32_bf16 v[160:163], v[48:51], a[20:23], v[160:163]
  ds_read_b128 v[36:39], v5 offset:25600
  v_mfma_f32_16x16x32_bf16 v[132:135], v[52:55], a[16:19], v[132:135]
  ds_read_b128 v[40:43], v5 offset:26624
  v_mfma_f32_16x16x32_bf16 v[164:167], v[52:55], a[20:23], v[164:167]
  ds_read_b128 v[44:47], v5 offset:27648
  v_mfma_f32_16x16x32_bf16 v[136:139], v[56:59], a[16:19], v[136:139]
  buffer_load_dwordx4 a[84:87], v5, s[12:15], s25 offen offset:2048 sc1
  v_mfma_f32_16x16x32_bf16 v[168:171], v[56:59], a[20:23], v[168:171]
  buffer_load_dwordx4 v5, s[12:15], s53 offen offset:1024 lds
  v_mfma_f32_16x16x32_bf16 v[140:143], v[60:63], a[16:19], v[140:143]
  v_mfma_f32_16x16x32_bf16 v[172:175], v[60:63], a[20:23], v[172:175]
  s_waitcnt vmcnt(24)
  s_waitcnt lgkmcnt(0)
  v_mfma_f32_16x16x32_bf16 v[112:115], v[32:35], a[24:27], v[112:115]
  ds_read_b128 v[48:51], v5 offset:28672
  v_mfma_f32_16x16x32_bf16 v[144:147], v[32:35], a[28:31], v[144:147]
  ds_read_b128 v[52:55], v5 offset:29696
  v_mfma_f32_16x16x32_bf16 v[116:119], v[36:39], a[24:27], v[116:119]
  ds_read_b128 v[56:59], v5 offset:30720
  v_mfma_f32_16x16x32_bf16 v[148:151], v[36:39], a[28:31], v[148:151]
  ds_read_b128 v[60:63], v5 offset:31744
  v_mfma_f32_16x16x32_bf16 v[120:123], v[40:43], a[24:27], v[120:123]
  buffer_load_dwordx4 a[88:91], v5, s[12:15], s24 offen offset:3072 sc1
  v_mfma_f32_16x16x32_bf16 v[152:155], v[40:43], a[28:31], v[152:155]
  buffer_load_dwordx4 v5, s[12:15], s53 offen offset:2048 lds
  v_mfma_f32_16x16x32_bf16 v[124:127], v[44:47], a[24:27], v[124:127]
  v_mfma_f32_16x16x32_bf16 v[156:159], v[44:47], a[28:31], v[156:159]
  s_waitcnt lgkmcnt(0)
  v_mfma_f32_16x16x32_bf16 v[128:131], v[48:51], a[24:27], v[128:131]
  ds_read_b128 v[32:35], v5 offset:32768
  v_mfma_f32_16x16x32_bf16 v[160:163], v[48:51], a[28:31], v[160:163]
  ds_read_b128 v[36:39], v5 offset:33792
  v_mfma_f32_16x16x32_bf16 v[132:135], v[52:55], a[24:27], v[132:135]
  ds_read_b128 v[40:43], v5 offset:34816
  v_mfma_f32_16x16x32_bf16 v[164:167], v[52:55], a[28:31], v[164:167]
  ds_read_b128 v[44:47], v5 offset:35840
  v_mfma_f32_16x16x32_bf16 v[136:139], v[56:59], a[24:27], v[136:139]
  buffer_load_dwordx4 a[92:95], v5, s[12:15], s25 offen offset:3072 sc1
  v_mfma_f32_16x16x32_bf16 v[168:171], v[56:59], a[28:31], v[168:171]
  buffer_load_dwordx4 v5, s[12:15], s53 offen offset:3072 lds
  v_mfma_f32_16x16x32_bf16 v[140:143], v[60:63], a[24:27], v[140:143]
  v_mfma_f32_16x16x32_bf16 v[172:175], v[60:63], a[28:31], v[172:175]
  s_waitcnt vmcnt(26)
  s_waitcnt lgkmcnt(0)
  v_mfma_f32_16x16x32_bf16 v[112:115], v[32:35], a[32:35], v[112:115]
  ds_read_b128 v[48:51], v5 offset:36864
  v_mfma_f32_16x16x32_bf16 v[144:147], v[32:35], a[36:39], v[144:147]
  ds_read_b128 v[52:55], v5 offset:37888
  v_mfma_f32_16x16x32_bf16 v[116:119], v[36:39], a[32:35], v[116:119]
  ds_read_b128 v[56:59], v5 offset:38912
  v_mfma_f32_16x16x32_bf16 v[148:151], v[36:39], a[36:39], v[148:151]
  ds_read_b128 v[60:63], v5 offset:39936
  v_mfma_f32_16x16x32_bf16 v[120:123], v[40:43], a[32:35], v[120:123]
  s_add_u32 s24, s24, 4096
  buffer_load_dwordx2 a[96:97], v6, s[12:15], s24 offen offset:0 sc1
  buffer_load_dwordx2 a[98:99], v6, s[12:15], s24 offen offset:512 sc1
  v_mfma_f32_16x16x32_bf16 v[152:155], v[40:43], a[36:39], v[152:155]
  v_mfma_f32_16x16x32_bf16 v[124:127], v[44:47], a[32:35], v[124:127]
  v_mfma_f32_16x16x32_bf16 v[156:159], v[44:47], a[36:39], v[156:159]
  s_waitcnt lgkmcnt(0)
  v_mfma_f32_16x16x32_bf16 v[128:131], v[48:51], a[32:35], v[128:131]
  ds_read_b128 v[32:35], v5 offset:40960
  v_mfma_f32_16x16x32_bf16 v[160:163], v[48:51], a[36:39], v[160:163]
  ds_read_b128 v[36:39], v5 offset:41984
  v_mfma_f32_16x16x32_bf16 v[132:135], v[52:55], a[32:35], v[132:135]
  ds_read_b128 v[40:43], v5 offset:43008
  v_mfma_f32_16x16x32_bf16 v[164:167], v[52:55], a[36:39], v[164:167]
  ds_read_b128 v[44:47], v5 offset:44032
  v_mfma_f32_16x16x32_bf16 v[136:139], v[56:59], a[32:35], v[136:139]
  s_add_u32 s25, s25, 4096
  buffer_load_dwordx2 a[100:101], v6, s[12:15], s25 offen offset:0 sc1
  buffer_load_dwordx2 a[102:103], v6, s[12:15], s25 offen offset:512 sc1
  v_mfma_f32_16x16x32_bf16 v[168:171], v[56:59], a[36:39], v[168:171]
  s_add_u32 m0, s51, 118784
  s_add_u32 s53, s52, 0x1d000
  buffer_load_dwordx4 v5, s[12:15], s53 offen offset:0 lds
  v_mfma_f32_16x16x32_bf16 v[140:143], v[60:63], a[32:35], v[140:143]
  v_mfma_f32_16x16x32_bf16 v[172:175], v[60:63], a[36:39], v[172:175]
  s_waitcnt vmcnt(29)
  s_waitcnt lgkmcnt(0)
  v_mfma_f32_16x16x32_bf16 v[112:115], v[32:35], a[40:43], v[112:115]
  ds_read_b128 v[48:51], v5 offset:45056
  v_mfma_f32_16x16x32_bf16 v[144:147], v[32:35], a[44:47], v[144:147]
  ds_read_b128 v[52:55], v5 offset:46080
  v_mfma_f32_16x16x32_bf16 v[116:119], v[36:39], a[40:43], v[116:119]
  ds_read_b128 v[56:59], v5 offset:47104
  v_mfma_f32_16x16x32_bf16 v[148:151], v[36:39], a[44:47], v[148:151]
  ds_read_b128 v[60:63], v5 offset:48128
  v_mfma_f32_16x16x32_bf16 v[120:123], v[40:43], a[40:43], v[120:123]
  buffer_load_dwordx4 a[104:107], v5, s[12:15], s24 offen offset:1024 sc1
  v_mfma_f32_16x16x32_bf16 v[152:155], v[40:43], a[44:47], v[152:155]
  buffer_load_dwordx4 v5, s[12:15], s53 offen offset:1024 lds
  v_mfma_f32_16x16x32_bf16 v[124:127], v[44:47], a[40:43], v[124:127]
  v_mfma_f32_16x16x32_bf16 v[156:159], v[44:47], a[44:47], v[156:159]
  s_waitcnt lgkmcnt(0)
  v_mfma_f32_16x16x32_bf16 v[128:131], v[48:51], a[40:43], v[128:131]
  ds_read_b128 v[32:35], v5 offset:49152
  v_mfma_f32_16x16x32_bf16 v[160:163], v[48:51], a[44:47], v[160:163]
  ds_read_b128 v[36:39], v5 offset:50176
  v_mfma_f32_16x16x32_bf16 v[132:135], v[52:55], a[40:43], v[132:135]
  ds_read_b128 v[40:43], v5 offset:51200
  v_mfma_f32_16x16x32_bf16 v[164:167], v[52:55], a[44:47], v[164:167]
  ds_read_b128 v[44:47], v5 offset:52224
  v_mfma_f32_16x16x32_bf16 v[136:139], v[56:59], a[40:43], v[136:139]
  buffer_load_dwordx4 a[108:111], v5, s[12:15], s25 offen offset:1024 sc1
  v_mfma_f32_16x16x32_bf16 v[168:171], v[56:59], a[44:47], v[168:171]
  buffer_load_dwordx4 v5, s[12:15], s53 offen offset:2048 lds
  v_mfma_f32_16x16x32_bf16 v[140:143], v[60:63], a[40:43], v[140:143]
  v_mfma_f32_16x16x32_bf16 v[172:175], v[60:63], a[44:47], v[172:175]
  s_waitcnt vmcnt(31)
  s_waitcnt lgkmcnt(0)
  v_mfma_f32_16x16x32_bf16 v[112:115], v[32:35], a[48:51], v[112:115]
  ds_read_b128 v[48:51], v5 offset:53248
  v_mfma_f32_16x16x32_bf16 v[144:147], v[32:35], a[52:55], v[144:147]
  ds_read_b128 v[52:55], v5 offset:54272
  v_mfma_f32_16x16x32_bf16 v[116:119], v[36:39], a[48:51], v[116:119]
  ds_read_b128 v[56:59], v5 offset:55296
  v_mfma_f32_16x16x32_bf16 v[148:151], v[36:39], a[52:55], v[148:151]
  ds_read_b128 v[60:63], v5 offset:56320
  v_mfma_f32_16x16x32_bf16 v[120:123], v[40:43], a[48:51], v[120:123]
  buffer_load_dwordx4 a[112:115], v5, s[12:15], s24 offen offset:2048 sc1
  v_mfma_f32_16x16x32_bf16 v[152:155], v[40:43], a[52:55], v[152:155]
  v_mfma_f32_16x16x32_bf16 v[124:127], v[44:47], a[48:51], v[124:127]
  v_mfma_f32_16x16x32_bf16 v[156:159], v[44:47], a[52:55], v[156:159]
  s_waitcnt lgkmcnt(0)
  s_barrier
  v_mfma_f32_16x16x32_bf16 v[128:131], v[48:51], a[48:51], v[128:131]
  ds_read_b128 v[32:35], v5 offset:57344
  v_mfma_f32_16x16x32_bf16 v[160:163], v[48:51], a[52:55], v[160:163]
  ds_read_b128 v[36:39], v5 offset:58368
  v_mfma_f32_16x16x32_bf16 v[132:135], v[52:55], a[48:51], v[132:135]
  ds_read_b128 v[40:43], v5 offset:59392
  v_mfma_f32_16x16x32_bf16 v[164:167], v[52:55], a[52:55], v[164:167]
  ds_read_b128 v[44:47], v5 offset:60416
  v_mfma_f32_16x16x32_bf16 v[136:139], v[56:59], a[48:51], v[136:139]
  buffer_load_dwordx4 a[116:119], v5, s[12:15], s25 offen offset:2048 sc1
  v_mfma_f32_16x16x32_bf16 v[168:171], v[56:59], a[52:55], v[168:171]
  v_mfma_f32_16x16x32_bf16 v[140:143], v[60:63], a[48:51], v[140:143]
  v_mfma_f32_16x16x32_bf16 v[172:175], v[60:63], a[52:55], v[172:175]
  s_waitcnt vmcnt(29)
  s_waitcnt lgkmcnt(0)
  v_mfma_f32_16x16x32_bf16 v[112:115], v[32:35], a[56:59], v[112:115]
  ds_read_b128 v[48:51], v5 offset:61440
  v_mfma_f32_16x16x32_bf16 v[144:147], v[32:35], a[60:63], v[144:147]
  ds_read_b128 v[52:55], v5 offset:62464
  v_mfma_f32_16x16x32_bf16 v[116:119], v[36:39], a[56:59], v[116:119]
  ds_read_b128 v[56:59], v5 offset:63488
  v_mfma_f32_16x16x32_bf16 v[148:151], v[36:39], a[60:63], v[148:151]
  ds_read_b128 v[60:63], v5 offset:64512
  v_mfma_f32_16x16x32_bf16 v[120:123], v[40:43], a[56:59], v[120:123]
  buffer_load_dwordx4 a[120:123], v5, s[12:15], s24 offen offset:3072 sc1
  v_mfma_f32_16x16x32_bf16 v[152:155], v[40:43], a[60:63], v[152:155]
  s_add_u32 m0, s51, 0
  s_add_u32 s53, s52, 0x23000
  buffer_load_dwordx4 v5, s[12:15], s53 offen offset:0 lds
  v_mfma_f32_16x16x32_bf16 v[124:127], v[44:47], a[56:59], v[124:127]
  buffer_load_dwordx4 v5, s[12:15], s53 offen offset:1024 lds
  v_mfma_f32_16x16x32_bf16 v[156:159], v[44:47], a[60:63], v[156:159]
  s_waitcnt lgkmcnt(0)
  v_mfma_f32_16x16x32_bf16 v[128:131], v[48:51], a[56:59], v[128:131]
  ds_read_b128 v[32:35], v7 offset:0
  v_mfma_f32_16x16x32_bf16 v[160:163], v[48:51], a[60:63], v[160:163]
  ds_read_b128 v[36:39], v7 offset:1024
  v_mfma_f32_16x16x32_bf16 v[132:135], v[52:55], a[56:59], v[132:135]
  ds_read_b128 v[40:43], v7 offset:2048
  v_mfma_f32_16x16x32_bf16 v[164:167], v[52:55], a[60:63], v[164:167]
  ds_read_b128 v[44:47], v7 offset:3072
  v_mfma_f32_16x16x32_bf16 v[136:139], v[56:59], a[56:59], v[136:139]
  buffer_load_dwordx4 a[124:127], v5, s[12:15], s25 offen offset:3072 sc1
  v_mfma_f32_16x16x32_bf16 v[168:171], v[56:59], a[60:63], v[168:171]
  buffer_load_dwordx4 v5, s[12:15], s53 offen offset:2048 lds
  v_mfma_f32_16x16x32_bf16 v[140:143], v[60:63], a[56:59], v[140:143]
  v_mfma_f32_16x16x32_bf16 v[172:175], v[60:63], a[60:63], v[172:175]
  s_waitcnt vmcnt(26)
  s_waitcnt lgkmcnt(0)
  v_mfma_f32_16x16x32_bf16 v[112:115], v[32:35], a[64:67], v[112:115]
  ds_read_b128 v[48:51], v7 offset:4096
  v_mfma_f32_16x16x32_bf16 v[144:147], v[32:35], a[68:71], v[144:147]
  ds_read_b128 v[52:55], v7 offset:5120
  v_mfma_f32_16x16x32_bf16 v[116:119], v[36:39], a[64:67], v[116:119]
  ds_read_b128 v[56:59], v7 offset:6144
  v_mfma_f32_16x16x32_bf16 v[148:151], v[36:39], a[68:71], v[148:151]
  ds_read_b128 v[60:63], v7 offset:7168
  v_mfma_f32_16x16x32_bf16 v[120:123], v[40:43], a[64:67], v[120:123]
  s_add_u32 s24, s24, 4096
  buffer_load_dwordx4 a[128:131], v5, s[12:15], s24 offen offset:0 sc1
  v_mfma_f32_16x16x32_bf16 v[152:155], v[40:43], a[68:71], v[152:155]
  buffer_load_dwordx4 v5, s[12:15], s53 offen offset:3072 lds
  v_mfma_f32_16x16x32_bf16 v[124:127], v[44:47], a[64:67], v[124:127]
  v_mfma_f32_16x16x32_bf16 v[156:159], v[44:47], a[68:71], v[156:159]
  s_waitcnt lgkmcnt(0)
  v_mfma_f32_16x16x32_bf16 v[128:131], v[48:51], a[64:67], v[128:131]
  ds_read_b128 v[32:35], v7 offset:8192
  v_mfma_f32_16x16x32_bf16 v[160:163], v[48:51], a[68:71], v[160:163]
  ds_read_b128 v[36:39], v7 offset:9216
  v_mfma_f32_16x16x32_bf16 v[132:135], v[52:55], a[64:67], v[132:135]
  ds_read_b128 v[40:43], v7 offset:10240
  v_mfma_f32_16x16x32_bf16 v[164:167], v[52:55], a[68:71], v[164:167]
  ds_read_b128 v[44:47], v7 offset:11264
  v_mfma_f32_16x16x32_bf16 v[136:139], v[56:59], a[64:67], v[136:139]
  s_add_u32 s25, s25, 4096
  buffer_load_dwordx4 a[132:135], v5, s[12:15], s25 offen offset:0 sc1
  v_mfma_f32_16x16x32_bf16 v[168:171], v[56:59], a[68:71], v[168:171]
  s_add_u32 m0, s51, 4096
  s_add_u32 s53, s52, 0x24000
  buffer_load_dwordx4 v5, s[12:15], s53 offen offset:0 lds
  v_mfma_f32_16x16x32_bf16 v[140:143], v[60:63], a[64:67], v[140:143]
  v_mfma_f32_16x16x32_bf16 v[172:175], v[60:63], a[68:71], v[172:175]
  s_waitcnt vmcnt(28)
  s_waitcnt vmcnt(32)
  s_waitcnt lgkmcnt(0)
  v_mfma_f32_16x16x32_bf16 v[112:115], v[32:35], a[72:75], v[112:115]
  ds_read_b128 v[48:51], v7 offset:12288
  v_mfma_f32_16x16x32_bf16 v[144:147], v[32:35], a[76:79], v[144:147]
  ds_read_b128 v[52:55], v7 offset:13312
  v_mfma_f32_16x16x32_bf16 v[116:119], v[36:39], a[72:75], v[116:119]
  ds_read_b128 v[56:59], v7 offset:14336
  v_mfma_f32_16x16x32_bf16 v[148:151], v[36:39], a[76:79], v[148:151]
  ds_read_b128 v[60:63], v7 offset:15360
  v_mfma_f32_16x16x32_bf16 v[120:123], v[40:43], a[72:75], v[120:123]
  buffer_load_dwordx2 a[136:137], v6, s[12:15], s24 offen offset:1024 sc1
  buffer_load_dwordx2 a[138:139], v6, s[12:15], s24 offen offset:1536 sc1
  v_mfma_f32_16x16x32_bf16 v[152:155], v[40:43], a[76:79], v[152:155]
  buffer_load_dwordx4 v5, s[12:15], s53 offen offset:1024 lds
  v_mfma_f32_16x16x32_bf16 v[124:127], v[44:47], a[72:75], v[124:127]
  v_mfma_f32_16x16x32_bf16 v[156:159], v[44:47], a[76:79], v[156:159]
  s_waitcnt lgkmcnt(0)
  v_mfma_f32_16x16x32_bf16 v[128:131], v[48:51], a[72:75], v[128:131]
  ds_read_b128 v[32:35], v7 offset:16384
  v_mfma_f32_16x16x32_bf16 v[160:163], v[48:51], a[76:79], v[160:163]
  ds_read_b128 v[36:39], v7 offset:17408
  v_mfma_f32_16x16x32_bf16 v[132:135], v[52:55], a[72:75], v[132:135]
  ds_read_b128 v[40:43], v7 offset:18432
  v_mfma_f32_16x16x32_bf16 v[164:167], v[52:55], a[76:79], v[164:167]
  ds_read_b128 v[44:47], v7 offset:19456
  v_mfma_f32_16x16x32_bf16 v[136:139], v[56:59], a[72:75], v[136:139]
  buffer_load_dwordx2 a[140:141], v6, s[12:15], s25 offen offset:1024 sc1
  buffer_load_dwordx2 a[142:143], v6, s[12:15], s25 offen offset:1536 sc1
  v_add_f32 v200, v200, v202
  v_mfma_f32_16x16x32_bf16 v[168:171], v[56:59], a[76:79], v[168:171]
  buffer_load_dwordx4 v5, s[12:15], s53 offen offset:2048 lds
  v_add_f32 v201, v201, v203
  v_mfma_f32_16x16x32_bf16 v[140:143], v[60:63], a[72:75], v[140:143]
  v_mov_b32 v202, v200
  v_mov_b32 v203, v201
  v_mfma_f32_16x16x32_bf16 v[172:175], v[60:63], a[76:79], v[172:175]
  v_permlane16_swap_b32 v200, v202
  v_permlane16_swap_b32 v201, v203
  s_waitcnt vmcnt(31)
  s_waitcnt lgkmcnt(0)
  v_mfma_f32_16x16x32_bf16 v[112:115], v[32:35], a[80:83], v[112:115]
  ds_read_b128 v[48:51], v7 offset:20480
  v_mfma_f32_16x16x32_bf16 v[144:147], v[32:35], a[84:87], v[144:147]
  ds_read_b128 v[52:55], v7 offset:21504
  v_mfma_f32_16x16x32_bf16 v[116:119], v[36:39], a[80:83], v[116:119]
  ds_read_b128 v[56:59], v7 offset:22528
  v_mfma_f32_16x16x32_bf16 v[148:151], v[36:39], a[84:87], v[148:151]
  ds_read_b128 v[60:63], v7 offset:23552
  v_mfma_f32_16x16x32_bf16 v[120:123], v[40:43], a[80:83], v[120:123]
  buffer_load_dwordx4 a[144:147], v5, s[12:15], s24 offen offset:2048 sc1
  v_add_f32 v200, v200, v202
  v_mfma_f32_16x16x32_bf16 v[152:155], v[40:43], a[84:87], v[152:155]
  s_add_u32 m0, s51, 28672
  s_add_u32 s53, s52, 0x2a000
  buffer_load_dwordx4 v5, s[12:15], s53 offen offset:0 lds
  v_add_f32 v201, v201, v203
  v_mfma_f32_16x16x32_bf16 v[124:127], v[44:47], a[80:83], v[124:127]
  v_mov_b32 v202, v200
  v_mov_b32 v203, v201
  v_mfma_f32_16x16x32_bf16 v[156:159], v[44:47], a[84:87], v[156:159]
  v_permlane32_swap_b32 v200, v202
  v_permlane32_swap_b32 v201, v203
  s_waitcnt lgkmcnt(0)
  v_mfma_f32_16x16x32_bf16 v[128:131], v[48:51], a[80:83], v[128:131]
  ds_read_b128 v[32:35], v7 offset:24576
  v_mfma_f32_16x16x32_bf16 v[160:163], v[48:51], a[84:87], v[160:163]
  ds_read_b128 v[36:39], v7 offset:25600
  v_mfma_f32_16x16x32_bf16 v[132:135], v[52:55], a[80:83], v[132:135]
  ds_read_b128 v[40:43], v7 offset:26624
  v_mfma_f32_16x16x32_bf16 v[164:167], v[52:55], a[84:87], v[164:167]
  ds_read_b128 v[44:47], v7 offset:27648
  v_mfma_f32_16x16x32_bf16 v[136:139], v[56:59], a[80:83], v[136:139]
  buffer_load_dwordx4 a[148:151], v5, s[12:15], s25 offen offset:2048 sc1
  v_add_f32 v200, v200, v202
  v_mfma_f32_16x16x32_bf16 v[168:171], v[56:59], a[84:87], v[168:171]
  buffer_load_dwordx4 v5, s[12:15], s53 offen offset:1024 lds
  v_add_f32 v201, v201, v203
  v_mfma_f32_16x16x32_bf16 v[140:143], v[60:63], a[80:83], v[140:143]
  v_mul_f32 v12, 0xbacccccd, v200
  v_mul_f32 v201, 0x3acccccd, v201
  v_mfma_f32_16x16x32_bf16 v[172:175], v[60:63], a[84:87], v[172:175]
  v_fma_f32 v201, -v12, v12, v201
  v_max_f32 v201, 0, v201
  s_waitcnt vmcnt(31)
  s_waitcnt lgkmcnt(0)
  v_mfma_f32_16x16x32_bf16 v[112:115], v[32:35], a[88:91], v[112:115]
  ds_read_b128 v[48:51], v7 offset:28672
  v_mfma_f32_16x16x32_bf16 v[144:147], v[32:35], a[92:95], v[144:147]
  ds_read_b128 v[52:55], v7 offset:29696
  v_mfma_f32_16x16x32_bf16 v[116:119], v[36:39], a[88:91], v[116:119]
  ds_read_b128 v[56:59], v7 offset:30720
  v_mfma_f32_16x16x32_bf16 v[148:151], v[36:39], a[92:95], v[148:151]
  ds_read_b128 v[60:63], v7 offset:31744
  v_mfma_f32_16x16x32_bf16 v[120:123], v[40:43], a[88:91], v[120:123]
  buffer_load_dwordx4 a[152:155], v5, s[12:15], s24 offen offset:3072 sc1
  v_add_f32 v10, 0x3727c5ac, v201
  v_mfma_f32_16x16x32_bf16 v[152:155], v[40:43], a[92:95], v[152:155]
  buffer_load_dwordx4 v5, s[12:15], s53 offen offset:2048 lds
  v_rsq_f32 v14, v10
  v_mfma_f32_16x16x32_bf16 v[124:127], v[44:47], a[88:91], v[124:127]
  v_mul_f32 v14, 0xbfb8aa3b, v14
  v_add_f32 v204, v204, v206
  v_mfma_f32_16x16x32_bf16 v[156:159], v[44:47], a[92:95], v[156:159]
  v_add_f32 v205, v205, v207
  v_mov_b32 v206, v204
  s_waitcnt lgkmcnt(0)
  v_mfma_f32_16x16x32_bf16 v[128:131], v[48:51], a[88:91], v[128:131]
  ds_read_b128 v[32:35], v7 offset:32768
  v_mfma_f32_16x16x32_bf16 v[160:163], v[48:51], a[92:95], v[160:163]
  ds_read_b128 v[36:39], v7 offset:33792
  v_mfma_f32_16x16x32_bf16 v[132:135], v[52:55], a[88:91], v[132:135]
  ds_read_b128 v[40:43], v7 offset:34816
  v_mfma_f32_16x16x32_bf16 v[164:167], v[52:55], a[92:95], v[164:167]
  ds_read_b128 v[44:47], v7 offset:35840
  v_mfma_f32_16x16x32_bf16 v[136:139], v[56:59], a[88:91], v[136:139]
  buffer_load_dwordx4 a[156:159], v5, s[12:15], s25 offen offset:3072 sc1
  v_mov_b32 v207, v205
  v_mfma_f32_16x16x32_bf16 v[168:171], v[56:59], a[92:95], v[168:171]
  buffer_load_dwordx4 v5, s[12:15], s53 offen offset:3072 lds
  v_permlane16_swap_b32 v204, v206
  v_mfma_f32_16x16x32_bf16 v[140:143], v[60:63], a[88:91], v[140:143]
  v_permlane16_swap_b32 v205, v207
  v_add_f32 v204, v204, v206
  v_mfma_f32_16x16x32_bf16 v[172:175], v[60:63], a[92:95], v[172:175]
  v_add_f32 v205, v205, v207
  v_mov_b32 v206, v204
  s_waitcnt vmcnt(30)
  s_waitcnt lgkmcnt(0)
  v_mfma_f32_16x16x32_bf16 v[112:115], v[32:35], a[96:99], v[112:115]
  ds_read_b128 v[48:51], v7 offset:36864
  v_mfma_f32_16x16x32_bf16 v[144:147], v[32:35], a[100:103], v[144:147]
  ds_read_b128 v[52:55], v7 offset:37888
  v_mfma_f32_16x16x32_bf16 v[116:119], v[36:39], a[96:99], v[116:119]
  ds_read_b128 v[56:59], v7 offset:38912
  v_mfma_f32_16x16x32_bf16 v[148:151], v[36:39], a[100:103], v[148:151]
  ds_read_b128 v[60:63], v7 offset:39936
  v_mfma_f32_16x16x32_bf16 v[120:123], v[40:43], a[96:99], v[120:123]
  s_add_u32 m0, s51, 32768
  s_add_u32 s53, s52, 0x2b000
  buffer_load_dwordx4 v5, s[12:15], s53 offen offset:0 lds
  v_mov_b32 v207, v205
  v_mfma_f32_16x16x32_bf16 v[152:155], v[40:43], a[100:103], v[152:155]
  v_permlane32_swap_b32 v204, v206
  v_permlane32_swap_b32 v205, v207
  v_mfma_f32_16x16x32_bf16 v[124:127], v[44:47], a[96:99], v[124:127]
  v_add_f32 v204, v204, v206
  v_add_f32 v205, v205, v207
  v_mfma_f32_16x16x32_bf16 v[156:159], v[44:47], a[100:103], v[156:159]
  v_mul_f32 v13, 0xbacccccd, v204
  v_mul_f32 v205, 0x3acccccd, v205
  s_waitcnt lgkmcnt(0)
  v_mfma_f32_16x16x32_bf16 v[128:131], v[48:51], a[96:99], v[128:131]
  ds_read_b128 v[32:35], v7 offset:40960
  v_mfma_f32_16x16x32_bf16 v[160:163], v[48:51], a[100:103], v[160:163]
  ds_read_b128 v[36:39], v7 offset:41984
  v_mfma_f32_16x16x32_bf16 v[132:135], v[52:55], a[96:99], v[132:135]
  ds_read_b128 v[40:43], v7 offset:43008
  v_mfma_f32_16x16x32_bf16 v[164:167], v[52:55], a[100:103], v[164:167]
  ds_read_b128 v[44:47], v7 offset:44032
  v_mfma_f32_16x16x32_bf16 v[136:139], v[56:59], a[96:99], v[136:139]
  buffer_load_dwordx4 v5, s[12:15], s53 offen offset:1024 lds
  v_fma_f32 v205, -v13, v13, v205
  v_mfma_f32_16x16x32_bf16 v[168:171], v[56:59], a[100:103], v[168:171]
  v_max_f32 v205, 0, v205
  v_add_f32 v11, 0x3727c5ac, v205
  v_mfma_f32_16x16x32_bf16 v[140:143], v[60:63], a[96:99], v[140:143]
  v_rsq_f32 v15, v11
  v_mfma_f32_16x16x32_bf16 v[172:175], v[60:63], a[100:103], v[172:175]
  v_mul_f32 v15, 0xbfb8aa3b, v15
  v_lshlrev_b32 v207, 4, v3
  s_waitcnt vmcnt(28)
  s_waitcnt lgkmcnt(0)
  v_mfma_f32_16x16x32_bf16 v[112:115], v[32:35], a[104:107], v[112:115]
  ds_read_b128 v[48:51], v7 offset:45056
  v_mfma_f32_16x16x32_bf16 v[144:147], v[32:35], a[108:111], v[144:147]
  ds_read_b128 v[52:55], v7 offset:46080
  v_mfma_f32_16x16x32_bf16 v[116:119], v[36:39], a[104:107], v[116:119]
  ds_read_b128 v[56:59], v7 offset:47104
  v_mfma_f32_16x16x32_bf16 v[148:151], v[36:39], a[108:111], v[148:151]
  ds_read_b128 v[60:63], v7 offset:48128
  v_mfma_f32_16x16x32_bf16 v[120:123], v[40:43], a[104:107], v[120:123]
  buffer_load_dwordx4 v5, s[12:15], s53 offen offset:2048 lds
  v_add_u32 v207, 143360, v207
  v_mfma_f32_16x16x32_bf16 v[152:155], v[40:43], a[108:111], v[152:155]
  v_cmp_gt_u32 s[64:65], 3, v3
  s_lshr_b32 s34, s5, 1
  v_mfma_f32_16x16x32_bf16 v[124:127], v[44:47], a[104:107], v[124:127]
  s_and_b32 s35, s5, 1
  s_mul_i32 s30, s9, 0x700000
  v_mfma_f32_16x16x32_bf16 v[156:159], v[44:47], a[108:111], v[156:159]
  s_mul_i32 s8, s20, 0xe000
  s_add_u32 s30, s30, s8
  s_waitcnt lgkmcnt(0)
  s_waitcnt vmcnt(0)
  s_barrier
  v_mfma_f32_16x16x32_bf16 v[128:131], v[48:51], a[104:107], v[128:131]
  ds_read_b128 v[32:35], v7 offset:49152
  v_mfma_f32_16x16x32_bf16 v[160:163], v[48:51], a[108:111], v[160:163]
  ds_read_b128 v[36:39], v7 offset:50176
  v_mfma_f32_16x16x32_bf16 v[132:135], v[52:55], a[104:107], v[132:135]
  ds_read_b128 v[40:43], v7 offset:51200
  v_mfma_f32_16x16x32_bf16 v[164:167], v[52:55], a[108:111], v[164:167]
  ds_read_b128 v[44:47], v7 offset:52224
  v_mfma_f32_16x16x32_bf16 v[136:139], v[56:59], a[104:107], v[136:139]
  s_mul_i32 s8, s34, 0x1c00
  s_add_u32 s30, s30, s8
  v_mfma_f32_16x16x32_bf16 v[168:171], v[56:59], a[108:111], v[168:171]
  s_add_u32 s30, s30, 0x1982000
  s_lshl_b32 s32, s35, 9
  v_mfma_f32_16x16x32_bf16 v[140:143], v[60:63], a[104:107], v[140:143]
  s_add_u32 s32, s32, 6144
  s_add_u32 s32, s32, s30
  v_mfma_f32_16x16x32_bf16 v[172:175], v[60:63], a[108:111], v[172:175]
  s_mul_i32 s34, s35, 3072
  s_add_u32 s30, s30, s34
  s_waitcnt vmcnt(26)
  s_waitcnt lgkmcnt(0)
  v_mfma_f32_16x16x32_bf16 v[112:115], v[32:35], a[112:115], v[112:115]
  ds_read_b128 v[48:51], v7 offset:53248
  v_mfma_f32_16x16x32_bf16 v[144:147], v[32:35], a[116:119], v[144:147]
  ds_read_b128 v[52:55], v7 offset:54272
  v_mfma_f32_16x16x32_bf16 v[116:119], v[36:39], a[112:115], v[116:119]
  ds_read_b128 v[56:59], v7 offset:55296
  v_mfma_f32_16x16x32_bf16 v[148:151], v[36:39], a[116:119], v[148:151]
  ds_read_b128 v[60:63], v7 offset:56320
  v_mfma_f32_16x16x32_bf16 v[120:123], v[40:43], a[112:115], v[120:123]
  s_add_u32 m0, s51, 57344
  s_add_u32 s53, s52, 0x31000
  buffer_load_dwordx4 v5, s[12:15], s53 offen offset:0 lds
  s_add_u32 s31, s30, 57344
  v_mfma_f32_16x16x32_bf16 v[152:155], v[40:43], a[116:119], v[152:155]
  buffer_load_dwordx4 v5, s[12:15], s53 offen offset:1024 lds
  s_add_u32 s33, s32, 57344
  v_mfma_f32_16x16x32_bf16 v[124:127], v[44:47], a[112:115], v[124:127]
  s_mul_i32 s45, s9, 0x500000
  s_add_u32 s45, s45, 0xede000
  v_mfma_f32_16x16x32_bf16 v[156:159], v[44:47], a[116:119], v[156:159]
  s_add_u32 s44, s45, s66
  s_add_u32 s45, s45, s67
  s_waitcnt lgkmcnt(0)
  v_mfma_f32_16x16x32_bf16 v[128:131], v[48:51], a[112:115], v[128:131]
  ds_read_b128 v[32:35], v7 offset:57344
  v_mfma_f32_16x16x32_bf16 v[160:163], v[48:51], a[116:119], v[160:163]
  ds_read_b128 v[36:39], v7 offset:58368
  v_mfma_f32_16x16x32_bf16 v[132:135], v[52:55], a[112:115], v[132:135]
  ds_read_b128 v[40:43], v7 offset:59392
  v_mfma_f32_16x16x32_bf16 v[164:167], v[52:55], a[116:119], v[164:167]
  ds_read_b128 v[44:47], v7 offset:60416
  v_mfma_f32_16x16x32_bf16 v[136:139], v[56:59], a[112:115], v[136:139]
  buffer_load_dwordx4 v5, s[12:15], s53 offen offset:2048 lds
  v_mfma_f32_16x16x32_bf16 v[168:171], v[56:59], a[116:119], v[168:171]
  buffer_load_dwordx4 v5, s[12:15], s53 offen offset:3072 lds
  v_mfma_f32_16x16x32_bf16 v[140:143], v[60:63], a[112:115], v[140:143]
  v_mfma_f32_16x16x32_bf16 v[172:175], v[60:63], a[116:119], v[172:175]
  s_waitcnt vmcnt(26)
  s_waitcnt lgkmcnt(0)
  v_mfma_f32_16x16x32_bf16 v[112:115], v[32:35], a[120:123], v[112:115]
  ds_read_b128 v[48:51], v7 offset:61440
  v_mfma_f32_16x16x32_bf16 v[144:147], v[32:35], a[124:127], v[144:147]
  ds_read_b128 v[52:55], v7 offset:62464
  v_mfma_f32_16x16x32_bf16 v[116:119], v[36:39], a[120:123], v[116:119]
  ds_read_b128 v[56:59], v7 offset:63488
  v_mfma_f32_16x16x32_bf16 v[148:151], v[36:39], a[124:127], v[148:151]
  ds_read_b128 v[60:63], v7 offset:64512
  v_mfma_f32_16x16x32_bf16 v[120:123], v[40:43], a[120:123], v[120:123]
  s_add_u32 m0, s51, 61440
  s_add_u32 s53, s52, 0x32000
  buffer_load_dwordx4 v5, s[12:15], s53 offen offset:0 lds
  v_mfma_f32_16x16x32_bf16 v[152:155], v[40:43], a[124:127], v[152:155]
  buffer_load_dwordx4 v5, s[12:15], s53 offen offset:1024 lds
  v_mfma_f32_16x16x32_bf16 v[124:127], v[44:47], a[120:123], v[124:127]
  v_mfma_f32_16x16x32_bf16 v[156:159], v[44:47], a[124:127], v[156:159]
  s_waitcnt lgkmcnt(0)
  v_mfma_f32_16x16x32_bf16 v[128:131], v[48:51], a[120:123], v[128:131]
  ds_read_b128 v[32:35], v8 offset:0
  v_mfma_f32_16x16x32_bf16 v[160:163], v[48:51], a[124:127], v[160:163]
  ds_read_b128 v[36:39], v8 offset:1024
  v_mfma_f32_16x16x32_bf16 v[132:135], v[52:55], a[120:123], v[132:135]
  ds_read_b128 v[40:43], v8 offset:2048
  v_mfma_f32_16x16x32_bf16 v[164:167], v[52:55], a[124:127], v[164:167]
  ds_read_b128 v[44:47], v8 offset:3072
  v_mfma_f32_16x16x32_bf16 v[136:139], v[56:59], a[120:123], v[136:139]
  buffer_load_dwordx4 v5, s[12:15], s53 offen offset:2048 lds
  v_mfma_f32_16x16x32_bf16 v[168:171], v[56:59], a[124:127], v[168:171]
  s_add_u32 m0, s51, 86016
  s_add_u32 s53, s52, 0x38000
  buffer_load_dwordx4 v5, s[12:15], s53 offen offset:0 lds
  v_mfma_f32_16x16x32_bf16 v[140:143], v[60:63], a[120:123], v[140:143]
  v_mfma_f32_16x16x32_bf16 v[172:175], v[60:63], a[124:127], v[172:175]
  s_waitcnt vmcnt(26)
  s_waitcnt lgkmcnt(0)
  v_mfma_f32_16x16x32_bf16 v[112:115], v[32:35], a[128:131], v[112:115]
  ds_read_b128 v[48:51], v8 offset:4096
  v_mfma_f32_16x16x32_bf16 v[144:147], v[32:35], a[132:135], v[144:147]
  ds_read_b128 v[52:55], v8 offset:5120
  v_mfma_f32_16x16x32_bf16 v[116:119], v[36:39], a[128:131], v[116:119]
  ds_read_b128 v[56:59], v8 offset:6144
  v_mfma_f32_16x16x32_bf16 v[148:151], v[36:39], a[132:135], v[148:151]
  ds_read_b128 v[60:63], v8 offset:7168
  v_mfma_f32_16x16x32_bf16 v[120:123], v[40:43], a[128:131], v[120:123]
  buffer_load_dwordx4 v5, s[12:15], s53 offen offset:1024 lds
  v_mfma_f32_16x16x32_bf16 v[152:155], v[40:43], a[132:135], v[152:155]
  buffer_load_dwordx4 v5, s[12:15], s53 offen offset:2048 lds
  v_mfma_f32_16x16x32_bf16 v[124:127], v[44:47], a[128:131], v[124:127]
  v_mfma_f32_16x16x32_bf16 v[156:159], v[44:47], a[132:135], v[156:159]
  s_waitcnt lgkmcnt(0)
  v_mfma_f32_16x16x32_bf16 v[128:131], v[48:51], a[128:131], v[128:131]
  ds_read_b128 v[32:35], v8 offset:8192
  v_mfma_f32_16x16x32_bf16 v[160:163], v[48:51], a[132:135], v[160:163]
  ds_read_b128 v[36:39], v8 offset:9216
  v_mfma_f32_16x16x32_bf16 v[132:135], v[52:55], a[128:131], v[132:135]
  ds_read_b128 v[40:43], v8 offset:10240
  v_mfma_f32_16x16x32_bf16 v[164:167], v[52:55], a[132:135], v[164:167]
  ds_read_b128 v[44:47], v8 offset:11264
  v_mfma_f32_16x16x32_bf16 v[136:139], v[56:59], a[128:131], v[136:139]
  buffer_load_dwordx4 v5, s[12:15], s53 offen offset:3072 lds
  v_mfma_f32_16x16x32_bf16 v[168:171], v[56:59], a[132:135], v[168:171]
  s_add_u32 m0, s51, 90112
  s_add_u32 s53, s52, 0x39000
  buffer_load_dwordx4 v5, s[12:15], s53 offen offset:0 lds
  v_mfma_f32_16x16x32_bf16 v[140:143], v[60:63], a[128:131], v[140:143]
  v_mfma_f32_16x16x32_bf16 v[172:175], v[60:63], a[132:135], v[172:175]
  s_waitcnt vmcnt(24)
  s_waitcnt lgkmcnt(0)
  s_barrier
  v_mfma_f32_16x16x32_bf16 v[112:115], v[32:35], a[136:139], v[112:115]
  ds_read_b128 v[48:51], v5 offset:0
  v_mfma_f32_16x16x32_bf16 v[144:147], v[32:35], a[140:143], v[144:147]
  ds_read_b128 v[52:55], v5 offset:1024
  v_mfma_f32_16x16x32_bf16 v[116:119], v[36:39], a[136:139], v[116:119]
  ds_read_b128 v[56:59], v5 offset:2048
  v_mfma_f32_16x16x32_bf16 v[148:151], v[36:39], a[140:143], v[148:151]
  ds_read_b128 v[60:63], v5 offset:3072
  v_mfma_f32_16x16x32_bf16 v[120:123], v[40:43], a[136:139], v[120:123]
  buffer_load_dwordx4 v5, s[12:15], s53 offen offset:1024 lds
  v_mfma_f32_16x16x32_bf16 v[152:155], v[40:43], a[140:143], v[152:155]
  buffer_load_dwordx4 v5, s[12:15], s53 offen offset:2048 lds
  v_mfma_f32_16x16x32_bf16 v[124:127], v[44:47], a[136:139], v[124:127]
  v_mfma_f32_16x16x32_bf16 v[156:159], v[44:47], a[140:143], v[156:159]
  s_waitcnt lgkmcnt(0)
  v_mfma_f32_16x16x32_bf16 v[128:131], v[48:51], a[136:139], v[128:131]
  ds_read_b128 v[32:35], v5 offset:4096
  v_mfma_f32_16x16x32_bf16 v[160:163], v[48:51], a[140:143], v[160:163]
  ds_read_b128 v[36:39], v5 offset:5120
  v_mfma_f32_16x16x32_bf16 v[132:135], v[52:55], a[136:139], v[132:135]
  ds_read_b128 v[40:43], v5 offset:6144
  v_mfma_f32_16x16x32_bf16 v[164:167], v[52:55], a[140:143], v[164:167]
  ds_read_b128 v[44:47], v5 offset:7168
  v_mfma_f32_16x16x32_bf16 v[136:139], v[56:59], a[136:139], v[136:139]
  s_add_u32 m0, s51, 114688
  s_add_u32 s53, s52, 0x3f000
  buffer_load_dwordx4 v5, s[12:15], s53 offen offset:0 lds
  v_mfma_f32_16x16x32_bf16 v[168:171], v[56:59], a[140:143], v[168:171]
  buffer_load_dwordx4 v5, s[12:15], s53 offen offset:1024 lds
  v_mfma_f32_16x16x32_bf16 v[140:143], v[60:63], a[136:139], v[140:143]
  v_mfma_f32_16x16x32_bf16 v[172:175], v[60:63], a[140:143], v[172:175]
  s_waitcnt vmcnt(24)
  s_waitcnt lgkmcnt(0)
  v_mfma_f32_16x16x32_bf16 v[112:115], v[32:35], a[144:147], v[112:115]
  ds_read_b128 v[48:51], v5 offset:8192
  v_mfma_f32_16x16x32_bf16 v[144:147], v[32:35], a[148:151], v[144:147]
  ds_read_b128 v[52:55], v5 offset:9216
  v_mfma_f32_16x16x32_bf16 v[116:119], v[36:39], a[144:147], v[116:119]
  ds_read_b128 v[56:59], v5 offset:10240
  v_mfma_f32_16x16x32_bf16 v[148:151], v[36:39], a[148:151], v[148:151]
  ds_read_b128 v[60:63], v5 offset:11264
  v_mfma_f32_16x16x32_bf16 v[120:123], v[40:43], a[144:147], v[120:123]
  buffer_load_dwordx4 v5, s[12:15], s53 offen offset:2048 lds
  v_mfma_f32_16x16x32_bf16 v[152:155], v[40:43], a[148:151], v[152:155]
  v_mfma_f32_16x16x32_bf16 v[124:127], v[44:47], a[144:147], v[124:127]
  v_mfma_f32_16x16x32_bf16 v[156:159], v[44:47], a[148:151], v[156:159]
  s_waitcnt lgkmcnt(0)
  v_mfma_f32_16x16x32_bf16 v[128:131], v[48:51], a[144:147], v[128:131]
  ds_read_b128 v[32:35], v5 offset:12288
  v_mfma_f32_16x16x32_bf16 v[160:163], v[48:51], a[148:151], v[160:163]
  ds_read_b128 v[36:39], v5 offset:13312
  v_mfma_f32_16x16x32_bf16 v[132:135], v[52:55], a[144:147], v[132:135]
  ds_read_b128 v[40:43], v5 offset:14336
  v_mfma_f32_16x16x32_bf16 v[164:167], v[52:55], a[148:151], v[164:167]
  ds_read_b128 v[44:47], v5 offset:15360
  v_mfma_f32_16x16x32_bf16 v[136:139], v[56:59], a[144:147], v[136:139]
  buffer_load_dwordx4 v5, s[12:15], s53 offen offset:3072 lds
  v_mfma_f32_16x16x32_bf16 v[168:171], v[56:59], a[148:151], v[168:171]
  s_add_u32 m0, s51, 118784
  s_add_u32 s53, s52, 0x40000
  buffer_load_dwordx4 v5, s[12:15], s53 offen offset:0 lds
  v_mfma_f32_16x16x32_bf16 v[140:143], v[60:63], a[144:147], v[140:143]
  v_mfma_f32_16x16x32_bf16 v[172:175], v[60:63], a[148:151], v[172:175]
  s_waitcnt vmcnt(23)
  s_waitcnt lgkmcnt(0)
  v_mfma_f32_16x16x32_bf16 v[112:115], v[32:35], a[152:155], v[112:115]
  ds_read_b128 v[48:51], v5 offset:16384
  v_mfma_f32_16x16x32_bf16 v[144:147], v[32:35], a[156:159], v[144:147]
  ds_read_b128 v[52:55], v5 offset:17408
  v_mfma_f32_16x16x32_bf16 v[116:119], v[36:39], a[152:155], v[116:119]
  ds_read_b128 v[56:59], v5 offset:18432
  v_mfma_f32_16x16x32_bf16 v[148:151], v[36:39], a[156:159], v[148:151]
  ds_read_b128 v[60:63], v5 offset:19456
  v_mfma_f32_16x16x32_bf16 v[120:123], v[40:43], a[152:155], v[120:123]
  buffer_load_dwordx4 v5, s[12:15], s53 offen offset:1024 lds
  v_mfma_f32_16x16x32_bf16 v[152:155], v[40:43], a[156:159], v[152:155]
  v_mfma_f32_16x16x32_bf16 v[124:127], v[44:47], a[152:155], v[124:127]
  v_mfma_f32_16x16x32_bf16 v[156:159], v[44:47], a[156:159], v[156:159]
  s_waitcnt lgkmcnt(0)
  v_mfma_f32_16x16x32_bf16 v[128:131], v[48:51], a[152:155], v[128:131]
  ds_read_b128 v[32:35], v5 offset:20480
  v_mfma_f32_16x16x32_bf16 v[160:163], v[48:51], a[156:159], v[160:163]
  ds_read_b128 v[36:39], v5 offset:21504
  v_mfma_f32_16x16x32_bf16 v[132:135], v[52:55], a[152:155], v[132:135]
  ds_read_b128 v[40:43], v5 offset:22528
  v_mfma_f32_16x16x32_bf16 v[164:167], v[52:55], a[156:159], v[164:167]
  buffer_load_dwordx4 v5, s[12:15], s53 offen offset:2048 lds
  v_mfma_f32_16x16x32_bf16 v[136:139], v[56:59], a[152:155], v[136:139]
  v_mfma_f32_16x16x32_bf16 v[168:171], v[56:59], a[156:159], v[168:171]
  v_mfma_f32_16x16x32_bf16 v[140:143], v[60:63], a[152:155], v[140:143]
  v_mfma_f32_16x16x32_bf16 v[172:175], v[60:63], a[156:159], v[172:175]
  s_waitcnt lgkmcnt(0)
  v_mfma_f32_16x16x32_bf16 v[64:67], v[32:35], a[0:3], 0
  ds_read_b128 v[48:51], v5 offset:23552
  v_mfma_f32_16x16x32_bf16 v[88:91], v[32:35], a[4:7], 0
  ds_read_b128 v[52:55], v5 offset:24576
  v_mfma_f32_16x16x32_bf16 v[68:71], v[36:39], a[0:3], 0
  ds_read_b128 v[56:59], v5 offset:25600
  v_mfma_f32_16x16x32_bf16 v[92:95], v[36:39], a[4:7], 0
  s_add_u32 s58, s48, 5120
  buffer_load_dwordx4 v[208:211], v9, s[12:15], s58 offen
  v_mfma_f32_16x16x32_bf16 v[72:75], v[40:43], a[0:3], 0
  v_mfma_f32_16x16x32_bf16 v[96:99], v[40:43], a[4:7], 0
  s_waitcnt lgkmcnt(0)
  v_mfma_f32_16x16x32_bf16 v[76:79], v[48:51], a[0:3], 0
  ds_read_b128 v[32:35], v5 offset:26624
  ds_read_b128 v[176:179], v207 offset:0
  ds_read_b128 v[184:187], v207 offset:1024
  v_mfma_f32_16x16x32_bf16 v[100:103], v[48:51], a[4:7], 0
  ds_read_b128 v[36:39], v5 offset:27648
  ds_read_b128 v[180:183], v207 offset:64
  ds_read_b128 v[188:191], v207 offset:1088
  v_mfma_f32_16x16x32_bf16 v[80:83], v[52:55], a[0:3], 0
  ds_read_b128 v[40:43], v5 offset:28672
  s_waitcnt lgkmcnt(1)
  v_fma_f32 v112, v176, v12, v112
  v_mfma_f32_16x16x32_bf16 v[104:107], v[52:55], a[4:7], 0
  s_add_u32 s58, s48, 20480
  buffer_load_dwordx4 v[212:215], v5, s[12:15], s58 offen offset:0
  v_fma_f32 v113, v177, v12, v113
  v_fma_f32 v114, v178, v12, v114
  v_mfma_f32_16x16x32_bf16 v[84:87], v[56:59], a[0:3], 0
  v_fma_f32 v115, v179, v12, v115
  v_fma_f32 v116, v180, v12, v116
  v_mfma_f32_16x16x32_bf16 v[108:111], v[56:59], a[4:7], 0
  v_fma_f32 v117, v181, v12, v117
  s_waitcnt lgkmcnt(0)
  v_mfma_f32_16x16x32_bf16 v[64:67], v[32:35], a[8:11], v[64:67]
  ds_read_b128 v[48:51], v5 offset:29696
  v_fma_f32 v118, v182, v12, v118
  v_fma_f32 v119, v183, v12, v119
  v_mfma_f32_16x16x32_bf16 v[88:91], v[32:35], a[12:15], v[88:91]
  ds_read_b128 v[52:55], v5 offset:30720
  v_mul_f32 v192, v112, v14
  v_mul_f32 v193, v113, v14
  v_mfma_f32_16x16x32_bf16 v[68:71], v[36:39], a[8:11], v[68:71]
  ds_read_b128 v[56:59], v5 offset:31744
  v_mul_f32 v194, v114, v14
  v_mul_f32 v195, v115, v14
  v_mfma_f32_16x16x32_bf16 v[92:95], v[36:39], a[12:15], v[92:95]
  buffer_load_dwordx4 v[216:219], v5, s[12:15], s58 offen offset:1024
  v_mul_f32 v196, v116, v14
  v_mul_f32 v197, v117, v14
  v_mfma_f32_16x16x32_bf16 v[72:75], v[40:43], a[8:11], v[72:75]
  v_mul_f32 v198, v118, v14
  v_mul_f32 v199, v119, v14
  v_mfma_f32_16x16x32_bf16 v[96:99], v[40:43], a[12:15], v[96:99]
  s_waitcnt lgkmcnt(0)
  v_mfma_f32_16x16x32_bf16 v[76:79], v[48:51], a[8:11], v[76:79]
  ds_read_b128 v[32:35], v5 offset:32768
  v_exp_f32 v192, v192
  v_mfma_f32_16x16x32_bf16 v[100:103], v[48:51], a[12:15], v[100:103]
  ds_read_b128 v[36:39], v5 offset:33792
  v_fma_f32 v128, v184, v12, v128
  v_exp_f32 v193, v193
  v_mfma_f32_16x16x32_bf16 v[80:83], v[52:55], a[8:11], v[80:83]
  ds_read_b128 v[40:43], v5 offset:34816
  v_fma_f32 v129, v185, v12, v129
  v_exp_f32 v194, v194
  v_mfma_f32_16x16x32_bf16 v[104:107], v[52:55], a[12:15], v[104:107]
  buffer_load_dwordx4 v[220:223], v5, s[12:15], s58 offen offset:2048
  v_fma_f32 v130, v186, v12, v130
  v_mfma_f32_16x16x32_bf16 v[84:87], v[56:59], a[8:11], v[84:87]
  v_exp_f32 v195, v195
  v_mfma_f32_16x16x32_bf16 v[108:111], v[56:59], a[12:15], v[108:111]
  s_waitcnt lgkmcnt(0)
  v_mfma_f32_16x16x32_bf16 v[64:67], v[32:35], a[16:19], v[64:67]
  ds_read_b128 v[48:51], v5 offset:35840
  v_fma_f32 v131, v187, v12, v131
  v_exp_f32 v196, v196
  v_mfma_f32_16x16x32_bf16 v[88:91], v[32:35], a[20:23], v[88:91]
  ds_read_b128 v[52:55], v5 offset:36864
  v_fma_f32 v132, v188, v12, v132
  v_exp_f32 v197, v197
  v_mfma_f32_16x16x32_bf16 v[68:71], v[36:39], a[16:19], v[68:71]
  ds_read_b128 v[56:59], v5 offset:37888
  v_fma_f32 v133, v189, v12, v133
  v_mfma_f32_16x16x32_bf16 v[92:95], v[36:39], a[20:23], v[92:95]
  buffer_load_dwordx4 v[224:227], v5, s[12:15], s58 offen offset:3072
  v_exp_f32 v198, v198
  v_mfma_f32_16x16x32_bf16 v[72:75], v[40:43], a[16:19], v[72:75]
  v_fma_f32 v134, v190, v12, v134
  v_mfma_f32_16x16x32_bf16 v[96:99], v[40:43], a[20:23], v[96:99]
  s_waitcnt lgkmcnt(0)
  v_mfma_f32_16x16x32_bf16 v[76:79], v[48:51], a[16:19], v[76:79]
  ds_read_b128 v[32:35], v5 offset:38912
  v_exp_f32 v199, v199
  v_mfma_f32_16x16x32_bf16 v[100:103], v[48:51], a[20:23], v[100:103]
  ds_read_b128 v[36:39], v5 offset:39936
  v_fma_f32 v135, v191, v12, v135
  v_fma_f32 v192, v192, v10, v10
  v_mfma_f32_16x16x32_bf16 v[80:83], v[52:55], a[16:19], v[80:83]
  ds_read_b128 v[40:43], v5 offset:40960
  v_fma_f32 v193, v193, v10, v10
  v_fma_f32 v194, v194, v10, v10
  v_mfma_f32_16x16x32_bf16 v[104:107], v[52:55], a[20:23], v[104:107]
  buffer_load_dwordx4 v[228:231], v9, s[12:15], s58 offen
  v_fma_f32 v195, v195, v10, v10
  v_fma_f32 v196, v196, v10, v10
  v_mfma_f32_16x16x32_bf16 v[84:87], v[56:59], a[16:19], v[84:87]
  v_fma_f32 v197, v197, v10, v10
  v_fma_f32 v198, v198, v10, v10
  v_mfma_f32_16x16x32_bf16 v[108:111], v[56:59], a[20:23], v[108:111]
  s_waitcnt lgkmcnt(0)
  v_mfma_f32_16x16x32_bf16 v[64:67], v[32:35], a[24:27], v[64:67]
  ds_read_b128 v[48:51], v5 offset:41984
  v_fma_f32 v199, v199, v10, v10
  v_rcp_f32 v192, v192
  v_mfma_f32_16x16x32_bf16 v[88:91], v[32:35], a[28:31], v[88:91]
  ds_read_b128 v[52:55], v5 offset:43008
  v_mul_f32 v112, v112, v128
  v_rcp_f32 v193, v193
  v_mfma_f32_16x16x32_bf16 v[68:71], v[36:39], a[24:27], v[68:71]
  ds_read_b128 v[56:59], v5 offset:44032
  v_mul_f32 v113, v113, v129
  v_mfma_f32_16x16x32_bf16 v[92:95], v[36:39], a[28:31], v[92:95]
  s_add_u32 s58, s48, 40960
  buffer_load_dwordx4 v[232:235], v5, s[12:15], s58 offen offset:0
  v_rcp_f32 v194, v194
  v_mfma_f32_16x16x32_bf16 v[72:75], v[40:43], a[24:27], v[72:75]
  v_mul_f32 v114, v114, v130
  v_mfma_f32_16x16x32_bf16 v[96:99], v[40:43], a[28:31], v[96:99]
  s_waitcnt lgkmcnt(0)
  v_mfma_f32_16x16x32_bf16 v[76:79], v[48:51], a[24:27], v[76:79]
  ds_read_b128 v[32:35], v5 offset:45056
  v_rcp_f32 v195, v195
  v_mfma_f32_16x16x32_bf16 v[100:103], v[48:51], a[28:31], v[100:103]
  ds_read_b128 v[36:39], v5 offset:46080
  v_mul_f32 v115, v115, v131
  v_rcp_f32 v196, v196
  v_mfma_f32_16x16x32_bf16 v[80:83], v[52:55], a[24:27], v[80:83]
  ds_read_b128 v[40:43], v5 offset:47104
  v_mul_f32 v116, v116, v132
  v_rcp_f32 v197, v197
  v_mfma_f32_16x16x32_bf16 v[104:107], v[52:55], a[28:31], v[104:107]
  buffer_load_dwordx4 v[236:239], v5, s[12:15], s58 offen offset:1024
  v_mul_f32 v117, v117, v133
  v_mfma_f32_16x16x32_bf16 v[84:87], v[56:59], a[24:27], v[84:87]
  v_rcp_f32 v198, v198
  v_mfma_f32_16x16x32_bf16 v[108:111], v[56:59], a[28:31], v[108:111]
  s_waitcnt lgkmcnt(0)
  v_mfma_f32_16x16x32_bf16 v[64:67], v[32:35], a[32:35], v[64:67]
  ds_read_b128 v[48:51], v5 offset:48128
  v_mul_f32 v118, v118, v134
  v_rcp_f32 v199, v199
  v_mfma_f32_16x16x32_bf16 v[88:91], v[32:35], a[36:39], v[88:91]
  ds_read_b128 v[52:55], v5 offset:49152
  v_mul_f32 v119, v119, v135
  v_mul_f32 v112, v112, v192
  v_mfma_f32_16x16x32_bf16 v[68:71], v[36:39], a[32:35], v[68:71]
  ds_read_b128 v[56:59], v5 offset:50176
  v_mul_f32 v113, v113, v193
  v_mul_f32 v114, v114, v194
  v_mfma_f32_16x16x32_bf16 v[92:95], v[36:39], a[36:39], v[92:95]
  buffer_load_dwordx4 v[240:243], v5, s[12:15], s58 offen offset:2048
  v_mul_f32 v115, v115, v195
  v_mfma_f32_16x16x32_bf16 v[72:75], v[40:43], a[32:35], v[72:75]
  v_mul_f32 v116, v116, v196
  v_mul_f32 v117, v117, v197
  v_mfma_f32_16x16x32_bf16 v[96:99], v[40:43], a[36:39], v[96:99]
  s_waitcnt lgkmcnt(0)
  v_mfma_f32_16x16x32_bf16 v[76:79], v[48:51], a[32:35], v[76:79]
  ds_read_b128 v[32:35], v5 offset:51200
  v_mul_f32 v118, v118, v198
  v_mul_f32 v119, v119, v199
  v_mfma_f32_16x16x32_bf16 v[100:103], v[48:51], a[36:39], v[100:103]
  ds_read_b128 v[36:39], v5 offset:52224
  v_cvt_pk_bf16_f32 v128, v112, v113
  v_cvt_pk_bf16_f32 v129, v114, v115
  v_mfma_f32_16x16x32_bf16 v[80:83], v[52:55], a[32:35], v[80:83]
  ds_read_b128 v[40:43], v5 offset:53248
  v_cvt_pk_bf16_f32 v130, v116, v117
  v_cvt_pk_bf16_f32 v131, v118, v119
  v_mfma_f32_16x16x32_bf16 v[104:107], v[52:55], a[36:39], v[104:107]
  buffer_load_dwordx4 v[244:247], v5, s[12:15], s58 offen offset:3072
  buffer_store_dwordx4 v[128:131], v5, s[12:15], s30 offen offset:0 sc1
  v_fma_f32 v144, v176, v13, v144
  v_mfma_f32_16x16x32_bf16 v[84:87], v[56:59], a[32:35], v[84:87]
  v_fma_f32 v145, v177, v13, v145
  v_fma_f32 v146, v178, v13, v146
  v_mfma_f32_16x16x32_bf16 v[108:111], v[56:59], a[36:39], v[108:111]
  s_waitcnt lgkmcnt(0)
  s_waitcnt vmcnt(11)
  s_barrier
  v_mfma_f32_16x16x32_bf16 v[64:67], v[32:35], a[40:43], v[64:67]
  ds_read_b128 v[48:51], v5 offset:54272
  v_fma_f32 v147, v179, v13, v147
  v_fma_f32 v148, v180, v13, v148
  v_mfma_f32_16x16x32_bf16 v[88:91], v[32:35], a[44:47], v[88:91]
  ds_read_b128 v[52:55], v5 offset:55296
  v_fma_f32 v149, v181, v13, v149
  v_fma_f32 v150, v182, v13, v150
  v_mfma_f32_16x16x32_bf16 v[68:71], v[36:39], a[40:43], v[68:71]
  ds_read_b128 v[56:59], v5 offset:56320
  v_fma_f32 v151, v183, v13, v151
  v_mul_f32 v192, v144, v15
  v_mfma_f32_16x16x32_bf16 v[92:95], v[36:39], a[44:47], v[92:95]
  buffer_load_dwordx4 v[248:251], v9, s[12:15], s58 offen
  v_mul_f32 v193, v145, v15
  v_mul_f32 v194, v146, v15
  v_mfma_f32_16x16x32_bf16 v[72:75], v[40:43], a[40:43], v[72:75]
  v_mul_f32 v195, v147, v15
  v_mul_f32 v196, v148, v15
  v_mfma_f32_16x16x32_bf16 v[96:99], v[40:43], a[44:47], v[96:99]
  s_waitcnt lgkmcnt(0)
  v_mfma_f32_16x16x32_bf16 v[76:79], v[48:51], a[40:43], v[76:79]
  ds_read_b128 v[32:35], v5 offset:57344
  v_mul_f32 v197, v149, v15
  v_mul_f32 v198, v150, v15
  v_mfma_f32_16x16x32_bf16 v[100:103], v[48:51], a[44:47], v[100:103]
  ds_read_b128 v[36:39], v5 offset:58368
  v_mul_f32 v199, v151, v15
  v_exp_f32 v192, v192
  v_mfma_f32_16x16x32_bf16 v[80:83], v[52:55], a[40:43], v[80:83]
  ds_read_b128 v[40:43], v5 offset:59392
  v_fma_f32 v160, v184, v13, v160
  v_exp_f32 v193, v193
  v_mfma_f32_16x16x32_bf16 v[104:107], v[52:55], a[44:47], v[104:107]
  s_add_u32 s58, s48, 56320
  buffer_load_dwordx4 v[252:255], v5, s[12:15], s58 offen offset:0
  v_fma_f32 v161, v185, v13, v161
  v_mfma_f32_16x16x32_bf16 v[84:87], v[56:59], a[40:43], v[84:87]
  v_exp_f32 v194, v194
  v_mfma_f32_16x16x32_bf16 v[108:111], v[56:59], a[44:47], v[108:111]
  s_waitcnt lgkmcnt(0)
  v_mfma_f32_16x16x32_bf16 v[64:67], v[32:35], a[48:51], v[64:67]
  ds_read_b128 v[48:51], v5 offset:60416
  v_fma_f32 v162, v186, v13, v162
  v_exp_f32 v195, v195
  v_mfma_f32_16x16x32_bf16 v[88:91], v[32:35], a[52:55], v[88:91]
  ds_read_b128 v[52:55], v5 offset:61440
  v_fma_f32 v163, v187, v13, v163
  v_exp_f32 v196, v196
  v_mfma_f32_16x16x32_bf16 v[68:71], v[36:39], a[48:51], v[68:71]
  ds_read_b128 v[56:59], v5 offset:62464
  v_fma_f32 v164, v188, v13, v164
  v_mfma_f32_16x16x32_bf16 v[92:95], v[36:39], a[52:55], v[92:95]
  s_add_u32 s58, s48, 56320
  buffer_load_dwordx4 a[0:3], v5, s[12:15], s58 offen offset:1024
  v_exp_f32 v197, v197
  v_mfma_f32_16x16x32_bf16 v[72:75], v[40:43], a[48:51], v[72:75]
  buffer_load_dwordx4 a[4:7], v5, s[12:15], s58 offen offset:2048
  v_fma_f32 v165, v189, v13, v165
  v_mfma_f32_16x16x32_bf16 v[96:99], v[40:43], a[52:55], v[96:99]
  s_waitcnt lgkmcnt(0)
  v_mfma_f32_16x16x32_bf16 v[76:79], v[48:51], a[48:51], v[76:79]
  ds_read_b128 v[32:35], v5 offset:63488
  v_exp_f32 v198, v198
  v_mfma_f32_16x16x32_bf16 v[100:103], v[48:51], a[52:55], v[100:103]
  ds_read_b128 v[36:39], v5 offset:64512
  v_fma_f32 v166, v190, v13, v166
  v_exp_f32 v199, v199
  v_mfma_f32_16x16x32_bf16 v[80:83], v[52:55], a[48:51], v[80:83]
  ds_read_b128 v[40:43], v7 offset:0
  v_fma_f32 v167, v191, v13, v167
  v_fma_f32 v192, v192, v11, v11
  v_mfma_f32_16x16x32_bf16 v[104:107], v[52:55], a[52:55], v[104:107]
  buffer_load_dwordx4 a[8:11], v5, s[12:15], s58 offen offset:3072
  v_fma_f32 v193, v193, v11, v11
  v_mfma_f32_16x16x32_bf16 v[84:87], v[56:59], a[48:51], v[84:87]
  buffer_load_dwordx4 a[12:15], v9, s[12:15], s58 offen
  v_fma_f32 v194, v194, v11, v11
  v_mfma_f32_16x16x32_bf16 v[108:111], v[56:59], a[52:55], v[108:111]
  v_fma_f32 v195, v195, v11, v11
  s_waitcnt lgkmcnt(0)
  v_mfma_f32_16x16x32_bf16 v[64:67], v[32:35], a[56:59], v[64:67]
  ds_read_b128 v[48:51], v7 offset:1024
  v_fma_f32 v196, v196, v11, v11
  v_fma_f32 v197, v197, v11, v11
  v_mfma_f32_16x16x32_bf16 v[88:91], v[32:35], a[60:63], v[88:91]
  ds_read_b128 v[52:55], v7 offset:2048
  v_fma_f32 v198, v198, v11, v11
  v_fma_f32 v199, v199, v11, v11
  v_mfma_f32_16x16x32_bf16 v[68:71], v[36:39], a[56:59], v[68:71]
  ds_read_b128 v[56:59], v7 offset:3072
  v_rcp_f32 v192, v192
  v_mfma_f32_16x16x32_bf16 v[92:95], v[36:39], a[60:63], v[92:95]
  s_add_u32 s58, s48, 10240
  buffer_load_dwordx4 a[16:19], v5, s[12:15], s58 offen offset:0
  v_mul_f32 v144, v144, v160
  v_rcp_f32 v193, v193
  v_mfma_f32_16x16x32_bf16 v[72:75], v[40:43], a[56:59], v[72:75]
  buffer_load_dwordx4 a[20:23], v5, s[12:15], s58 offen offset:1024
  v_mul_f32 v145, v145, v161
  v_mfma_f32_16x16x32_bf16 v[96:99], v[40:43], a[60:63], v[96:99]
  v_rcp_f32 v194, v194
  s_waitcnt lgkmcnt(0)
  v_mfma_f32_16x16x32_bf16 v[76:79], v[48:51], a[56:59], v[76:79]
  ds_read_b128 v[32:35], v7 offset:4096
  v_mul_f32 v146, v146, v162
  v_rcp_f32 v195, v195
  v_mfma_f32_16x16x32_bf16 v[100:103], v[48:51], a[60:63], v[100:103]
  ds_read_b128 v[36:39], v7 offset:5120
  v_mul_f32 v147, v147, v163
  v_rcp_f32 v196, v196
  v_mfma_f32_16x16x32_bf16 v[80:83], v[52:55], a[56:59], v[80:83]
  ds_read_b128 v[40:43], v7 offset:6144
  v_mul_f32 v148, v148, v164
  v_mfma_f32_16x16x32_bf16 v[104:107], v[52:55], a[60:63], v[104:107]
  buffer_load_dwordx4 a[24:27], v5, s[12:15], s58 offen offset:2048
  v_rcp_f32 v197, v197
  v_mfma_f32_16x16x32_bf16 v[84:87], v[56:59], a[56:59], v[84:87]
  buffer_load_dwordx4 a[28:31], v5, s[12:15], s58 offen offset:3072
  v_mfma_f32_16x16x32_bf16 v[108:111], v[56:59], a[60:63], v[108:111]
  s_waitcnt lgkmcnt(0)
  v_mfma_f32_16x16x32_bf16 v[64:67], v[32:35], a[64:67], v[64:67]
  ds_read_b128 v[48:51], v7 offset:7168
  v_mul_f32 v149, v149, v165
  v_rcp_f32 v198, v198
  v_mfma_f32_16x16x32_bf16 v[88:91], v[32:35], a[68:71], v[88:91]
  ds_read_b128 v[52:55], v7 offset:8192
  v_mul_f32 v150, v150, v166
  v_rcp_f32 v199, v199
  v_mfma_f32_16x16x32_bf16 v[68:71], v[36:39], a[64:67], v[68:71]
  ds_read_b128 v[56:59], v7 offset:9216
  v_mul_f32 v151, v151, v167
  v_mfma_f32_16x16x32_bf16 v[92:95], v[36:39], a[68:71], v[92:95]
  buffer_load_dwordx4 a[32:35], v9, s[12:15], s58 offen
  v_mul_f32 v144, v144, v192
  v_mfma_f32_16x16x32_bf16 v[72:75], v[40:43], a[64:67], v[72:75]
  s_add_u32 s58, s48, 25600
  buffer_load_dwordx4 a[36:39], v5, s[12:15], s58 offen offset:0
  v_mul_f32 v145, v145, v193
  v_mfma_f32_16x16x32_bf16 v[96:99], v[40:43], a[68:71], v[96:99]
  v_mul_f32 v146, v146, v194
  s_waitcnt lgkmcnt(0)
  v_mfma_f32_16x16x32_bf16 v[76:79], v[48:51], a[64:67], v[76:79]
  ds_read_b128 v[32:35], v7 offset:10240
  v_mul_f32 v147, v147, v195
  v_mul_f32 v148, v148, v196
  v_mfma_f32_16x16x32_bf16 v[100:103], v[48:51], a[68:71], v[100:103]
  ds_read_b128 v[36:39], v7 offset:11264
  v_mul_f32 v149, v149, v197
  v_mul_f32 v150, v150, v198
  v_mfma_f32_16x16x32_bf16 v[80:83], v[52:55], a[64:67], v[80:83]
  ds_read_b128 v[40:43], v7 offset:12288
  v_mul_f32 v151, v151, v199
  v_cvt_pk_bf16_f32 v160, v144, v145
  v_mfma_f32_16x16x32_bf16 v[104:107], v[52:55], a[68:71], v[104:107]
  buffer_load_dwordx4 a[40:43], v5, s[12:15], s58 offen offset:1024
  v_cvt_pk_bf16_f32 v161, v146, v147
  v_cvt_pk_bf16_f32 v162, v148, v149
  v_mfma_f32_16x16x32_bf16 v[84:87], v[56:59], a[64:67], v[84:87]
  buffer_load_dwordx4 a[44:47], v5, s[12:15], s58 offen offset:2048
  v_cvt_pk_bf16_f32 v163, v150, v151
  v_mfma_f32_16x16x32_bf16 v[108:111], v[56:59], a[68:71], v[108:111]
  buffer_store_dwordx4 v[160:163], v5, s[12:15], s31 offen offset:0 sc1
  s_waitcnt lgkmcnt(0)
  v_mfma_f32_16x16x32_bf16 v[64:67], v[32:35], a[72:75], v[64:67]
  ds_read_b128 v[48:51], v7 offset:13312
  ds_read_b128 v[176:179], v207 offset:128
  ds_read_b128 v[184:187], v207 offset:1152
  v_mfma_f32_16x16x32_bf16 v[88:91], v[32:35], a[76:79], v[88:91]
  ds_read_b128 v[52:55], v7 offset:14336
  ds_read_b128 v[180:183], v207 offset:192
  ds_read_b128 v[188:191], v207 offset:1216
  v_mfma_f32_16x16x32_bf16 v[68:71], v[36:39], a[72:75], v[68:71]
  ds_read_b128 v[56:59], v7 offset:15360
  s_waitcnt lgkmcnt(1)
  v_fma_f32 v120, v176, v12, v120
  v_mfma_f32_16x16x32_bf16 v[92:95], v[36:39], a[76:79], v[92:95]
  buffer_load_dwordx4 a[48:51], v5, s[12:15], s58 offen offset:3072
  v_fma_f32 v121, v177, v12, v121
  v_fma_f32 v122, v178, v12, v122
  v_mfma_f32_16x16x32_bf16 v[72:75], v[40:43], a[72:75], v[72:75]
  buffer_load_dwordx4 a[52:55], v9, s[12:15], s58 offen
  v_fma_f32 v123, v179, v12, v123
  v_fma_f32 v124, v180, v12, v124
  v_mfma_f32_16x16x32_bf16 v[96:99], v[40:43], a[76:79], v[96:99]
  v_fma_f32 v125, v181, v12, v125
  s_waitcnt lgkmcnt(0)
  v_mfma_f32_16x16x32_bf16 v[76:79], v[48:51], a[72:75], v[76:79]
  ds_read_b128 v[32:35], v7 offset:16384
  v_fma_f32 v126, v182, v12, v126
  v_fma_f32 v127, v183, v12, v127
  v_mfma_f32_16x16x32_bf16 v[100:103], v[48:51], a[76:79], v[100:103]
  ds_read_b128 v[36:39], v7 offset:17408
  v_mul_f32 v192, v120, v14
  v_mul_f32 v193, v121, v14
  v_mfma_f32_16x16x32_bf16 v[80:83], v[52:55], a[72:75], v[80:83]
  ds_read_b128 v[40:43], v7 offset:18432
  v_mul_f32 v194, v122, v14
  v_mul_f32 v195, v123, v14
  v_mfma_f32_16x16x32_bf16 v[104:107], v[52:55], a[76:79], v[104:107]
  s_add_u32 s58, s48, 46080
  buffer_load_dwordx4 a[56:59], v5, s[12:15], s58 offen offset:0
  v_mul_f32 v196, v124, v14
  v_mul_f32 v197, v125, v14
  v_mfma_f32_16x16x32_bf16 v[84:87], v[56:59], a[72:75], v[84:87]
  buffer_load_dwordx4 a[60:63], v5, s[12:15], s58 offen offset:1024
  v_mul_f32 v198, v126, v14
  v_mfma_f32_16x16x32_bf16 v[108:111], v[56:59], a[76:79], v[108:111]
  v_mul_f32 v199, v127, v14
  s_waitcnt lgkmcnt(0)
  v_mfma_f32_16x16x32_bf16 v[64:67], v[32:35], a[80:83], v[64:67]
  ds_read_b128 v[48:51], v7 offset:19456
  v_exp_f32 v192, v192
  v_mfma_f32_16x16x32_bf16 v[88:91], v[32:35], a[84:87], v[88:91]
  ds_read_b128 v[52:55], v7 offset:20480
  v_fma_f32 v136, v184, v12, v136
  v_exp_f32 v193, v193
  v_mfma_f32_16x16x32_bf16 v[68:71], v[36:39], a[80:83], v[68:71]
  ds_read_b128 v[56:59], v7 offset:21504
  v_fma_f32 v137, v185, v12, v137
  v_exp_f32 v194, v194
  v_mfma_f32_16x16x32_bf16 v[92:95], v[36:39], a[84:87], v[92:95]
  buffer_load_dwordx4 a[64:67], v5, s[12:15], s58 offen offset:2048
  v_fma_f32 v138, v186, v12, v138
  v_mfma_f32_16x16x32_bf16 v[72:75], v[40:43], a[80:83], v[72:75]
  buffer_load_dwordx4 a[68:71], v5, s[12:15], s58 offen offset:3072
  v_exp_f32 v195, v195
  v_mfma_f32_16x16x32_bf16 v[96:99], v[40:43], a[84:87], v[96:99]
  s_waitcnt lgkmcnt(0)
  v_mfma_f32_16x16x32_bf16 v[76:79], v[48:51], a[80:83], v[76:79]
  ds_read_b128 v[32:35], v7 offset:22528
  v_fma_f32 v139, v187, v12, v139
  v_exp_f32 v196, v196
  v_mfma_f32_16x16x32_bf16 v[100:103], v[48:51], a[84:87], v[100:103]
  ds_read_b128 v[36:39], v7 offset:23552
  v_fma_f32 v140, v188, v12, v140
  v_exp_f32 v197, v197
  v_mfma_f32_16x16x32_bf16 v[80:83], v[52:55], a[80:83], v[80:83]
  ds_read_b128 v[40:43], v7 offset:24576
  v_fma_f32 v141, v189, v12, v141
  v_mfma_f32_16x16x32_bf16 v[104:107], v[52:55], a[84:87], v[104:107]
  buffer_load_dwordx4 a[72:75], v9, s[12:15], s58 offen
  v_exp_f32 v198, v198
  v_mfma_f32_16x16x32_bf16 v[84:87], v[56:59], a[80:83], v[84:87]
  s_add_u32 s58, s48, 61440
  buffer_load_dwordx4 a[76:79], v5, s[12:15], s58 offen offset:0
  v_fma_f32 v142, v190, v12, v142
  v_mfma_f32_16x16x32_bf16 v[108:111], v[56:59], a[84:87], v[108:111]
  s_waitcnt lgkmcnt(0)
  v_mfma_f32_16x16x32_bf16 v[64:67], v[32:35], a[88:91], v[64:67]
  ds_read_b128 v[48:51], v7 offset:25600
  v_exp_f32 v199, v199
  v_mfma_f32_16x16x32_bf16 v[88:91], v[32:35], a[92:95], v[88:91]
  ds_read_b128 v[52:55], v7 offset:26624
  v_fma_f32 v143, v191, v12, v143
  v_fma_f32 v192, v192, v10, v10
  v_mfma_f32_16x16x32_bf16 v[68:71], v[36:39], a[88:91], v[68:71]
  ds_read_b128 v[56:59], v7 offset:27648
  v_fma_f32 v193, v193, v10, v10
  v_fma_f32 v194, v194, v10, v10
  v_mfma_f32_16x16x32_bf16 v[92:95], v[36:39], a[92:95], v[92:95]
  buffer_load_dwordx4 a[80:83], v5, s[12:15], s58 offen offset:1024
  v_fma_f32 v195, v195, v10, v10
  v_fma_f32 v196, v196, v10, v10
  v_mfma_f32_16x16x32_bf16 v[72:75], v[40:43], a[88:91], v[72:75]
  buffer_load_dwordx4 a[84:87], v5, s[12:15], s58 offen offset:2048
  v_fma_f32 v197, v197, v10, v10
  v_mfma_f32_16x16x32_bf16 v[96:99], v[40:43], a[92:95], v[96:99]
  v_fma_f32 v198, v198, v10, v10
  s_waitcnt lgkmcnt(0)
  v_mfma_f32_16x16x32_bf16 v[76:79], v[48:51], a[88:91], v[76:79]
  ds_read_b128 v[32:35], v7 offset:28672
  v_fma_f32 v199, v199, v10, v10
  v_rcp_f32 v192, v192
  v_mfma_f32_16x16x32_bf16 v[100:103], v[48:51], a[92:95], v[100:103]
  ds_read_b128 v[36:39], v7 offset:29696
  v_mul_f32 v120, v120, v136
  v_rcp_f32 v193, v193
  v_mfma_f32_16x16x32_bf16 v[80:83], v[52:55], a[88:91], v[80:83]
  ds_read_b128 v[40:43], v7 offset:30720
  v_mul_f32 v121, v121, v137
  v_mfma_f32_16x16x32_bf16 v[104:107], v[52:55], a[92:95], v[104:107]
  v_rcp_f32 v194, v194
  v_mfma_f32_16x16x32_bf16 v[84:87], v[56:59], a[88:91], v[84:87]
  v_mul_f32 v122, v122, v138
  v_mfma_f32_16x16x32_bf16 v[108:111], v[56:59], a[92:95], v[108:111]
  s_waitcnt lgkmcnt(0)
  v_mfma_f32_16x16x32_bf16 v[64:67], v[32:35], a[96:99], v[64:67]
  ds_read_b128 v[48:51], v7 offset:31744
  v_rcp_f32 v195, v195
  v_mfma_f32_16x16x32_bf16 v[88:91], v[32:35], a[100:103], v[88:91]
  ds_read_b128 v[52:55], v7 offset:32768
  v_mul_f32 v123, v123, v139
  v_rcp_f32 v196, v196
  v_mfma_f32_16x16x32_bf16 v[68:71], v[36:39], a[96:99], v[68:71]
  ds_read_b128 v[56:59], v7 offset:33792
  v_mul_f32 v124, v124, v140
  v_rcp_f32 v197, v197
  v_mfma_f32_16x16x32_bf16 v[92:95], v[36:39], a[100:103], v[92:95]
  buffer_load_dwordx4 a[88:91], v5, s[12:15], s58 offen offset:3072
  v_mul_f32 v125, v125, v141
  v_mfma_f32_16x16x32_bf16 v[72:75], v[40:43], a[96:99], v[72:75]
  buffer_load_dwordx4 a[92:95], v9, s[12:15], s58 offen
  v_rcp_f32 v198, v198
  v_mfma_f32_16x16x32_bf16 v[96:99], v[40:43], a[100:103], v[96:99]
  s_waitcnt lgkmcnt(0)
  v_mfma_f32_16x16x32_bf16 v[76:79], v[48:51], a[96:99], v[76:79]
  ds_read_b128 v[32:35], v7 offset:34816
  v_mul_f32 v126, v126, v142
  v_rcp_f32 v199, v199
  v_mfma_f32_16x16x32_bf16 v[100:103], v[48:51], a[100:103], v[100:103]
  ds_read_b128 v[36:39], v7 offset:35840
  v_mul_f32 v127, v127, v143
  v_mul_f32 v120, v120, v192
  v_mfma_f32_16x16x32_bf16 v[80:83], v[52:55], a[96:99], v[80:83]
  ds_read_b128 v[40:43], v7 offset:36864
  v_mul_f32 v121, v121, v193
  v_mul_f32 v122, v122, v194
  v_mfma_f32_16x16x32_bf16 v[104:107], v[52:55], a[100:103], v[104:107]
  v_mul_f32 v123, v123, v195
  v_mul_f32 v124, v124, v196
  v_mfma_f32_16x16x32_bf16 v[84:87], v[56:59], a[96:99], v[84:87]
  v_mul_f32 v125, v125, v197
  v_mfma_f32_16x16x32_bf16 v[108:111], v[56:59], a[100:103], v[108:111]
  s_waitcnt lgkmcnt(0)
  v_mfma_f32_16x16x32_bf16 v[64:67], v[32:35], a[104:107], v[64:67]
  ds_read_b128 v[48:51], v7 offset:37888
  v_mul_f32 v126, v126, v198
  v_mul_f32 v127, v127, v199
  v_mfma_f32_16x16x32_bf16 v[88:91], v[32:35], a[108:111], v[88:91]
  ds_read_b128 v[52:55], v7 offset:38912
  v_cvt_pk_bf16_f32 v136, v120, v121
  v_cvt_pk_bf16_f32 v137, v122, v123
  v_mfma_f32_16x16x32_bf16 v[68:71], v[36:39], a[104:107], v[68:71]
  ds_read_b128 v[56:59], v7 offset:39936
  v_cvt_pk_bf16_f32 v138, v124, v125
  v_cvt_pk_bf16_f32 v139, v126, v127
  v_mfma_f32_16x16x32_bf16 v[92:95], v[36:39], a[108:111], v[92:95]
  s_add_u32 s58, s48, 30720
  buffer_load_dwordx4 a[96:99], v5, s[12:15], s58 offen offset:0
  buffer_store_dwordx4 v[136:139], v5, s[12:15], s30 offen offset:1024 sc1
  v_fma_f32 v152, v176, v13, v152
  v_mfma_f32_16x16x32_bf16 v[72:75], v[40:43], a[104:107], v[72:75]
  buffer_load_dwordx4 a[100:103], v5, s[12:15], s58 offen offset:1024
  v_fma_f32 v153, v177, v13, v153
  v_mfma_f32_16x16x32_bf16 v[96:99], v[40:43], a[108:111], v[96:99]
  v_fma_f32 v154, v178, v13, v154
  s_waitcnt lgkmcnt(0)
  v_mfma_f32_16x16x32_bf16 v[76:79], v[48:51], a[104:107], v[76:79]
  ds_read_b128 v[32:35], v7 offset:40960
  v_fma_f32 v155, v179, v13, v155
  v_fma_f32 v156, v180, v13, v156
  v_mfma_f32_16x16x32_bf16 v[100:103], v[48:51], a[108:111], v[100:103]
  ds_read_b128 v[36:39], v7 offset:41984
  v_fma_f32 v157, v181, v13, v157
  v_fma_f32 v158, v182, v13, v158
  v_mfma_f32_16x16x32_bf16 v[80:83], v[52:55], a[104:107], v[80:83]
  ds_read_b128 v[40:43], v7 offset:43008
  v_fma_f32 v159, v183, v13, v159
  v_mul_f32 v192, v152, v15
  v_mfma_f32_16x16x32_bf16 v[104:107], v[52:55], a[108:111], v[104:107]
  v_mul_f32 v193, v153, v15
  v_mul_f32 v194, v154, v15
  v_mfma_f32_16x16x32_bf16 v[84:87], v[56:59], a[104:107], v[84:87]
  v_mul_f32 v195, v155, v15
  v_mul_f32 v196, v156, v15
  v_mfma_f32_16x16x32_bf16 v[108:111], v[56:59], a[108:111], v[108:111]
  s_waitcnt lgkmcnt(0)
  v_mfma_f32_16x16x32_bf16 v[64:67], v[32:35], a[112:115], v[64:67]
  ds_read_b128 v[48:51], v7 offset:44032
  v_mul_f32 v197, v157, v15
  v_mul_f32 v198, v158, v15
  v_mfma_f32_16x16x32_bf16 v[88:91], v[32:35], a[116:119], v[88:91]
  ds_read_b128 v[52:55], v7 offset:45056
  v_mul_f32 v199, v159, v15
  v_exp_f32 v192, v192
  v_mfma_f32_16x16x32_bf16 v[68:71], v[36:39], a[112:115], v[68:71]
  ds_read_b128 v[56:59], v7 offset:46080
  v_fma_f32 v168, v184, v13, v168
  v_exp_f32 v193, v193
  v_mfma_f32_16x16x32_bf16 v[92:95], v[36:39], a[116:119], v[92:95]
  buffer_load_dwordx4 a[104:107], v5, s[12:15], s58 offen offset:2048
  v_fma_f32 v169, v185, v13, v169
  v_mfma_f32_16x16x32_bf16 v[72:75], v[40:43], a[112:115], v[72:75]
  buffer_load_dwordx4 a[108:111], v5, s[12:15], s58 offen offset:3072
  v_exp_f32 v194, v194
  v_mfma_f32_16x16x32_bf16 v[96:99], v[40:43], a[116:119], v[96:99]
  s_waitcnt lgkmcnt(0)
  v_mfma_f32_16x16x32_bf16 v[76:79], v[48:51], a[112:115], v[76:79]
  ds_read_b128 v[32:35], v7 offset:47104
  v_fma_f32 v170, v186, v13, v170
  v_exp_f32 v195, v195
  v_mfma_f32_16x16x32_bf16 v[100:103], v[48:51], a[116:119], v[100:103]
  ds_read_b128 v[36:39], v7 offset:48128
  v_fma_f32 v171, v187, v13, v171
  v_exp_f32 v196, v196
  v_mfma_f32_16x16x32_bf16 v[80:83], v[52:55], a[112:115], v[80:83]
  ds_read_b128 v[40:43], v7 offset:49152
  v_fma_f32 v172, v188, v13, v172
  v_mfma_f32_16x16x32_bf16 v[104:107], v[52:55], a[116:119], v[104:107]
  v_exp_f32 v197, v197
  v_mfma_f32_16x16x32_bf16 v[84:87], v[56:59], a[112:115], v[84:87]
  v_fma_f32 v173, v189, v13, v173
  v_mfma_f32_16x16x32_bf16 v[108:111], v[56:59], a[116:119], v[108:111]
  s_waitcnt lgkmcnt(0)
  v_mfma_f32_16x16x32_bf16 v[64:67], v[32:35], a[120:123], v[64:67]
  ds_read_b128 v[48:51], v7 offset:50176
  v_exp_f32 v198, v198
  v_mfma_f32_16x16x32_bf16 v[88:91], v[32:35], a[124:127], v[88:91]
  ds_read_b128 v[52:55], v7 offset:51200
  v_fma_f32 v174, v190, v13, v174
  v_exp_f32 v199, v199
  v_mfma_f32_16x16x32_bf16 v[68:71], v[36:39], a[120:123], v[68:71]
  ds_read_b128 v[56:59], v7 offset:52224
  v_fma_f32 v175, v191, v13, v175
  v_fma_f32 v192, v192, v11, v11
  v_mfma_f32_16x16x32_bf16 v[92:95], v[36:39], a[124:127], v[92:95]
  buffer_load_dwordx4 a[112:115], v9, s[12:15], s58 offen
  v_fma_f32 v193, v193, v11, v11
  v_mfma_f32_16x16x32_bf16 v[72:75], v[40:43], a[120:123], v[72:75]
  s_add_u32 s58, s48, 66560
  buffer_load_dwordx4 a[116:119], v5, s[12:15], s58 offen offset:0
  v_fma_f32 v194, v194, v11, v11
  v_mfma_f32_16x16x32_bf16 v[96:99], v[40:43], a[124:127], v[96:99]
  v_fma_f32 v195, v195, v11, v11
  s_waitcnt lgkmcnt(0)
  v_mfma_f32_16x16x32_bf16 v[76:79], v[48:51], a[120:123], v[76:79]
  ds_read_b128 v[32:35], v7 offset:53248
  v_fma_f32 v196, v196, v11, v11
  v_fma_f32 v197, v197, v11, v11
  v_mfma_f32_16x16x32_bf16 v[100:103], v[48:51], a[124:127], v[100:103]
  ds_read_b128 v[36:39], v7 offset:54272
  v_fma_f32 v198, v198, v11, v11
  v_fma_f32 v199, v199, v11, v11
  v_mfma_f32_16x16x32_bf16 v[80:83], v[52:55], a[120:123], v[80:83]
  ds_read_b128 v[40:43], v7 offset:55296
  v_rcp_f32 v192, v192
  v_mfma_f32_16x16x32_bf16 v[104:107], v[52:55], a[124:127], v[104:107]
  v_mul_f32 v152, v152, v168
  v_rcp_f32 v193, v193
  v_mfma_f32_16x16x32_bf16 v[84:87], v[56:59], a[120:123], v[84:87]
  v_mul_f32 v153, v153, v169
  v_rcp_f32 v194, v194
  v_mfma_f32_16x16x32_bf16 v[108:111], v[56:59], a[124:127], v[108:111]
  s_waitcnt lgkmcnt(0)
  v_mfma_f32_16x16x32_bf16 v[64:67], v[32:35], a[128:131], v[64:67]
  ds_read_b128 v[48:51], v7 offset:56320
  v_mul_f32 v154, v154, v170
  v_rcp_f32 v195, v195
  v_mfma_f32_16x16x32_bf16 v[88:91], v[32:35], a[132:135], v[88:91]
  ds_read_b128 v[52:55], v7 offset:57344
  v_mul_f32 v155, v155, v171
  v_rcp_f32 v196, v196
  v_mfma_f32_16x16x32_bf16 v[68:71], v[36:39], a[128:131], v[68:71]
  ds_read_b128 v[56:59], v7 offset:58368
  v_mul_f32 v156, v156, v172
  v_mfma_f32_16x16x32_bf16 v[92:95], v[36:39], a[132:135], v[92:95]
  buffer_load_dwordx4 a[120:123], v5, s[12:15], s58 offen offset:1024
  v_rcp_f32 v197, v197
  v_mfma_f32_16x16x32_bf16 v[72:75], v[40:43], a[128:131], v[72:75]
  buffer_load_dwordx4 a[124:127], v5, s[12:15], s58 offen offset:2048
  v_mfma_f32_16x16x32_bf16 v[96:99], v[40:43], a[132:135], v[96:99]
  s_waitcnt lgkmcnt(0)
  v_mfma_f32_16x16x32_bf16 v[76:79], v[48:51], a[128:131], v[76:79]
  ds_read_b128 v[32:35], v7 offset:59392
  v_mul_f32 v157, v157, v173
  v_rcp_f32 v198, v198
  v_mfma_f32_16x16x32_bf16 v[100:103], v[48:51], a[132:135], v[100:103]
  ds_read_b128 v[36:39], v7 offset:60416
  v_mul_f32 v158, v158, v174
  v_rcp_f32 v199, v199
  v_mfma_f32_16x16x32_bf16 v[80:83], v[52:55], a[128:131], v[80:83]
  ds_read_b128 v[40:43], v7 offset:61440
  v_mul_f32 v159, v159, v175
  v_mfma_f32_16x16x32_bf16 v[104:107], v[52:55], a[132:135], v[104:107]
  v_mul_f32 v152, v152, v192
  v_mul_f32 v153, v153, v193
  v_mfma_f32_16x16x32_bf16 v[84:87], v[56:59], a[128:131], v[84:87]
  v_mul_f32 v154, v154, v194
  v_mfma_f32_16x16x32_bf16 v[108:111], v[56:59], a[132:135], v[108:111]
  s_waitcnt lgkmcnt(0)
  v_mfma_f32_16x16x32_bf16 v[64:67], v[32:35], a[136:139], v[64:67]
  ds_read_b128 v[48:51], v7 offset:62464
  v_mul_f32 v155, v155, v195
  v_mul_f32 v156, v156, v196
  v_mfma_f32_16x16x32_bf16 v[88:91], v[32:35], a[140:143], v[88:91]
  ds_read_b128 v[52:55], v7 offset:63488
  v_mul_f32 v157, v157, v197
  v_mul_f32 v158, v158, v198
  v_mfma_f32_16x16x32_bf16 v[68:71], v[36:39], a[136:139], v[68:71]
  ds_read_b128 v[56:59], v7 offset:64512
  v_mul_f32 v159, v159, v199
  v_cvt_pk_bf16_f32 v168, v152, v153
  v_mfma_f32_16x16x32_bf16 v[92:95], v[36:39], a[140:143], v[92:95]
  buffer_load_dwordx4 a[128:131], v5, s[12:15], s58 offen offset:3072
  v_cvt_pk_bf16_f32 v169, v154, v155
  v_cvt_pk_bf16_f32 v170, v156, v157
  v_mfma_f32_16x16x32_bf16 v[72:75], v[40:43], a[136:139], v[72:75]
  buffer_load_dwordx4 a[132:135], v9, s[12:15], s58 offen
  v_cvt_pk_bf16_f32 v171, v158, v159
  v_mfma_f32_16x16x32_bf16 v[96:99], v[40:43], a[140:143], v[96:99]
  buffer_store_dwordx4 v[168:171], v5, s[12:15], s31 offen offset:1024 sc1
  s_waitcnt lgkmcnt(0)
  v_mfma_f32_16x16x32_bf16 v[76:79], v[48:51], a[136:139], v[76:79]
  ds_read_b128 v[32:35], v8 offset:0
  v_mfma_f32_16x16x32_bf16 v[100:103], v[48:51], a[140:143], v[100:103]
  ds_read_b128 v[36:39], v8 offset:1024
  v_mfma_f32_16x16x32_bf16 v[80:83], v[52:55], a[136:139], v[80:83]
  ds_read_b128 v[40:43], v8 offset:2048
  v_mfma_f32_16x16x32_bf16 v[104:107], v[52:55], a[140:143], v[104:107]
  v_mfma_f32_16x16x32_bf16 v[84:87], v[56:59], a[136:139], v[84:87]
  v_mfma_f32_16x16x32_bf16 v[108:111], v[56:59], a[140:143], v[108:111]
  s_waitcnt lgkmcnt(0)
  v_mfma_f32_16x16x32_bf16 v[64:67], v[32:35], a[144:147], v[64:67]
  ds_read_b128 v[48:51], v8 offset:3072
  v_mfma_f32_16x16x32_bf16 v[88:91], v[32:35], a[148:151], v[88:91]
  ds_read_b128 v[52:55], v8 offset:4096
  v_mfma_f32_16x16x32_bf16 v[68:71], v[36:39], a[144:147], v[68:71]
  ds_read_b128 v[56:59], v8 offset:5120
  v_mfma_f32_16x16x32_bf16 v[92:95], v[36:39], a[148:151], v[92:95]
  v_mfma_f32_16x16x32_bf16 v[72:75], v[40:43], a[144:147], v[72:75]
  v_mfma_f32_16x16x32_bf16 v[96:99], v[40:43], a[148:151], v[96:99]
  s_waitcnt lgkmcnt(0)
  v_mfma_f32_16x16x32_bf16 v[76:79], v[48:51], a[144:147], v[76:79]
  ds_read_b128 v[32:35], v8 offset:6144
  v_mfma_f32_16x16x32_bf16 v[100:103], v[48:51], a[148:151], v[100:103]
  ds_read_b128 v[36:39], v8 offset:7168
  v_mfma_f32_16x16x32_bf16 v[80:83], v[52:55], a[144:147], v[80:83]
  ds_read_b128 v[40:43], v8 offset:8192
  v_mfma_f32_16x16x32_bf16 v[104:107], v[52:55], a[148:151], v[104:107]
  v_mfma_f32_16x16x32_bf16 v[84:87], v[56:59], a[144:147], v[84:87]
  v_mfma_f32_16x16x32_bf16 v[108:111], v[56:59], a[148:151], v[108:111]
  s_waitcnt lgkmcnt(0)
  s_waitcnt vmcnt(0)
  s_barrier
  s_cmp_lg_u32 s3, 0
  s_cbranch_scc1 W0_23
  v_mov_b32 v26, 1
  buffer_atomic_add v26, v28, s[12:15], s78 offen sc1
W0_23:
  s_add_u32 s23, s23, 1
  v_mfma_f32_16x16x32_bf16 v[64:67], v[32:35], a[152:155], v[64:67]
  ds_read_b128 v[48:51], v8 offset:9216
  v_mfma_f32_16x16x32_bf16 v[88:91], v[32:35], a[156:159], v[88:91]
  ds_read_b128 v[52:55], v8 offset:10240
  v_mfma_f32_16x16x32_bf16 v[68:71], v[36:39], a[152:155], v[68:71]
  ds_read_b128 v[56:59], v8 offset:11264
  v_mfma_f32_16x16x32_bf16 v[92:95], v[36:39], a[156:159], v[92:95]
  v_mfma_f32_16x16x32_bf16 v[72:75], v[40:43], a[152:155], v[72:75]
  v_mfma_f32_16x16x32_bf16 v[96:99], v[40:43], a[156:159], v[96:99]
  s_waitcnt lgkmcnt(0)
  v_mfma_f32_16x16x32_bf16 v[76:79], v[48:51], a[152:155], v[76:79]
  v_mfma_f32_16x16x32_bf16 v[100:103], v[48:51], a[156:159], v[100:103]
  v_mfma_f32_16x16x32_bf16 v[80:83], v[52:55], a[152:155], v[80:83]
  v_mfma_f32_16x16x32_bf16 v[104:107], v[52:55], a[156:159], v[104:107]
  v_mfma_f32_16x16x32_bf16 v[84:87], v[56:59], a[152:155], v[84:87]
  v_mfma_f32_16x16x32_bf16 v[108:111], v[56:59], a[156:159], v[108:111]
  ds_read_b128 v[32:35], v207 offset:256
  ds_read_b128 v[44:47], v207 offset:1280
  ds_read_b128 v[36:39], v207 offset:320
  ds_read_b128 v[48:51], v207 offset:1344
  ds_read_b128 v[40:43], v207 offset:384
  ds_read_b128 v[52:55], v207 offset:1408
  s_waitcnt lgkmcnt(4)
  s_waitcnt lgkmcnt(2)
  v_pk_fma_f32 v[64:65], v[32:33], v[12:13], v[64:65] op_sel:[0,0,0] op_sel_hi:[1,0,1]
  v_pk_fma_f32 v[66:67], v[34:35], v[12:13], v[66:67] op_sel:[0,0,0] op_sel_hi:[1,0,1]
  v_pk_fma_f32 v[68:69], v[36:37], v[12:13], v[68:69] op_sel:[0,0,0] op_sel_hi:[1,0,1]
  v_pk_fma_f32 v[70:71], v[38:39], v[12:13], v[70:71] op_sel:[0,0,0] op_sel_hi:[1,0,1]
  v_pk_mul_f32 v[192:193], v[64:65], v[14:15] op_sel:[0,0] op_sel_hi:[1,0]
  v_pk_mul_f32 v[194:195], v[66:67], v[14:15] op_sel:[0,0] op_sel_hi:[1,0]
  v_pk_mul_f32 v[196:197], v[68:69], v[14:15] op_sel:[0,0] op_sel_hi:[1,0]
  v_pk_mul_f32 v[198:199], v[70:71], v[14:15] op_sel:[0,0] op_sel_hi:[1,0]
  v_exp_f32 v192, v192
  v_exp_f32 v193, v193
  v_exp_f32 v194, v194
  v_exp_f32 v195, v195
  v_exp_f32 v196, v196
  v_exp_f32 v197, v197
  v_exp_f32 v198, v198
  v_exp_f32 v199, v199
  v_pk_fma_f32 v[76:77], v[44:45], v[12:13], v[76:77] op_sel:[0,0,0] op_sel_hi:[1,0,1]
  v_pk_fma_f32 v[78:79], v[46:47], v[12:13], v[78:79] op_sel:[0,0,0] op_sel_hi:[1,0,1]
  v_pk_fma_f32 v[80:81], v[48:49], v[12:13], v[80:81] op_sel:[0,0,0] op_sel_hi:[1,0,1]
  v_pk_fma_f32 v[82:83], v[50:51], v[12:13], v[82:83] op_sel:[0,0,0] op_sel_hi:[1,0,1]
  v_pk_fma_f32 v[192:193], v[192:193], v[10:11], v[10:11] op_sel:[0,0,0] op_sel_hi:[1,0,0]
  v_pk_fma_f32 v[194:195], v[194:195], v[10:11], v[10:11] op_sel:[0,0,0] op_sel_hi:[1,0,0]
  v_pk_fma_f32 v[196:197], v[196:197], v[10:11], v[10:11] op_sel:[0,0,0] op_sel_hi:[1,0,0]
  v_pk_fma_f32 v[198:199], v[198:199], v[10:11], v[10:11] op_sel:[0,0,0] op_sel_hi:[1,0,0]
  v_rcp_f32 v192, v192
  v_rcp_f32 v193, v193
  v_rcp_f32 v194, v194
  v_rcp_f32 v195, v195
  v_rcp_f32 v196, v196
  v_rcp_f32 v197, v197
  v_rcp_f32 v198, v198
  v_rcp_f32 v199, v199
  v_pk_mul_f32 v[64:65], v[64:65], v[76:77]
  v_pk_mul_f32 v[66:67], v[66:67], v[78:79]
  v_pk_mul_f32 v[68:69], v[68:69], v[80:81]
  v_pk_mul_f32 v[70:71], v[70:71], v[82:83]
  v_pk_mul_f32 v[64:65], v[64:65], v[192:193]
  v_pk_mul_f32 v[66:67], v[66:67], v[194:195]
  v_pk_mul_f32 v[68:69], v[68:69], v[196:197]
  v_pk_mul_f32 v[70:71], v[70:71], v[198:199]
  v_cvt_pk_bf16_f32 v76, v64, v65
  v_cvt_pk_bf16_f32 v77, v66, v67
  v_cvt_pk_bf16_f32 v78, v68, v69
  v_cvt_pk_bf16_f32 v79, v70, v71
  buffer_store_dwordx4 v[76:79], v5, s[12:15], s30 offen offset:2048 sc1
  s_cmp_lg_u32 s3, 0
  s_cbranch_scc1 W0_24
  buffer_load_dword v27, v29, s[12:15], s79 offen sc1
W0_24:
  s_waitcnt lgkmcnt(0)
  v_cndmask_b32 v40, 0, v40, s[64:65]
  v_cndmask_b32 v52, 0, v52, s[64:65]
  v_cndmask_b32 v41, 0, v41, s[64:65]
  v_cndmask_b32 v53, 0, v53, s[64:65]
  v_cndmask_b32 v42, 0, v42, s[64:65]
  v_cndmask_b32 v54, 0, v54, s[64:65]
  v_cndmask_b32 v43, 0, v43, s[64:65]
  v_cndmask_b32 v55, 0, v55, s[64:65]
  v_pk_fma_f32 v[72:73], v[40:41], v[12:13], v[72:73] op_sel:[0,0,0] op_sel_hi:[1,0,1]
  v_pk_fma_f32 v[74:75], v[42:43], v[12:13], v[74:75] op_sel:[0,0,0] op_sel_hi:[1,0,1]
  v_pk_mul_f32 v[192:193], v[72:73], v[14:15] op_sel:[0,0] op_sel_hi:[1,0]
  v_pk_mul_f32 v[194:195], v[74:75], v[14:15] op_sel:[0,0] op_sel_hi:[1,0]
  v_exp_f32 v192, v192
  v_exp_f32 v193, v193
  v_exp_f32 v194, v194
  v_exp_f32 v195, v195
  v_pk_fma_f32 v[84:85], v[52:53], v[12:13], v[84:85] op_sel:[0,0,0] op_sel_hi:[1,0,1]
  v_pk_fma_f32 v[86:87], v[54:55], v[12:13], v[86:87] op_sel:[0,0,0] op_sel_hi:[1,0,1]
  v_pk_fma_f32 v[192:193], v[192:193], v[10:11], v[10:11] op_sel:[0,0,0] op_sel_hi:[1,0,0]
  v_pk_fma_f32 v[194:195], v[194:195], v[10:11], v[10:11] op_sel:[0,0,0] op_sel_hi:[1,0,0]
  v_rcp_f32 v192, v192
  v_rcp_f32 v193, v193
  v_rcp_f32 v194, v194
  v_rcp_f32 v195, v195
  v_pk_mul_f32 v[72:73], v[72:73], v[84:85]
  v_pk_mul_f32 v[74:75], v[74:75], v[86:87]
  v_pk_mul_f32 v[72:73], v[72:73], v[192:193]
  v_pk_mul_f32 v[74:75], v[74:75], v[194:195]
  v_cvt_pk_bf16_f32 v84, v72, v73
  v_cvt_pk_bf16_f32 v85, v74, v75
  buffer_store_dwordx2 v[84:85], v6, s[12:15], s32 offen sc1
  s_cmp_lg_u32 s3, 0
  s_cbranch_scc1 W0_25
  s_waitcnt vmcnt(1)
  v_cmp_gt_u32 vcc, s23, v27
  s_cmp_eq_u64 vcc, 0
  s_cbranch_scc1 W0_25
  s_mov_b32 s74, 0
PL_26:
  buffer_load_dword v26, v29, s[12:15], s79 offen sc1
  s_waitcnt vmcnt(0)
  v_cmp_gt_u32 vcc, s23, v26
  s_cmp_eq_u64 vcc, 0
  s_cbranch_scc1 PD_27
  s_add_u32 s74, s74, 1
  s_cmp_lt_u32 s74, 0x40000
  s_cbranch_scc1 PL_26
PD_27:
W0_25:
  s_barrier
  v_pk_fma_f32 v[88:89], v[32:33], v[12:13], v[88:89] op_sel:[0,1,0] op_sel_hi:[1,1,1]
  v_pk_fma_f32 v[90:91], v[34:35], v[12:13], v[90:91] op_sel:[0,1,0] op_sel_hi:[1,1,1]
  v_pk_fma_f32 v[92:93], v[36:37], v[12:13], v[92:93] op_sel:[0,1,0] op_sel_hi:[1,1,1]
  v_pk_fma_f32 v[94:95], v[38:39], v[12:13], v[94:95] op_sel:[0,1,0] op_sel_hi:[1,1,1]
  v_pk_mul_f32 v[192:193], v[88:89], v[14:15] op_sel:[0,1] op_sel_hi:[1,1]
  v_pk_mul_f32 v[194:195], v[90:91], v[14:15] op_sel:[0,1] op_sel_hi:[1,1]
  v_pk_mul_f32 v[196:197], v[92:93], v[14:15] op_sel:[0,1] op_sel_hi:[1,1]
  v_pk_mul_f32 v[198:199], v[94:95], v[14:15] op_sel:[0,1] op_sel_hi:[1,1]
  v_exp_f32 v192, v192
  v_exp_f32 v193, v193
  v_exp_f32 v194, v194
  v_exp_f32 v195, v195
  v_exp_f32 v196, v196
  v_exp_f32 v197, v197
  v_exp_f32 v198, v198
  v_exp_f32 v199, v199
  buffer_load_dwordx4 v[112:115], v5, s[12:15], s82 offen offset:0 sc1
  buffer_load_dwordx4 v[116:119], v5, s[12:15], s86 offen offset:0 sc1
  v_pk_fma_f32 v[100:101], v[44:45], v[12:13], v[100:101] op_sel:[0,1,0] op_sel_hi:[1,1,1]
  v_pk_fma_f32 v[102:103], v[46:47], v[12:13], v[102:103] op_sel:[0,1,0] op_sel_hi:[1,1,1]
  v_pk_fma_f32 v[104:105], v[48:49], v[12:13], v[104:105] op_sel:[0,1,0] op_sel_hi:[1,1,1]
  v_pk_fma_f32 v[106:107], v[50:51], v[12:13], v[106:107] op_sel:[0,1,0] op_sel_hi:[1,1,1]
  v_pk_fma_f32 v[192:193], v[192:193], v[10:11], v[10:11] op_sel:[0,1,1] op_sel_hi:[1,1,1]
  v_pk_fma_f32 v[194:195], v[194:195], v[10:11], v[10:11] op_sel:[0,1,1] op_sel_hi:[1,1,1]
  v_pk_fma_f32 v[196:197], v[196:197], v[10:11], v[10:11] op_sel:[0,1,1] op_sel_hi:[1,1,1]
  v_pk_fma_f32 v[198:199], v[198:199], v[10:11], v[10:11] op_sel:[0,1,1] op_sel_hi:[1,1,1]
  v_rcp_f32 v192, v192
  v_rcp_f32 v193, v193
  v_rcp_f32 v194, v194
  v_rcp_f32 v195, v195
  v_rcp_f32 v196, v196
  v_rcp_f32 v197, v197
  v_rcp_f32 v198, v198
  v_rcp_f32 v199, v199
  buffer_load_dwordx4 v[120:123], v5, s[12:15], s90 offen offset:0 sc1
  buffer_load_dwordx4 v[124:127], v5, s[12:15], s94 offen offset:0 sc1
  v_pk_mul_f32 v[88:89], v[88:89], v[100:101]
  v_pk_mul_f32 v[90:91], v[90:91], v[102:103]
  v_pk_mul_f32 v[92:93], v[92:93], v[104:105]
  v_pk_mul_f32 v[94:95], v[94:95], v[106:107]
  buffer_load_dwordx4 v[128:131], v5, s[12:15], s82 offen offset:3072 sc1
  buffer_load_dwordx4 v[132:135], v5, s[12:15], s86 offen offset:3072 sc1
  v_pk_mul_f32 v[88:89], v[88:89], v[192:193]
  v_pk_mul_f32 v[90:91], v[90:91], v[194:195]
  v_pk_mul_f32 v[92:93], v[92:93], v[196:197]
  v_pk_mul_f32 v[94:95], v[94:95], v[198:199]
  v_cvt_pk_bf16_f32 v100, v88, v89
  v_cvt_pk_bf16_f32 v101, v90, v91
  v_cvt_pk_bf16_f32 v102, v92, v93
  v_cvt_pk_bf16_f32 v103, v94, v95
  buffer_store_dwordx4 v[100:103], v5, s[12:15], s31 offen offset:2048 sc1
  buffer_load_dwordx4 v[136:139], v5, s[12:15], s90 offen offset:3072 sc1
  buffer_load_dwordx4 v[140:143], v5, s[12:15], s94 offen offset:3072 sc1
  v_pk_fma_f32 v[96:97], v[40:41], v[12:13], v[96:97] op_sel:[0,1,0] op_sel_hi:[1,1,1]
  v_pk_fma_f32 v[98:99], v[42:43], v[12:13], v[98:99] op_sel:[0,1,0] op_sel_hi:[1,1,1]
  v_pk_mul_f32 v[192:193], v[96:97], v[14:15] op_sel:[0,1] op_sel_hi:[1,1]
  v_pk_mul_f32 v[194:195], v[98:99], v[14:15] op_sel:[0,1] op_sel_hi:[1,1]
  v_exp_f32 v192, v192
  v_exp_f32 v193, v193
  v_exp_f32 v194, v194
  v_exp_f32 v195, v195
  buffer_load_dwordx4 v[144:147], v5, s[12:15], s83 offen offset:3072 sc1
  buffer_load_dwordx4 v[148:151], v5, s[12:15], s87 offen offset:3072 sc1
  v_pk_fma_f32 v[108:109], v[52:53], v[12:13], v[108:109] op_sel:[0,1,0] op_sel_hi:[1,1,1]
  v_pk_fma_f32 v[110:111], v[54:55], v[12:13], v[110:111] op_sel:[0,1,0] op_sel_hi:[1,1,1]
  v_pk_fma_f32 v[192:193], v[192:193], v[10:11], v[10:11] op_sel:[0,1,1] op_sel_hi:[1,1,1]
  v_pk_fma_f32 v[194:195], v[194:195], v[10:11], v[10:11] op_sel:[0,1,1] op_sel_hi:[1,1,1]
  v_rcp_f32 v192, v192
  v_rcp_f32 v193, v193
  v_rcp_f32 v194, v194
  v_rcp_f32 v195, v195
  buffer_load_dwordx4 v[152:155], v5, s[12:15], s91 offen offset:3072 sc1
  buffer_load_dwordx4 v[156:159], v5, s[12:15], s95 offen offset:3072 sc1
  v_pk_mul_f32 v[96:97], v[96:97], v[108:109]
  v_pk_mul_f32 v[98:99], v[98:99], v[110:111]
  buffer_load_dwordx4 v[160:163], v5, s[12:15], s84 offen offset:2048 sc1
  buffer_load_dwordx4 v[164:167], v5, s[12:15], s88 offen offset:2048 sc1
  v_pk_mul_f32 v[96:97], v[96:97], v[192:193]
  v_pk_mul_f32 v[98:99], v[98:99], v[194:195]
  v_cvt_pk_bf16_f32 v108, v96, v97
  v_cvt_pk_bf16_f32 v109, v98, v99
  buffer_store_dwordx2 v[108:109], v6, s[12:15], s33 offen sc1
  buffer_load_dwordx4 v[168:171], v5, s[12:15], s92 offen offset:2048 sc1
  buffer_load_dwordx4 v[172:175], v5, s[12:15], s96 offen offset:2048 sc1
  s_cmp_eq_u32 s9, 1
  s_cselect_b32 s62, 0, s14
  buffer_load_dwordx4 v[176:179], v5, s[12:15], s82 offen offset:1024 sc1
  buffer_load_dwordx4 v[180:183], v5, s[12:15], s86 offen offset:1024 sc1
  buffer_load_dwordx4 v[184:187], v5, s[12:15], s90 offen offset:1024 sc1
  buffer_load_dwordx4 v[188:191], v5, s[12:15], s94 offen offset:1024 sc1
  buffer_load_dwordx4 v[192:195], v5, s[12:15], s83 offen offset:0 sc1
  buffer_load_dwordx4 v[196:199], v5, s[12:15], s87 offen offset:0 sc1
  buffer_load_dwordx4 v[200:203], v5, s[12:15], s91 offen offset:0 sc1
  buffer_load_dwordx4 v[204:207], v5, s[12:15], s95 offen offset:0 sc1
  s_waitcnt vmcnt(22)
  v_mfma_f32_16x16x32_bf16 v[32:35], a[160:163], v[112:115], 0
  v_mfma_f32_16x16x32_bf16 v[36:39], a[164:167], v[112:115], 0
  v_mfma_f32_16x16x32_bf16 v[40:43], a[168:171], v[112:115], 0
  v_mfma_f32_16x16x32_bf16 v[44:47], a[172:175], v[112:115], 0
  v_mfma_f32_16x16x32_bf16 v[48:51], a[176:179], v[112:115], 0
  v_mfma_f32_16x16x32_bf16 v[52:55], a[160:163], v[116:119], 0
  v_mfma_f32_16x16x32_bf16 v[56:59], a[164:167], v[116:119], 0
  v_mfma_f32_16x16x32_bf16 v[60:63], a[168:171], v[116:119], 0
  v_mfma_f32_16x16x32_bf16 v[64:67], a[172:175], v[116:119], 0
  v_mfma_f32_16x16x32_bf16 v[68:71], a[176:179], v[116:119], 0
  v_mfma_f32_16x16x32_bf16 v[72:75], a[160:163], v[120:123], 0
  v_mfma_f32_16x16x32_bf16 v[76:79], a[164:167], v[120:123], 0
  v_mfma_f32_16x16x32_bf16 v[80:83], a[168:171], v[120:123], 0
  v_mfma_f32_16x16x32_bf16 v[84:87], a[172:175], v[120:123], 0
  v_mfma_f32_16x16x32_bf16 v[88:91], a[176:179], v[120:123], 0
  v_mfma_f32_16x16x32_bf16 v[92:95], a[160:163], v[124:127], 0
  v_mfma_f32_16x16x32_bf16 v[96:99], a[164:167], v[124:127], 0
  v_mfma_f32_16x16x32_bf16 v[100:103], a[168:171], v[124:127], 0
  v_mfma_f32_16x16x32_bf16 v[104:107], a[172:175], v[124:127], 0
  v_mfma_f32_16x16x32_bf16 v[108:111], a[176:179], v[124:127], 0
  s_waitcnt vmcnt(17)
  v_mfma_f32_16x16x32_bf16 v[32:35], a[180:183], v[128:131], v[32:35]
  v_mfma_f32_16x16x32_bf16 v[36:39], a[184:187], v[128:131], v[36:39]
  buffer_load_dwordx4 v[112:115], v5, s[12:15], s84 offen offset:0 sc1
  v_mfma_f32_16x16x32_bf16 v[40:43], a[188:191], v[128:131], v[40:43]
  v_mfma_f32_16x16x32_bf16 v[44:47], a[192:195], v[128:131], v[44:47]
  buffer_load_dwordx4 v[116:119], v5, s[12:15], s88 offen offset:0 sc1
  v_mfma_f32_16x16x32_bf16 v[48:51], a[196:199], v[128:131], v[48:51]
  v_mfma_f32_16x16x32_bf16 v[52:55], a[180:183], v[132:135], v[52:55]
  buffer_load_dwordx4 v[120:123], v5, s[12:15], s92 offen offset:0 sc1
  v_mfma_f32_16x16x32_bf16 v[56:59], a[184:187], v[132:135], v[56:59]
  v_mfma_f32_16x16x32_bf16 v[60:63], a[188:191], v[132:135], v[60:63]
  buffer_load_dwordx4 v[124:127], v5, s[12:15], s96 offen offset:0 sc1
  v_mfma_f32_16x16x32_bf16 v[64:67], a[192:195], v[132:135], v[64:67]
  v_mfma_f32_16x16x32_bf16 v[68:71], a[196:199], v[132:135], v[68:71]
  v_mfma_f32_16x16x32_bf16 v[72:75], a[180:183], v[136:139], v[72:75]
  v_mfma_f32_16x16x32_bf16 v[76:79], a[184:187], v[136:139], v[76:79]
  v_mfma_f32_16x16x32_bf16 v[80:83], a[188:191], v[136:139], v[80:83]
  v_mfma_f32_16x16x32_bf16 v[84:87], a[192:195], v[136:139], v[84:87]
  v_mfma_f32_16x16x32_bf16 v[88:91], a[196:199], v[136:139], v[88:91]
  v_mfma_f32_16x16x32_bf16 v[92:95], a[180:183], v[140:143], v[92:95]
  v_mfma_f32_16x16x32_bf16 v[96:99], a[184:187], v[140:143], v[96:99]
  v_mfma_f32_16x16x32_bf16 v[100:103], a[188:191], v[140:143], v[100:103]
  v_mfma_f32_16x16x32_bf16 v[104:107], a[192:195], v[140:143], v[104:107]
  v_mfma_f32_16x16x32_bf16 v[108:111], a[196:199], v[140:143], v[108:111]
  s_waitcnt vmcnt(14)
  s_barrier
  s_cmp_lg_u32 s3, 0
  s_cbranch_scc1 W0_28
  v_mov_b32 v26, 1
  buffer_atomic_add v26, v28, s[12:15], s78 offen sc1
W0_28:
  s_add_u32 s23, s23, 1
  s_waitcnt vmcnt(17)
  v_mfma_f32_16x16x32_bf16 v[32:35], a[200:203], v[144:147], v[32:35]
  v_mfma_f32_16x16x32_bf16 v[36:39], a[204:207], v[144:147], v[36:39]
  buffer_load_dwordx4 v[128:131], v5, s[12:15], s84 offen offset:3072 sc1
  v_mfma_f32_16x16x32_bf16 v[40:43], a[208:211], v[144:147], v[40:43]
  v_mfma_f32_16x16x32_bf16 v[44:47], a[212:215], v[144:147], v[44:47]
  buffer_load_dwordx4 v[132:135], v5, s[12:15], s88 offen offset:3072 sc1
  v_mfma_f32_16x16x32_bf16 v[48:51], a[216:219], v[144:147], v[48:51]
  v_mfma_f32_16x16x32_bf16 v[52:55], a[200:203], v[148:151], v[52:55]
  buffer_load_dwordx4 v[136:139], v5, s[12:15], s92 offen offset:3072 sc1
  v_mfma_f32_16x16x32_bf16 v[56:59], a[204:207], v[148:151], v[56:59]
  v_mfma_f32_16x16x32_bf16 v[60:63], a[208:211], v[148:151], v[60:63]
  buffer_load_dwordx4 v[140:143], v5, s[12:15], s96 offen offset:3072 sc1
  v_mfma_f32_16x16x32_bf16 v[64:67], a[212:215], v[148:151], v[64:67]
  v_mfma_f32_16x16x32_bf16 v[68:71], a[216:219], v[148:151], v[68:71]
  v_mfma_f32_16x16x32_bf16 v[72:75], a[200:203], v[152:155], v[72:75]
  v_mfma_f32_16x16x32_bf16 v[76:79], a[204:207], v[152:155], v[76:79]
  v_mfma_f32_16x16x32_bf16 v[80:83], a[208:211], v[152:155], v[80:83]
  v_mfma_f32_16x16x32_bf16 v[84:87], a[212:215], v[152:155], v[84:87]
  v_mfma_f32_16x16x32_bf16 v[88:91], a[216:219], v[152:155], v[88:91]
  v_mfma_f32_16x16x32_bf16 v[92:95], a[200:203], v[156:159], v[92:95]
  v_mfma_f32_16x16x32_bf16 v[96:99], a[204:207], v[156:159], v[96:99]
  v_mfma_f32_16x16x32_bf16 v[100:103], a[208:211], v[156:159], v[100:103]
  v_mfma_f32_16x16x32_bf16 v[104:107], a[212:215], v[156:159], v[104:107]
  v_mfma_f32_16x16x32_bf16 v[108:111], a[216:219], v[156:159], v[108:111]
  s_cmp_lg_u32 s3, 0
  s_cbranch_scc1 W0_29
  buffer_load_dword v27, v29, s[12:15], s79 offen sc1
W0_29:
  s_waitcnt vmcnt(16)
  v_mfma_f32_16x16x32_bf16 v[32:35], a[220:223], v[160:163], v[32:35]
  v_mfma_f32_16x16x32_bf16 v[36:39], a[224:227], v[160:163], v[36:39]
  v_mfma_f32_16x16x32_bf16 v[40:43], a[228:231], v[160:163], v[40:43]
  v_mfma_f32_16x16x32_bf16 v[44:47], a[232:235], v[160:163], v[44:47]
  v_mfma_f32_16x16x32_bf16 v[48:51], a[236:239], v[160:163], v[48:51]
  v_mfma_f32_16x16x32_bf16 v[52:55], a[220:223], v[164:167], v[52:55]
  v_mfma_f32_16x16x32_bf16 v[56:59], a[224:227], v[164:167], v[56:59]
  v_mfma_f32_16x16x32_bf16 v[60:63], a[228:231], v[164:167], v[60:63]
  v_mfma_f32_16x16x32_bf16 v[64:67], a[232:235], v[164:167], v[64:67]
  v_mfma_f32_16x16x32_bf16 v[68:71], a[236:239], v[164:167], v[68:71]
  v_mfma_f32_16x16x32_bf16 v[72:75], a[220:223], v[168:171], v[72:75]
  v_mfma_f32_16x16x32_bf16 v[76:79], a[224:227], v[168:171], v[76:79]
  v_mfma_f32_16x16x32_bf16 v[80:83], a[228:231], v[168:171], v[80:83]
  v_mfma_f32_16x16x32_bf16 v[84:87], a[232:235], v[168:171], v[84:87]
  v_mfma_f32_16x16x32_bf16 v[88:91], a[236:239], v[168:171], v[88:91]
  v_mfma_f32_16x16x32_bf16 v[92:95], a[220:223], v[172:175], v[92:95]
  v_mfma_f32_16x16x32_bf16 v[96:99], a[224:227], v[172:175], v[96:99]
  v_mfma_f32_16x16x32_bf16 v[100:103], a[228:231], v[172:175], v[100:103]
  v_mfma_f32_16x16x32_bf16 v[104:107], a[232:235], v[172:175], v[104:107]
  v_mfma_f32_16x16x32_bf16 v[108:111], a[236:239], v[172:175], v[108:111]
  s_cmp_lg_u32 s3, 0
  s_cbranch_scc1 W0_30
  s_waitcnt vmcnt(0)
  v_cmp_gt_u32 vcc, s23, v27
  s_cmp_eq_u64 vcc, 0
  s_cbranch_scc1 W0_30
  s_mov_b32 s74, 0
PL_31:
  buffer_load_dword v26, v29, s[12:15], s79 offen sc1
  s_waitcnt vmcnt(0)
  v_cmp_gt_u32 vcc, s23, v26
  s_cmp_eq_u64 vcc, 0
  s_cbranch_scc1 PD_32
  s_add_u32 s74, s74, 1
  s_cmp_lt_u32 s74, 0x40000
  s_cbranch_scc1 PL_31
PD_32:
W0_30:
  s_barrier
  s_waitcnt vmcnt(12)
  v_mfma_f32_16x16x32_bf16 v[32:35], a[240:243], v[176:179], v[32:35]
  v_mfma_f32_16x16x32_bf16 v[36:39], a[244:247], v[176:179], v[36:39]
  buffer_load_dwordx4 v[144:147], v5, s[12:15], s82 offen offset:2048 sc1
  v_mfma_f32_16x16x32_bf16 v[40:43], a[248:251], v[176:179], v[40:43]
  v_mfma_f32_16x16x32_bf16 v[44:47], a[252:255], v[176:179], v[44:47]
  buffer_load_dwordx4 v[148:151], v5, s[12:15], s86 offen offset:2048 sc1
  v_mfma_f32_16x16x32_bf16 v[48:51], v[208:211], v[176:179], v[48:51]
  v_mfma_f32_16x16x32_bf16 v[52:55], a[240:243], v[180:183], v[52:55]
  buffer_load_dwordx4 v[152:155], v5, s[12:15], s90 offen offset:2048 sc1
  v_mfma_f32_16x16x32_bf16 v[56:59], a[244:247], v[180:183], v[56:59]
  v_mfma_f32_16x16x32_bf16 v[60:63], a[248:251], v[180:183], v[60:63]
  buffer_load_dwordx4 v[156:159], v5, s[12:15], s94 offen offset:2048 sc1
  v_mfma_f32_16x16x32_bf16 v[64:67], a[252:255], v[180:183], v[64:67]
  v_mfma_f32_16x16x32_bf16 v[68:71], v[208:211], v[180:183], v[68:71]
  buffer_load_dwordx4 v[160:163], v5, s[12:15], s83 offen offset:1024 sc1
  v_mfma_f32_16x16x32_bf16 v[72:75], a[240:243], v[184:187], v[72:75]
  v_mfma_f32_16x16x32_bf16 v[76:79], a[244:247], v[184:187], v[76:79]
  buffer_load_dwordx4 v[164:167], v5, s[12:15], s87 offen offset:1024 sc1
  v_mfma_f32_16x16x32_bf16 v[80:83], a[248:251], v[184:187], v[80:83]
  v_mfma_f32_16x16x32_bf16 v[84:87], a[252:255], v[184:187], v[84:87]
  buffer_load_dwordx4 v[168:171], v5, s[12:15], s91 offen offset:1024 sc1
  v_mfma_f32_16x16x32_bf16 v[88:91], v[208:211], v[184:187], v[88:91]
  v_mfma_f32_16x16x32_bf16 v[92:95], a[240:243], v[188:191], v[92:95]
  buffer_load_dwordx4 v[172:175], v5, s[12:15], s95 offen offset:1024 sc1
  v_mfma_f32_16x16x32_bf16 v[96:99], a[244:247], v[188:191], v[96:99]
  v_mfma_f32_16x16x32_bf16 v[100:103], a[248:251], v[188:191], v[100:103]
  v_mfma_f32_16x16x32_bf16 v[104:107], a[252:255], v[188:191], v[104:107]
  v_mfma_f32_16x16x32_bf16 v[108:111], v[208:211], v[188:191], v[108:111]
  s_waitcnt vmcnt(16)
  v_mfma_f32_16x16x32_bf16 v[32:35], v[212:215], v[192:195], v[32:35]
  v_mfma_f32_16x16x32_bf16 v[36:39], v[216:219], v[192:195], v[36:39]
  buffer_load_dwordx4 v[176:179], v5, s[12:15], s84 offen offset:1024 sc1
  v_mfma_f32_16x16x32_bf16 v[40:43], v[220:223], v[192:195], v[40:43]
  v_mfma_f32_16x16x32_bf16 v[44:47], v[224:227], v[192:195], v[44:47]
  buffer_load_dwordx4 v[180:183], v5, s[12:15], s88 offen offset:1024 sc1
  v_mfma_f32_16x16x32_bf16 v[48:51], v[228:231], v[192:195], v[48:51]
  v_mfma_f32_16x16x32_bf16 v[52:55], v[212:215], v[196:199], v[52:55]
  buffer_load_dwordx4 v[184:187], v5, s[12:15], s92 offen offset:1024 sc1
  v_mfma_f32_16x16x32_bf16 v[56:59], v[216:219], v[196:199], v[56:59]
  v_mfma_f32_16x16x32_bf16 v[60:63], v[220:223], v[196:199], v[60:63]
  buffer_load_dwordx4 v[188:191], v5, s[12:15], s96 offen offset:1024 sc1
  v_mfma_f32_16x16x32_bf16 v[64:67], v[224:227], v[196:199], v[64:67]
  v_mfma_f32_16x16x32_bf16 v[68:71], v[228:231], v[196:199], v[68:71]
  v_mfma_f32_16x16x32_bf16 v[72:75], v[212:215], v[200:203], v[72:75]
  v_mfma_f32_16x16x32_bf16 v[76:79], v[216:219], v[200:203], v[76:79]
  v_mfma_f32_16x16x32_bf16 v[80:83], v[220:223], v[200:203], v[80:83]
  v_mfma_f32_16x16x32_bf16 v[84:87], v[224:227], v[200:203], v[84:87]
  v_mfma_f32_16x16x32_bf16 v[88:91], v[228:231], v[200:203], v[88:91]
  v_mfma_f32_16x16x32_bf16 v[92:95], v[212:215], v[204:207], v[92:95]
  v_mfma_f32_16x16x32_bf16 v[96:99], v[216:219], v[204:207], v[96:99]
  v_mfma_f32_16x16x32_bf16 v[100:103], v[220:223], v[204:207], v[100:103]
  v_mfma_f32_16x16x32_bf16 v[104:107], v[224:227], v[204:207], v[104:107]
  v_mfma_f32_16x16x32_bf16 v[108:111], v[228:231], v[204:207], v[108:111]
  s_waitcnt vmcnt(16)
  v_mfma_f32_16x16x32_bf16 v[32:35], v[232:235], v[112:115], v[32:35]
  v_mfma_f32_16x16x32_bf16 v[36:39], v[236:239], v[112:115], v[36:39]
  buffer_load_dwordx4 v[192:195], v5, s[12:15], s85 offen offset:0 sc1
  v_mfma_f32_16x16x32_bf16 v[40:43], v[240:243], v[112:115], v[40:43]
  v_mfma_f32_16x16x32_bf16 v[44:47], v[244:247], v[112:115], v[44:47]
  buffer_load_dwordx4 v[196:199], v5, s[12:15], s89 offen offset:0 sc1
  v_mfma_f32_16x16x32_bf16 v[48:51], v[248:251], v[112:115], v[48:51]
  v_mfma_f32_16x16x32_bf16 v[52:55], v[232:235], v[116:119], v[52:55]
  buffer_load_dwordx4 v[200:203], v5, s[12:15], s93 offen offset:0 sc1
  v_mfma_f32_16x16x32_bf16 v[56:59], v[236:239], v[116:119], v[56:59]
  v_mfma_f32_16x16x32_bf16 v[60:63], v[240:243], v[116:119], v[60:63]
  buffer_load_dwordx4 v[204:207], v5, s[12:15], s97 offen offset:0 sc1
  v_mfma_f32_16x16x32_bf16 v[64:67], v[244:247], v[116:119], v[64:67]
  v_mfma_f32_16x16x32_bf16 v[68:71], v[248:251], v[116:119], v[68:71]
  v_mfma_f32_16x16x32_bf16 v[72:75], v[232:235], v[120:123], v[72:75]
  v_mfma_f32_16x16x32_bf16 v[76:79], v[236:239], v[120:123], v[76:79]
  v_mfma_f32_16x16x32_bf16 v[80:83], v[240:243], v[120:123], v[80:83]
  v_mfma_f32_16x16x32_bf16 v[84:87], v[244:247], v[120:123], v[84:87]
  v_mfma_f32_16x16x32_bf16 v[88:91], v[248:251], v[120:123], v[88:91]
  v_mfma_f32_16x16x32_bf16 v[92:95], v[232:235], v[124:127], v[92:95]
  v_mfma_f32_16x16x32_bf16 v[96:99], v[236:239], v[124:127], v[96:99]
  v_mfma_f32_16x16x32_bf16 v[100:103], v[240:243], v[124:127], v[100:103]
  v_mfma_f32_16x16x32_bf16 v[104:107], v[244:247], v[124:127], v[104:107]
  v_mfma_f32_16x16x32_bf16 v[108:111], v[248:251], v[124:127], v[108:111]
  s_waitcnt vmcnt(16)
  v_mfma_f32_16x16x32_bf16 v[32:35], v[252:255], v[128:131], v[32:35]
  v_mfma_f32_16x16x32_bf16 v[36:39], a[0:3], v[128:131], v[36:39]
  buffer_load_dwordx2 v[112:113], v6, s[12:15], s83 offen offset:2048 sc1
  buffer_load_dwordx2 v[114:115], v6, s[12:15], s83 offen offset:2560 sc1
  v_mfma_f32_16x16x32_bf16 v[40:43], a[4:7], v[128:131], v[40:43]
  v_mfma_f32_16x16x32_bf16 v[44:47], a[8:11], v[128:131], v[44:47]
  buffer_load_dwordx2 v[116:117], v6, s[12:15], s87 offen offset:2048 sc1
  buffer_load_dwordx2 v[118:119], v6, s[12:15], s87 offen offset:2560 sc1
  v_mfma_f32_16x16x32_bf16 v[48:51], a[12:15], v[128:131], v[48:51]
  v_mfma_f32_16x16x32_bf16 v[52:55], v[252:255], v[132:135], v[52:55]
  buffer_load_dwordx2 v[120:121], v6, s[12:15], s91 offen offset:2048 sc1
  buffer_load_dwordx2 v[122:123], v6, s[12:15], s91 offen offset:2560 sc1
  v_mfma_f32_16x16x32_bf16 v[56:59], a[0:3], v[132:135], v[56:59]
  v_mfma_f32_16x16x32_bf16 v[60:63], a[4:7], v[132:135], v[60:63]
  buffer_load_dwordx2 v[124:125], v6, s[12:15], s95 offen offset:2048 sc1
  buffer_load_dwordx2 v[126:127], v6, s[12:15], s95 offen offset:2560 sc1
  v_mfma_f32_16x16x32_bf16 v[64:67], a[8:11], v[132:135], v[64:67]
  v_mfma_f32_16x16x32_bf16 v[68:71], a[12:15], v[132:135], v[68:71]
  v_mfma_f32_16x16x32_bf16 v[72:75], v[252:255], v[136:139], v[72:75]
  v_mfma_f32_16x16x32_bf16 v[76:79], a[0:3], v[136:139], v[76:79]
  v_mfma_f32_16x16x32_bf16 v[80:83], a[4:7], v[136:139], v[80:83]
  v_mfma_f32_16x16x32_bf16 v[84:87], a[8:11], v[136:139], v[84:87]
  v_mfma_f32_16x16x32_bf16 v[88:91], a[12:15], v[136:139], v[88:91]
  v_mfma_f32_16x16x32_bf16 v[92:95], v[252:255], v[140:143], v[92:95]
  v_mfma_f32_16x16x32_bf16 v[96:99], a[0:3], v[140:143], v[96:99]
  v_mfma_f32_16x16x32_bf16 v[100:103], a[4:7], v[140:143], v[100:103]
  v_mfma_f32_16x16x32_bf16 v[104:107], a[8:11], v[140:143], v[104:107]
  v_mfma_f32_16x16x32_bf16 v[108:111], a[12:15], v[140:143], v[108:111]
  s_waitcnt vmcnt(20)
  v_mfma_f32_16x16x32_bf16 v[32:35], a[16:19], v[144:147], v[32:35]
  v_mfma_f32_16x16x32_bf16 v[36:39], a[20:23], v[144:147], v[36:39]
  buffer_load_dwordx2 v[128:129], v6, s[12:15], s85 offen offset:1024 sc1
  buffer_load_dwordx2 v[130:131], v6, s[12:15], s85 offen offset:1536 sc1
  v_mfma_f32_16x16x32_bf16 v[40:43], a[24:27], v[144:147], v[40:43]
  v_mfma_f32_16x16x32_bf16 v[44:47], a[28:31], v[144:147], v[44:47]
  buffer_load_dwordx2 v[132:133], v6, s[12:15], s89 offen offset:1024 sc1
  buffer_load_dwordx2 v[134:135], v6, s[12:15], s89 offen offset:1536 sc1
  v_mfma_f32_16x16x32_bf16 v[48:51], a[32:35], v[144:147], v[48:51]
  v_mfma_f32_16x16x32_bf16 v[52:55], a[16:19], v[148:151], v[52:55]
  buffer_load_dwordx2 v[136:137], v6, s[12:15], s93 offen offset:1024 sc1
  buffer_load_dwordx2 v[138:139], v6, s[12:15], s93 offen offset:1536 sc1
  v_mfma_f32_16x16x32_bf16 v[56:59], a[20:23], v[148:151], v[56:59]
  v_mfma_f32_16x16x32_bf16 v[60:63], a[24:27], v[148:151], v[60:63]
  buffer_load_dwordx2 v[140:141], v6, s[12:15], s97 offen offset:1024 sc1
  buffer_load_dwordx2 v[142:143], v6, s[12:15], s97 offen offset:1536 sc1
  v_mfma_f32_16x16x32_bf16 v[64:67], a[28:31], v[148:151], v[64:67]
  v_mfma_f32_16x16x32_bf16 v[68:71], a[32:35], v[148:151], v[68:71]
  v_mfma_f32_16x16x32_bf16 v[72:75], a[16:19], v[152:155], v[72:75]
  v_mfma_f32_16x16x32_bf16 v[76:79], a[20:23], v[152:155], v[76:79]
  v_mfma_f32_16x16x32_bf16 v[80:83], a[24:27], v[152:155], v[80:83]
  v_mfma_f32_16x16x32_bf16 v[84:87], a[28:31], v[152:155], v[84:87]
  v_mfma_f32_16x16x32_bf16 v[88:91], a[32:35], v[152:155], v[88:91]
  v_mfma_f32_16x16x32_bf16 v[92:95], a[16:19], v[156:159], v[92:95]
  v_mfma_f32_16x16x32_bf16 v[96:99], a[20:23], v[156:159], v[96:99]
  v_mfma_f32_16x16x32_bf16 v[100:103], a[24:27], v[156:159], v[100:103]
  v_mfma_f32_16x16x32_bf16 v[104:107], a[28:31], v[156:159], v[104:107]
  v_mfma_f32_16x16x32_bf16 v[108:111], a[32:35], v[156:159], v[108:111]
  s_waitcnt vmcnt(24)
  v_mfma_f32_16x16x32_bf16 v[32:35], a[36:39], v[160:163], v[32:35]
  v_mfma_f32_16x16x32_bf16 v[36:39], a[40:43], v[160:163], v[36:39]
  v_mfma_f32_16x16x32_bf16 v[40:43], a[44:47], v[160:163], v[40:43]
  v_mfma_f32_16x16x32_bf16 v[44:47], a[48:51], v[160:163], v[44:47]
  s_mul_i32 s54, s3, 25600
  s_mul_i32 s55, s5, 0x28000
  s_add_u32 s55, s55, s54
  s_add_u32 m0, s54, 0
  s_add_u32 s53, s55, 0x0
  buffer_load_dwordx4 v5, s[60:63], s53 offen offset:0 lds
  v_mfma_f32_16x16x32_bf16 v[48:51], a[52:55], v[160:163], v[48:51]
  v_mfma_f32_16x16x32_bf16 v[52:55], a[36:39], v[164:167], v[52:55]
  v_mfma_f32_16x16x32_bf16 v[56:59], a[40:43], v[164:167], v[56:59]
  v_mfma_f32_16x16x32_bf16 v[60:63], a[44:47], v[164:167], v[60:63]
  buffer_load_dwordx4 v5, s[60:63], s53 offen offset:1024 lds
  v_mfma_f32_16x16x32_bf16 v[64:67], a[48:51], v[164:167], v[64:67]
  v_mfma_f32_16x16x32_bf16 v[68:71], a[52:55], v[164:167], v[68:71]
  v_mfma_f32_16x16x32_bf16 v[72:75], a[36:39], v[168:171], v[72:75]
  v_mfma_f32_16x16x32_bf16 v[76:79], a[40:43], v[168:171], v[76:79]
  buffer_load_dwordx4 v5, s[60:63], s53 offen offset:2048 lds
  v_mfma_f32_16x16x32_bf16 v[80:83], a[44:47], v[168:171], v[80:83]
  v_mfma_f32_16x16x32_bf16 v[84:87], a[48:51], v[168:171], v[84:87]
  v_mfma_f32_16x16x32_bf16 v[88:91], a[52:55], v[168:171], v[88:91]
  v_mfma_f32_16x16x32_bf16 v[92:95], a[36:39], v[172:175], v[92:95]
  buffer_load_dwordx4 v5, s[60:63], s53 offen offset:3072 lds
  v_mfma_f32_16x16x32_bf16 v[96:99], a[40:43], v[172:175], v[96:99]
  v_mfma_f32_16x16x32_bf16 v[100:103], a[44:47], v[172:175], v[100:103]
  v_mfma_f32_16x16x32_bf16 v[104:107], a[48:51], v[172:175], v[104:107]
  v_mfma_f32_16x16x32_bf16 v[108:111], a[52:55], v[172:175], v[108:111]
  s_add_u32 m0, s54, 4096
  s_add_u32 s53, s55, 0x1000
  buffer_load_dwordx4 v5, s[60:63], s53 offen offset:0 lds
  s_waitcnt vmcnt(25)
  v_mfma_f32_16x16x32_bf16 v[32:35], a[56:59], v[176:179], v[32:35]
  v_mfma_f32_16x16x32_bf16 v[36:39], a[60:63], v[176:179], v[36:39]
  v_mfma_f32_16x16x32_bf16 v[40:43], a[64:67], v[176:179], v[40:43]
  v_mfma_f32_16x16x32_bf16 v[44:47], a[68:71], v[176:179], v[44:47]
  buffer_load_dwordx4 v5, s[60:63], s53 offen offset:1024 lds
  v_mfma_f32_16x16x32_bf16 v[48:51], a[72:75], v[176:179], v[48:51]
  v_mfma_f32_16x16x32_bf16 v[52:55], a[56:59], v[180:183], v[52:55]
  v_mfma_f32_16x16x32_bf16 v[56:59], a[60:63], v[180:183], v[56:59]
  v_mfma_f32_16x16x32_bf16 v[60:63], a[64:67], v[180:183], v[60:63]
  buffer_load_dwordx4 v5, s[60:63], s53 offen offset:2048 lds
  v_mfma_f32_16x16x32_bf16 v[64:67], a[68:71], v[180:183], v[64:67]
  v_mfma_f32_16x16x32_bf16 v[68:71], a[72:75], v[180:183], v[68:71]
  v_mfma_f32_16x16x32_bf16 v[72:75], a[56:59], v[184:187], v[72:75]
  v_mfma_f32_16x16x32_bf16 v[76:79], a[60:63], v[184:187], v[76:79]
  buffer_load_dwordx4 v5, s[60:63], s53 offen offset:3072 lds
  v_mfma_f32_16x16x32_bf16 v[80:83], a[64:67], v[184:187], v[80:83]
  v_mfma_f32_16x16x32_bf16 v[84:87], a[68:71], v[184:187], v[84:87]
  v_mfma_f32_16x16x32_bf16 v[88:91], a[72:75], v[184:187], v[88:91]
  v_mfma_f32_16x16x32_bf16 v[92:95], a[56:59], v[188:191], v[92:95]
  s_add_u32 m0, s54, 8192
  s_add_u32 s53, s55, 0x2000
  buffer_load_dwordx4 v5, s[60:63], s53 offen offset:0 lds
  v_mfma_f32_16x16x32_bf16 v[96:99], a[60:63], v[188:191], v[96:99]
  v_mfma_f32_16x16x32_bf16 v[100:103], a[64:67], v[188:191], v[100:103]
  v_mfma_f32_16x16x32_bf16 v[104:107], a[68:71], v[188:191], v[104:107]
  v_mfma_f32_16x16x32_bf16 v[108:111], a[72:75], v[188:191], v[108:111]
  buffer_load_dwordx4 v5, s[60:63], s53 offen offset:1024 lds
  s_waitcnt vmcnt(26)
  v_mfma_f32_16x16x32_bf16 v[32:35], a[76:79], v[192:195], v[32:35]
  v_mfma_f32_16x16x32_bf16 v[36:39], a[80:83], v[192:195], v[36:39]
  v_mfma_f32_16x16x32_bf16 v[40:43], a[84:87], v[192:195], v[40:43]
  v_mfma_f32_16x16x32_bf16 v[44:47], a[88:91], v[192:195], v[44:47]
  buffer_load_dwordx4 v5, s[60:63], s53 offen offset:2048 lds
  v_mfma_f32_16x16x32_bf16 v[48:51], a[92:95], v[192:195], v[48:51]
  v_mfma_f32_16x16x32_bf16 v[52:55], a[76:79], v[196:199], v[52:55]
  v_mfma_f32_16x16x32_bf16 v[56:59], a[80:83], v[196:199], v[56:59]
  v_mfma_f32_16x16x32_bf16 v[60:63], a[84:87], v[196:199], v[60:63]
  buffer_load_dwordx4 v5, s[60:63], s53 offen offset:3072 lds
  v_mfma_f32_16x16x32_bf16 v[64:67], a[88:91], v[196:199], v[64:67]
  v_mfma_f32_16x16x32_bf16 v[68:71], a[92:95], v[196:199], v[68:71]
  v_mfma_f32_16x16x32_bf16 v[72:75], a[76:79], v[200:203], v[72:75]
  v_mfma_f32_16x16x32_bf16 v[76:79], a[80:83], v[200:203], v[76:79]
  s_add_u32 m0, s54, 12288
  s_add_u32 s53, s55, 0x3000
  buffer_load_dwordx4 v5, s[60:63], s53 offen offset:0 lds
  v_mfma_f32_16x16x32_bf16 v[80:83], a[84:87], v[200:203], v[80:83]
  v_mfma_f32_16x16x32_bf16 v[84:87], a[88:91], v[200:203], v[84:87]
  v_mfma_f32_16x16x32_bf16 v[88:91], a[92:95], v[200:203], v[88:91]
  v_mfma_f32_16x16x32_bf16 v[92:95], a[76:79], v[204:207], v[92:95]
  buffer_load_dwordx4 v5, s[60:63], s53 offen offset:1024 lds
  v_mfma_f32_16x16x32_bf16 v[96:99], a[80:83], v[204:207], v[96:99]
  v_mfma_f32_16x16x32_bf16 v[100:103], a[84:87], v[204:207], v[100:103]
  v_mfma_f32_16x16x32_bf16 v[104:107], a[88:91], v[204:207], v[104:107]
  v_mfma_f32_16x16x32_bf16 v[108:111], a[92:95], v[204:207], v[108:111]
  buffer_load_dwordx4 v5, s[60:63], s53 offen offset:2048 lds
  s_waitcnt vmcnt(23)
  v_mfma_f32_16x16x32_bf16 v[32:35], a[96:99], v[112:115], v[32:35]
  v_mfma_f32_16x16x32_bf16 v[36:39], a[100:103], v[112:115], v[36:39]
  v_mfma_f32_16x16x32_bf16 v[40:43], a[104:107], v[112:115], v[40:43]
  v_mfma_f32_16x16x32_bf16 v[44:47], a[108:111], v[112:115], v[44:47]
  buffer_load_dwordx4 v5, s[60:63], s53 offen offset:3072 lds
  v_mfma_f32_16x16x32_bf16 v[48:51], a[112:115], v[112:115], v[48:51]
  v_mfma_f32_16x16x32_bf16 v[52:55], a[96:99], v[116:119], v[52:55]
  v_mfma_f32_16x16x32_bf16 v[56:59], a[100:103], v[116:119], v[56:59]
  v_mfma_f32_16x16x32_bf16 v[60:63], a[104:107], v[116:119], v[60:63]
  s_add_u32 m0, s54, 16384
  s_add_u32 s53, s55, 0x4000
  buffer_load_dwordx4 v5, s[60:63], s53 offen offset:0 lds
  v_mfma_f32_16x16x32_bf16 v[64:67], a[108:111], v[116:119], v[64:67]
  v_mfma_f32_16x16x32_bf16 v[68:71], a[112:115], v[116:119], v[68:71]
  v_mfma_f32_16x16x32_bf16 v[72:75], a[96:99], v[120:123], v[72:75]
  v_mfma_f32_16x16x32_bf16 v[76:79], a[100:103], v[120:123], v[76:79]
  buffer_load_dwordx4 v5, s[60:63], s53 offen offset:1024 lds
  v_mfma_f32_16x16x32_bf16 v[80:83], a[104:107], v[120:123], v[80:83]
  v_mfma_f32_16x16x32_bf16 v[84:87], a[108:111], v[120:123], v[84:87]
  v_mfma_f32_16x16x32_bf16 v[88:91], a[112:115], v[120:123], v[88:91]
  v_mfma_f32_16x16x32_bf16 v[92:95], a[96:99], v[124:127], v[92:95]
  buffer_load_dwordx4 v5, s[60:63], s53 offen offset:2048 lds
  v_mfma_f32_16x16x32_bf16 v[96:99], a[100:103], v[124:127], v[96:99]
  v_mfma_f32_16x16x32_bf16 v[100:103], a[104:107], v[124:127], v[100:103]
  v_mfma_f32_16x16x32_bf16 v[104:107], a[108:111], v[124:127], v[104:107]
  v_mfma_f32_16x16x32_bf16 v[108:111], a[112:115], v[124:127], v[108:111]
  buffer_load_dwordx4 v5, s[60:63], s53 offen offset:3072 lds
  s_waitcnt vmcnt(20)
  v_mfma_f32_16x16x32_bf16 v[32:35], a[116:119], v[128:131], v[32:35]
  v_mfma_f32_16x16x32_bf16 v[36:39], a[120:123], v[128:131], v[36:39]
  v_mfma_f32_16x16x32_bf16 v[40:43], a[124:127], v[128:131], v[40:43]
  v_mfma_f32_16x16x32_bf16 v[44:47], a[128:131], v[128:131], v[44:47]
  s_add_u32 m0, s54, 20480
  s_add_u32 s53, s55, 0x5000
  buffer_load_dwordx4 v5, s[60:63], s53 offen offset:0 lds
  v_mfma_f32_16x16x32_bf16 v[48:51], a[132:135], v[128:131], v[48:51]
  v_mfma_f32_16x16x32_bf16 v[52:55], a[116:119], v[132:135], v[52:55]
  v_mfma_f32_16x16x32_bf16 v[56:59], a[120:123], v[132:135], v[56:59]
  v_mfma_f32_16x16x32_bf16 v[60:63], a[124:127], v[132:135], v[60:63]
  buffer_load_dwordx4 v5, s[60:63], s53 offen offset:1024 lds
  v_mfma_f32_16x16x32_bf16 v[64:67], a[128:131], v[132:135], v[64:67]
  v_mfma_f32_16x16x32_bf16 v[68:71], a[132:135], v[132:135], v[68:71]
  v_add_u32 v10, s40, v5
  ds_write_b128 v10, v[32:35] offset:0
  ds_write_b128 v10, v[36:39] offset:1024
  ds_write_b128 v10, v[40:43] offset:2048
  ds_write_b128 v10, v[44:47] offset:3072
  ds_write_b128 v10, v[48:51] offset:4096
  v_mfma_f32_16x16x32_bf16 v[72:75], a[116:119], v[136:139], v[72:75]
  v_mfma_f32_16x16x32_bf16 v[76:79], a[120:123], v[136:139], v[76:79]
  buffer_load_dwordx4 v5, s[60:63], s53 offen offset:2048 lds
  v_mfma_f32_16x16x32_bf16 v[80:83], a[124:127], v[136:139], v[80:83]
  v_mfma_f32_16x16x32_bf16 v[84:87], a[128:131], v[136:139], v[84:87]
  v_mfma_f32_16x16x32_bf16 v[88:91], a[132:135], v[136:139], v[88:91]
  v_add_u32 v10, s41, v5
  ds_write_b128 v10, v[52:55] offset:0
  ds_write_b128 v10, v[56:59] offset:1024
  ds_write_b128 v10, v[60:63] offset:2048
  ds_write_b128 v10, v[64:67] offset:3072
  ds_write_b128 v10, v[68:71] offset:4096
  v_mfma_f32_16x16x32_bf16 v[92:95], a[116:119], v[140:143], v[92:95]
  buffer_load_dwordx4 v5, s[60:63], s53 offen offset:3072 lds
  v_mfma_f32_16x16x32_bf16 v[96:99], a[120:123], v[140:143], v[96:99]
  v_mfma_f32_16x16x32_bf16 v[100:103], a[124:127], v[140:143], v[100:103]
  v_mfma_f32_16x16x32_bf16 v[104:107], a[128:131], v[140:143], v[104:107]
  v_mfma_f32_16x16x32_bf16 v[108:111], a[132:135], v[140:143], v[108:111]
  s_add_u32 m0, s54, 24576
  s_add_u32 s53, s55, 0x6000
  buffer_load_dwordx4 v5, s[60:63], s53 offen offset:0 lds
  v_add_u32 v10, s42, v5
  ds_write_b128 v10, v[72:75] offset:0
  ds_write_b128 v10, v[76:79] offset:1024
  ds_write_b128 v10, v[80:83] offset:2048
  ds_write_b128 v10, v[84:87] offset:3072
  ds_write_b128 v10, v[88:91] offset:4096
  s_waitcnt lgkmcnt(0)
  s_barrier
  v_add_u32 v10, s43, v5
  ds_read_b128 v[112:115], v10 offset:0
  ds_read_b128 v[116:119], v10 offset:1024
  ds_read_b128 v[120:123], v10 offset:2048
  ds_read_b128 v[124:127], v10 offset:3072
  ds_read_b128 v[128:131], v10 offset:4096
  ds_read_b128 v[132:135], v10 offset:5120
  ds_read_b128 v[136:139], v10 offset:6144
  ds_read_b128 v[140:143], v10 offset:7168
  ds_read_b128 v[144:147], v10 offset:8192
  ds_read_b128 v[148:151], v10 offset:9216
  ds_read_b128 v[152:155], v10 offset:10240
  ds_read_b128 v[156:159], v10 offset:11264
  ds_read_b128 v[160:163], v10 offset:12288
  ds_read_b128 v[164:167], v10 offset:13312
  ds_read_b128 v[168:171], v10 offset:14336
  v_lshlrev_b32 v172, 16, v16
  v_and_b32 v173, 0xffff0000, v16
  v_lshlrev_b32 v174, 16, v17
  v_and_b32 v175, 0xffff0000, v17
  v_lshlrev_b32 v176, 16, v18
  v_and_b32 v177, 0xffff0000, v18
  v_lshlrev_b32 v178, 16, v19
  v_and_b32 v179, 0xffff0000, v19
  v_lshlrev_b32 v180, 16, v20
  v_and_b32 v181, 0xffff0000, v20
  v_lshlrev_b32 v182, 16, v21
  v_and_b32 v183, 0xffff0000, v21
  v_lshlrev_b32 v184, 16, v22
  v_and_b32 v185, 0xffff0000, v22
  v_lshlrev_b32 v186, 16, v23
  v_and_b32 v187, 0xffff0000, v23
  v_lshlrev_b32 v188, 16, v24
  v_and_b32 v189, 0xffff0000, v24
  v_lshlrev_b32 v190, 16, v25
  v_and_b32 v191, 0xffff0000, v25
  v_pk_add_f32 v[92:93], v[92:93], v[172:173]
  v_pk_add_f32 v[94:95], v[94:95], v[174:175]
  v_pk_add_f32 v[96:97], v[96:97], v[176:177]
  v_pk_add_f32 v[98:99], v[98:99], v[178:179]
  v_pk_add_f32 v[100:101], v[100:101], v[180:181]
  v_pk_add_f32 v[102:103], v[102:103], v[182:183]
  v_pk_add_f32 v[104:105], v[104:105], v[184:185]
  v_pk_add_f32 v[106:107], v[106:107], v[186:187]
  v_pk_add_f32 v[108:109], v[108:109], v[188:189]
  v_pk_add_f32 v[110:111], v[110:111], v[190:191]
  s_waitcnt lgkmcnt(10)
  v_pk_add_f32 v[92:93], v[92:93], v[112:113]
  v_pk_add_f32 v[94:95], v[94:95], v[114:115]
  v_pk_add_f32 v[96:97], v[96:97], v[116:117]
  v_pk_add_f32 v[98:99], v[98:99], v[118:119]
  v_pk_add_f32 v[100:101], v[100:101], v[120:121]
  v_pk_add_f32 v[102:103], v[102:103], v[122:123]
  v_pk_add_f32 v[104:105], v[104:105], v[124:125]
  v_pk_add_f32 v[106:107], v[106:107], v[126:127]
  v_pk_add_f32 v[108:109], v[108:109], v[128:129]
  v_pk_add_f32 v[110:111], v[110:111], v[130:131]
  s_waitcnt lgkmcnt(5)
  v_pk_add_f32 v[92:93], v[92:93], v[132:133]
  v_pk_add_f32 v[94:95], v[94:95], v[134:135]
  v_pk_add_f32 v[96:97], v[96:97], v[136:137]
  v_pk_add_f32 v[98:99], v[98:99], v[138:139]
  v_pk_add_f32 v[100:101], v[100:101], v[140:141]
  v_pk_add_f32 v[102:103], v[102:103], v[142:143]
  v_pk_add_f32 v[104:105], v[104:105], v[144:145]
  v_pk_add_f32 v[106:107], v[106:107], v[146:147]
  v_pk_add_f32 v[108:109], v[108:109], v[148:149]
  v_pk_add_f32 v[110:111], v[110:111], v[150:151]
  s_waitcnt lgkmcnt(0)
  v_pk_add_f32 v[92:93], v[92:93], v[152:153]
  v_pk_add_f32 v[94:95], v[94:95], v[154:155]
  v_pk_add_f32 v[96:97], v[96:97], v[156:157]
  v_pk_add_f32 v[98:99], v[98:99], v[158:159]
  v_pk_add_f32 v[100:101], v[100:101], v[160:161]
  v_pk_add_f32 v[102:103], v[102:103], v[162:163]
  v_pk_add_f32 v[104:105], v[104:105], v[164:165]
  v_pk_add_f32 v[106:107], v[106:107], v[166:167]
  v_pk_add_f32 v[108:109], v[108:109], v[168:169]
  v_pk_add_f32 v[110:111], v[110:111], v[170:171]
  v_cvt_pk_bf16_f32 v16, v92, v93
  v_cvt_pk_bf16_f32 v17, v94, v95
  v_cvt_pk_bf16_f32 v18, v96, v97
  v_cvt_pk_bf16_f32 v19, v98, v99
  v_cvt_pk_bf16_f32 v20, v100, v101
  v_cvt_pk_bf16_f32 v21, v102, v103
  v_cvt_pk_bf16_f32 v22, v104, v105
  v_cvt_pk_bf16_f32 v23, v106, v107
  v_cvt_pk_bf16_f32 v24, v108, v109
  v_cvt_pk_bf16_f32 v25, v110, v111
  s_cmp_eq_u32 s9, 1
  s_cbranch_scc1 FINAL
  buffer_store_dwordx4 v[16:19], v5, s[12:15], s44 offen sc1
  buffer_store_dwordx4 v[20:23], v5, s[12:15], s44 offen offset:1024 sc1
  buffer_store_dwordx2 v[24:25], v6, s[12:15], s45 offen sc1
  s_mov_b32 s46, 0x3f803f80
  v_mov_b32 v10, 0
  v_mov_b32 v11, 0
  v_mov_b32 v12, 0
  v_mov_b32 v13, 0
  v_dot2_f32_bf16 v10, v16, s46, v10
  v_dot2_f32_bf16 v11, v16, v16, v11
  v_dot2_f32_bf16 v12, v17, s46, v12
  v_dot2_f32_bf16 v13, v17, v17, v13
  v_dot2_f32_bf16 v10, v18, s46, v10
  v_dot2_f32_bf16 v11, v18, v18, v11
  v_dot2_f32_bf16 v12, v19, s46, v12
  v_dot2_f32_bf16 v13, v19, v19, v13
  v_dot2_f32_bf16 v10, v20, s46, v10
  v_dot2_f32_bf16 v11, v20, v20, v11
  v_dot2_f32_bf16 v12, v21, s46, v12
  v_dot2_f32_bf16 v13, v21, v21, v13
  v_dot2_f32_bf16 v10, v22, s46, v10
  v_dot2_f32_bf16 v11, v22, v22, v11
  v_dot2_f32_bf16 v12, v23, s46, v12
  v_dot2_f32_bf16 v13, v23, v23, v13
  v_dot2_f32_bf16 v10, v24, s46, v10
  v_dot2_f32_bf16 v11, v24, v24, v11
  v_dot2_f32_bf16 v12, v25, s46, v12
  v_dot2_f32_bf16 v13, v25, v25, v13
  v_lshlrev_b32 v14, 3, v4
  v_mov_b32 v15, 0x40000000
  v_cmp_eq_u32 vcc, 0, v3
  s_nop 1
  v_cndmask_b32 v14, v15, v14, vcc
  s_mul_i32 s46, s9, 0x40000
  s_mul_i32 s8, s21, 0x400
  s_add_u32 s46, s46, s8
  s_mul_i32 s8, s7, 0x80
  s_add_u32 s46, s46, s8
  s_add_u32 s46, s46, 0x141e000
  v_pk_add_f32 v[10:11], v[10:11], v[12:13]
  v_mov_b32 v12, v10
  v_mov_b32 v13, v11
  s_nop 0
  v_permlane16_swap_b32 v10, v12
  v_permlane16_swap_b32 v11, v13
  v_pk_add_f32 v[10:11], v[10:11], v[12:13]
  v_mov_b32 v12, v10
  v_mov_b32 v13, v11
  s_nop 0
  v_permlane32_swap_b32 v10, v12
  v_permlane32_swap_b32 v11, v13
  v_pk_add_f32 v[10:11], v[10:11], v[12:13]
  buffer_store_dwordx2 v[10:11], v14, s[12:15], s46 offen sc1
  s_add_u32 s36, s36, 0x280000
  s_add_u32 s37, s37, 0x280000
  s_add_u32 s38, s38, 0x280000
  s_add_u32 s39, s39, 0x280000
  s_add_u32 s82, s82, 0x700000
  s_add_u32 s83, s83, 0x700000
  s_add_u32 s84, s84, 0x700000
  s_add_u32 s85, s85, 0x700000
  s_add_u32 s86, s86, 0x700000
  s_add_u32 s87, s87, 0x700000
  s_add_u32 s88, s88, 0x700000
  s_add_u32 s89, s89, 0x700000
  s_add_u32 s90, s90, 0x700000
  s_add_u32 s91, s91, 0x700000
  s_add_u32 s92, s92, 0x700000
  s_add_u32 s93, s93, 0x700000
  s_add_u32 s94, s94, 0x700000
  s_add_u32 s95, s95, 0x700000
  s_add_u32 s96, s96, 0x700000
  s_add_u32 s97, s97, 0x700000
  s_waitcnt vmcnt(0)
  s_barrier
  s_cmp_lg_u32 s3, 0
  s_cbranch_scc1 W0_33
  v_mov_b32 v26, 1
  buffer_atomic_add v26, v28, s[12:15], s78 offen sc1
W0_33:
  s_add_u32 s23, s23, 1
  s_add_u32 s9, s9, 1
  s_mul_i32 s24, s9, 0x500000
  s_mul_i32 s8, s20, 0x5000
  s_add_u32 s24, s24, s8
  s_add_u32 s24, s24, 0x9de000
  s_add_u32 s25, s24, 20480
  s_cmp_lg_u32 s3, 0
  s_cbranch_scc1 W0_34
  s_mov_b32 s74, 0
PL_35:
  buffer_load_dword v26, v29, s[12:15], s79 offen sc1
  s_waitcnt vmcnt(0)
  v_cmp_gt_u32 vcc, s23, v26
  s_cmp_eq_u64 vcc, 0
  s_cbranch_scc1 PD_36
  s_add_u32 s74, s74, 1
  s_cmp_lt_u32 s74, 0x40000
  s_cbranch_scc1 PL_35
PD_36:
W0_34:
  s_barrier
  s_add_u32 s22, s22, 1
  s_branch LOOP
FINAL:
  v_mul_u32_u24 v10, 1280, v4
  v_lshl_add_u32 v10, v3, 3, v10
  s_mul_i32 s46, s21, 0x5000
  s_mul_i32 s8, s7, 0xa0
  s_add_u32 s46, s46, s8
  s_and_b32 s47, s7, 1
  s_cmp_eq_u32 s47, 1
  s_mov_b32 s50, 0
  s_cselect_b32 s50, 32, s50
  s_add_u32 s50, s50, s46
  buffer_store_dwordx2 v[16:17], v10, s[16:19], s50 offen
  s_cmp_eq_u32 s47, 1
  s_mov_b32 s50, 32
  s_cselect_b32 s50, 64, s50
  s_add_u32 s50, s50, s46
  buffer_store_dwordx2 v[18:19], v10, s[16:19], s50 offen
  s_cmp_eq_u32 s47, 1
  s_mov_b32 s50, 64
  s_cselect_b32 s50, 96, s50
  s_add_u32 s50, s50, s46
  buffer_store_dwordx2 v[20:21], v10, s[16:19], s50 offen
  s_cmp_eq_u32 s47, 1
  s_mov_b32 s50, 96
  s_cselect_b32 s50, 128, s50
  s_add_u32 s50, s50, s46
  buffer_store_dwordx2 v[22:23], v10, s[16:19], s50 offen
  s_cmp_eq_u32 s47, 1
  s_mov_b32 s50, 128
  s_cselect_b32 s50, 0, s50
  s_add_u32 s50, s50, s46
  buffer_store_dwordx2 v[24:25], v10, s[16:19], s50 offen
  s_waitcnt vmcnt(0)
MAIN_END:
  s_endpgm
.section .rodata,"a"
.p2align 6
.amdhsa_kernel k0_kernel
  .amdhsa_next_free_vgpr 128
  .amdhsa_next_free_sgpr 102
  .amdhsa_accum_offset 128
  .amdhsa_group_segment_fixed_size 0
  .amdhsa_kernarg_size 80
  .amdhsa_user_sgpr_count 2
  .amdhsa_user_sgpr_kernarg_segment_ptr 1
  .amdhsa_system_sgpr_workgroup_id_x 1
.end_amdhsa_kernel
.p2align 6
.amdhsa_kernel main_kernel
  .amdhsa_next_free_vgpr 512
  .amdhsa_next_free_sgpr 102
  .amdhsa_accum_offset 256
  .amdhsa_group_segment_fixed_size 0
  .amdhsa_kernarg_size 80
  .amdhsa_user_sgpr_count 2
  .amdhsa_user_sgpr_kernarg_segment_ptr 1
  .amdhsa_system_sgpr_workgroup_id_x 1
.end_amdhsa_kernel
```
